```python
import torch

def _softmax(x, axis=-1):
    return torch.softmax(x, dim=axis)
def _gelu(x):
    return torch.nn.functional.gelu(x, approximate="tanh")
def _silu(x):
    return torch.nn.functional.silu(x)
def _sigmoid(x):
    return torch.sigmoid(x)
def _layernorm(x, axis=-1, eps=1e-5):
    m = x.mean(dim=axis, keepdim=True)
    v = x.var(dim=axis, keepdim=True, unbiased=False)
    return (x - m) / torch.sqrt(v + eps)
def _scatter_add(tgt, idx, src, axis=0):
    return tgt.clone().index_add_(axis, idx, src)
def _segment_sum(src, seg, n):
    out = torch.zeros((n,) + src.shape[1:], dtype=src.dtype)
    return out.index_add_(0, seg, src)
def _pad(x, pw):
    flat = tuple(v for pair in reversed(pw) for v in pair)
    return torch.nn.functional.pad(x, flat)

kernel_name = 'standalone__gqa_block_cached__near_ridge'

def setup_inputs():

    _w = (lambda a: (lambda t: t.to(torch.bfloat16) if t.is_floating_point() else t)(torch.as_tensor(a)))
    B, Sq, D = 8, 288, 512
    Hq, Hkv, Sk, Dh = 32, 32, 1024, 128
    assert Hq % Hkv == 0, (Hq, Hkv)
    return {
        "x": _w((lambda *s: torch.randn(*s, dtype=torch.bfloat16) * 0.8)(B, Sq, D)),
        "k_cache": _w((lambda *s: torch.randn(*s, dtype=torch.bfloat16) * 0.8)(B, Hkv, Sk, Dh)),
        "v_cache": _w((lambda *s: torch.randn(*s, dtype=torch.bfloat16) * 0.05)(B, Hkv, Sk, Dh)),
        "wq": _w((lambda *s: torch.randn(*s, dtype=torch.bfloat16) * 0.8)(D, Hq * Dh) * (D ** -0.5)),
        "wo": _w((lambda *s: torch.randn(*s, dtype=torch.bfloat16) * 0.05)(Hq * Dh, D) * ((Hq * Dh) ** -0.5)),
    }

def reference(x, k_cache, v_cache, wq, wo):
    B, Sq, D = x.shape
    Hq, Dh = 32, 128
    Hkv = k_cache.shape[1]
    rep = Hq // Hkv
    q = (lambda x, *d: x.permute(*d))((x @ wq).reshape(B, Sq, Hq, Dh), 0, 2, 1, 3)
    k = (lambda x, n, axis: torch.repeat_interleave(x, n, dim=axis))(k_cache, rep, axis=1)
    v = (lambda x, n, axis: torch.repeat_interleave(x, n, dim=axis))(v_cache, rep, axis=1)
    scores = torch.einsum("bhqd,bhkd->bhqk", q, k) * (Dh ** -0.5)
    p = _softmax(scores, axis=-1)
    o = torch.einsum("bhqk,bhkd->bhqd", p, v)
    return (lambda x, *d: x.permute(*d))(o, 0, 2, 1, 3).reshape(B, Sq, Hq * Dh) @ wo
```

```asm
; @launch grid=(256,1,1) block=(256,1,1) lds=163840
.amdgcn_target "amdgcn-amd-amdhsa--gfx950"
.text
.globl standalone__gqa_block_cached__near_ridge_kernel
.p2align 8
.type standalone__gqa_block_cached__near_ridge_kernel,@function
standalone__gqa_block_cached__near_ridge_kernel:
    s_cmp_ge_u32 s2, 256
    s_cbranch_scc1 L_end
    s_load_dwordx16 s[32:47], s[0:1], 0
    v_lshrrev_b32 v1, 6, v0
    v_and_b32 v0, 63, v0
    v_readfirstlane_b32 s3, v1
    s_mov_b32 s59, 0
L_restart:
    s_lshr_b32 s4, s2, 5
    s_and_b32 s6, s2, 7
    s_lshl_b32 s6, s6, 2
    s_bfe_u32 s7, s2, 0x20003
    s_add_u32 s5, s6, s7
    v_lshrrev_b32 v232, 3, v0
    v_and_b32 v233, 7, v0
    v_lshrrev_b32 v234, 1, v232
    v_and_b32 v235, 1, v234
    v_lshlrev_b32 v235, 1, v235
    v_xor_b32 v235, v235, v233
    v_lshlrev_b32 v236, 13, v232
    v_lshl_add_u32 v74, v235, 4, v236
    s_and_b32 s6, s3, 1
    s_lshl_b32 s7, s6, 6
    v_xor_b32 v74, s7, v74
    s_lshl_b32 s6, s6, 2
    v_xor_b32 v235, v234, v233
    v_xor_b32 v237, s6, v235
    v_lshlrev_b32 v236, 10, v232
    v_lshl_add_u32 v72, v237, 4, v236
    v_xor_b32 v73, 64, v72
    s_mul_i32 s60, s3, 73728
    s_mul_i32 s61, s3, 9216
    s_lshl_b32 s62, s3, 16
    s_lshl_b32 s63, s3, 11
    s_add_u32 s63, s63, 36864
    s_mul_i32 s6, s4, 294912
    s_lshl_b32 s7, s5, 8
    s_mov_b32 s18, 294912
    s_mov_b32 s19, 0x20000
    s_sub_u32 s22, 4194304, s7
    s_mov_b32 s23, 0x20000
    s_add_u32 s100, s5, s4
    s_and_b32 s100, s100, 1
    s_getpc_b64 s[96:97]
L_pc0:
    s_lshr_b32 s98, s2, 3
    s_lshl_b32 s98, s98, 2
    s_add_u32 s98, s98, s3
    s_lshl_b32 s98, s98, 6
    s_waitcnt lgkmcnt(0)
    s_load_dword s99, s[96:97], s98
    s_add_u32 s98, s98, 8192
    s_load_dword s99, s[96:97], s98
    s_add_u32 s98, s98, 8192
    s_load_dword s99, s[96:97], s98
    s_add_u32 s98, s98, 8192
    s_load_dword s99, s[96:97], s98
    s_add_u32 s98, s98, 8192
    s_load_dword s99, s[96:97], s98
    s_add_u32 s98, s98, 8192
    s_add_u32 s16, s32, s6
    s_addc_u32 s17, s33, 0
    s_add_u32 s20, s38, s7
    s_addc_u32 s21, s39, 0
    s_xor_b32 s101, s100, 0
    s_lshl_b32 s66, s101, 19
    s_add_u32 s66, s66, s62
    s_lshl_b32 s101, s101, 7
    s_add_u32 s101, s101, s60
    s_add_u32 m0, s63, 0
    s_add_u32 s64, s66, 0
    buffer_load_dwordx4 v74, s[20:23], s64 offen lds
    s_add_u32 m0, s63, 1024
    s_add_u32 s64, s66, 128
    buffer_load_dwordx4 v74, s[20:23], s64 offen lds
    s_add_u32 m0, s63, 8192
    s_add_u32 s64, s66, 262144
    buffer_load_dwordx4 v74, s[20:23], s64 offen lds
    s_add_u32 m0, s63, 9216
    s_add_u32 s64, s66, 262272
    buffer_load_dwordx4 v74, s[20:23], s64 offen lds
    s_add_u32 m0, s61, 0
    s_add_u32 s64, s101, 0
    buffer_load_dwordx4 v72, s[16:19], s64 offen lds
    s_add_u32 m0, s61, 1024
    s_add_u32 s64, s101, 8192
    buffer_load_dwordx4 v73, s[16:19], s64 offen lds
    s_add_u32 m0, s61, 2048
    s_add_u32 s64, s101, 16384
    buffer_load_dwordx4 v72, s[16:19], s64 offen lds
    s_add_u32 m0, s61, 3072
    s_add_u32 s64, s101, 24576
    buffer_load_dwordx4 v73, s[16:19], s64 offen lds
    s_add_u32 m0, s61, 4096
    s_add_u32 s64, s101, 32768
    buffer_load_dwordx4 v72, s[16:19], s64 offen lds
    s_add_u32 m0, s61, 5120
    s_add_u32 s64, s101, 40960
    buffer_load_dwordx4 v73, s[16:19], s64 offen lds
    s_add_u32 m0, s61, 6144
    s_add_u32 s64, s101, 49152
    buffer_load_dwordx4 v72, s[16:19], s64 offen lds
    s_add_u32 m0, s61, 7168
    s_add_u32 s64, s101, 57344
    buffer_load_dwordx4 v73, s[16:19], s64 offen lds
    s_add_u32 m0, s61, 8192
    s_add_u32 s64, s101, 65536
    buffer_load_dwordx4 v72, s[16:19], s64 offen lds
    s_lshl_b32 s91, s3, 13
    v_lshrrev_b32 v232, 3, v0
    v_and_b32 v233, 7, v0
    v_lshrrev_b32 v234, 1, v232
    v_xor_b32 v235, v234, v233
    v_lshlrev_b32 v236, 8, v232
    v_lshl_add_u32 v2, v235, 4, v236
    v_xor_b32 v4, 64, v2
    v_add_u32 v1, 1024, v2
    v_add_u32 v3, 1024, v4
    v_add_u32 v2, 128, v2
    v_add_u32 v4, 128, v4
    v_lshlrev_b32 v235, 1, v234
    v_xor_b32 v235, v235, v233
    v_lshl_add_u32 v6, v235, 4, v236
    v_add_u32 v5, 1024, v6
    v_add_u32 v6, 128, v6
    v_mov_b32 v7, v5
    v_mov_b32 v8, v6
    s_lshl_b32 s6, s4, 5
    s_add_u32 s6, s6, s5
    s_lshl_b32 s6, s6, 18
    s_add_u32 s8, s34, s6
    s_addc_u32 s9, s35, 0
    s_sub_u32 s8, s8, 1024
    s_subb_u32 s9, s9, 0
    s_mov_b32 s10, 263168
    s_mov_b32 s11, 0x20000
    s_add_u32 s12, s36, s6
    s_addc_u32 s13, s37, 0
    s_sub_u32 s12, s12, 1024
    s_subb_u32 s13, s13, 0
    s_mov_b32 s14, 263168
    s_mov_b32 s15, 0x20000
    s_lshr_b32 s38, s2, 3
    s_xor_b32 s38, s38, s2
    s_and_b32 s38, s38, 0
    s_lshl_b32 s38, s38, 15
    s_add_u32 s38, s38, s91
    s_mov_b32 s32, 0x3ffff
    s_mov_b32 s33, 0x3ffff
    s_mov_b32 s48, s38
    s_add_u32 s49, s38, 4096
    s_mov_b32 s50, s38
    s_add_u32 s51, s38, 4096
    s_mov_b32 s52, 32768
    s_mov_b32 s53, 32768
    s_add_u32 s67, s91, 131072
    s_mov_b32 s68, s67
    s_add_u32 s86, s91, 65536
    s_add_u32 s54, s91, 0
    s_add_u32 s55, s91, 4096
    s_add_u32 s56, s91, 32768
    s_add_u32 s57, s91, 36864
    s_mul_i32 s6, s4, 2359296
    s_add_u32 s24, s46, s6
    s_addc_u32 s25, s47, 0
    s_mov_b32 s26, 2359296
    s_mov_b32 s27, 0x20000
    s_lshr_b32 s88, s2, 5
    s_and_b32 s90, s2, 1
    s_bfe_u32 s87, s2, 0x20001
    s_bfe_u32 s6, s2, 0x10003
    s_lshl_b32 s6, s6, 2
    s_add_u32 s87, s87, s6
    s_bfe_u32 s6, s2, 0x10004
    s_lshl_b32 s89, s87, 1
    s_add_u32 s89, s89, s6
    s_mul_i32 s89, s89, 9
    v_and_b32 v238, 15, v0
    v_lshrrev_b32 v239, 4, v0
    v_bfe_u32 v240, v0, 2, 2
    v_and_b32 v241, 3, v0
    v_lshrrev_b32 v234, 3, v238
    v_lshlrev_b32 v234, 10, v234
    v_and_b32 v235, 7, v238
    v_lshl_add_u32 v234, v235, 7, v234
    v_lshrrev_b32 v235, 1, v238
    v_xor_b32 v235, v235, v239
    v_lshl_add_u32 v52, v235, 4, v234
    v_xor_b32 v53, 64, v52
    v_add_u32 v54, s91, v52
    v_add_u32 v55, s91, v53
    v_lshrrev_b32 v234, 1, v240
    v_and_b32 v235, 1, v239
    v_lshl_add_u32 v234, v235, 1, v234
    v_lshlrev_b32 v234, 5, v234
    v_lshl_add_u32 v234, v241, 3, v234
    v_lshl_add_u32 v234, v240, 7, v234
    v_lshl_add_u32 v234, v239, 11, v234
    v_add_u32 v56, 36864, v234
    v_xor_b32 v57, 32, v56
    v_xor_b32 v58, 64, v56
    v_xor_b32 v59, 96, v56
    s_and_b32 s6, s3, 1
    s_lshl_b32 s6, s6, 6
    s_lshr_b32 s7, s3, 1
    s_lshl_b32 s7, s7, 10
    v_xor_b32 v60, s6, v56
    v_add_u32 v60, s7, v60
    v_xor_b32 v61, 32, v60
    s_mov_b32 s65, 0x3e0293ee
    v_mov_b32 v252, s65
    v_mov_b32 v253, s65
    s_xor_b32 s101, s100, 1
    s_lshl_b32 s66, s101, 19
    s_add_u32 s66, s66, s62
    s_lshl_b32 s101, s101, 7
    s_add_u32 s101, s101, s60
    s_add_u32 m0, s63, 53248
    s_add_u32 s64, s66, 0
    buffer_load_dwordx4 v74, s[20:23], s64 offen lds
    s_add_u32 m0, s63, 54272
    s_add_u32 s64, s66, 128
    buffer_load_dwordx4 v74, s[20:23], s64 offen lds
    s_add_u32 m0, s63, 61440
    s_add_u32 s64, s66, 262144
    buffer_load_dwordx4 v74, s[20:23], s64 offen lds
    s_add_u32 m0, s63, 62464
    s_add_u32 s64, s66, 262272
    buffer_load_dwordx4 v74, s[20:23], s64 offen lds
    s_add_u32 m0, s61, 53248
    s_add_u32 s64, s101, 0
    buffer_load_dwordx4 v72, s[16:19], s64 offen lds
    s_add_u32 m0, s61, 54272
    s_add_u32 s64, s101, 8192
    buffer_load_dwordx4 v73, s[16:19], s64 offen lds
    s_add_u32 m0, s61, 55296
    s_add_u32 s64, s101, 16384
    buffer_load_dwordx4 v72, s[16:19], s64 offen lds
    s_add_u32 m0, s61, 56320
    s_add_u32 s64, s101, 24576
    buffer_load_dwordx4 v73, s[16:19], s64 offen lds
    s_add_u32 m0, s61, 57344
    s_add_u32 s64, s101, 32768
    buffer_load_dwordx4 v72, s[16:19], s64 offen lds
    s_add_u32 m0, s61, 58368
    s_add_u32 s64, s101, 40960
    buffer_load_dwordx4 v73, s[16:19], s64 offen lds
    s_add_u32 m0, s61, 59392
    s_add_u32 s64, s101, 49152
    buffer_load_dwordx4 v72, s[16:19], s64 offen lds
    s_add_u32 m0, s61, 60416
    s_add_u32 s64, s101, 57344
    buffer_load_dwordx4 v73, s[16:19], s64 offen lds
    s_add_u32 m0, s61, 61440
    s_add_u32 s64, s101, 65536
    buffer_load_dwordx4 v72, s[16:19], s64 offen lds
    s_waitcnt vmcnt(13) lgkmcnt(0)
    s_barrier
    ds_read_b64_tr_b16 a[192:193], v56 offset:0
    ds_read_b64_tr_b16 a[194:195], v56 offset:512
    ds_read_b128 v[12:15], v54 offset:0
    ds_read_b128 v[16:19], v54 offset:2048
    ds_read_b128 v[20:23], v54 offset:4096
    ds_read_b128 v[24:27], v54 offset:6144
    ds_read_b64_tr_b16 a[196:197], v57 offset:0
    ds_read_b64_tr_b16 a[198:199], v57 offset:512
    ds_read_b64_tr_b16 a[200:201], v58 offset:0
    ds_read_b64_tr_b16 a[202:203], v58 offset:512
    ds_read_b64_tr_b16 a[204:205], v59 offset:0
    ds_read_b64_tr_b16 a[206:207], v59 offset:512
    ds_read_b64_tr_b16 a[208:209], v56 offset:1024
    ds_read_b64_tr_b16 a[210:211], v56 offset:1536
    ds_read_b64_tr_b16 a[212:213], v57 offset:1024
    ds_read_b64_tr_b16 a[214:215], v57 offset:1536
    ds_read_b64_tr_b16 a[216:217], v58 offset:1024
    ds_read_b64_tr_b16 a[218:219], v58 offset:1536
    ds_read_b64_tr_b16 a[220:221], v59 offset:1024
    ds_read_b64_tr_b16 a[222:223], v59 offset:1536
    ds_read_b64_tr_b16 a[224:225], v60 offset:0
    ds_read_b64_tr_b16 a[226:227], v60 offset:512
    ds_read_b64_tr_b16 a[228:229], v61 offset:0
    ds_read_b64_tr_b16 a[230:231], v61 offset:512
    ds_read_b128 v[44:47], v52 offset:32768
    ds_read_b128 v[48:51], v52 offset:34816
    s_waitcnt lgkmcnt(15)
    v_mfma_f32_16x16x32_bf16 v[108:111], a[192:195], v[12:15], 0
    s_xor_b32 s101, s100, 2
    s_lshl_b32 s66, s101, 19
    s_add_u32 s66, s66, s62
    s_lshl_b32 s101, s101, 7
    s_add_u32 s101, s101, s60
    s_add_u32 m0, s63, 106496
    s_add_u32 s64, s66, 0
    v_accvgpr_write_b32 a0, 0
    v_accvgpr_write_b32 a1, 0
    v_mfma_f32_16x16x32_bf16 v[140:143], a[192:195], v[16:19], 0
    buffer_load_dwordx4 v74, s[20:23], s64 offen lds
    v_mfma_f32_16x16x32_bf16 v[172:175], a[192:195], v[20:23], 0
    v_accvgpr_write_b32 a2, 0
    v_accvgpr_write_b32 a3, 0
    v_mfma_f32_16x16x32_bf16 v[204:207], a[192:195], v[24:27], 0
    ds_read_b128 v[28:31], v55 offset:0
    ds_read_b128 v[32:35], v55 offset:2048
    v_mfma_f32_16x16x32_bf16 v[112:115], a[196:199], v[12:15], 0
    ds_read_b128 v[36:39], v55 offset:4096
    ds_read_b128 v[40:43], v55 offset:6144
    v_mfma_f32_16x16x32_bf16 v[144:147], a[196:199], v[16:19], 0
    s_add_u32 m0, s63, 107520
    s_add_u32 s64, s66, 128
    ds_read_b64_tr_b16 a[192:193], v56 offset:8192
    ds_read_b64_tr_b16 a[194:195], v56 offset:8704
    v_mfma_f32_16x16x32_bf16 v[176:179], a[196:199], v[20:23], 0
    buffer_load_dwordx4 v74, s[20:23], s64 offen lds
    v_mfma_f32_16x16x32_bf16 v[208:211], a[196:199], v[24:27], 0
    s_add_u32 m0, s63, 114688
    s_add_u32 s64, s66, 262144
    ds_read_b64_tr_b16 a[196:197], v57 offset:8192
    ds_read_b64_tr_b16 a[198:199], v57 offset:8704
    v_mfma_f32_16x16x32_bf16 v[116:119], a[200:203], v[12:15], 0
    buffer_load_dwordx4 v74, s[20:23], s64 offen lds
    v_mfma_f32_16x16x32_bf16 v[148:151], a[200:203], v[16:19], 0
    s_add_u32 m0, s63, 115712
    s_add_u32 s64, s66, 262272
    v_add_u32 v62, 0xd000, v52
    v_add_u32 v63, 0xd000, v53
    v_mfma_f32_16x16x32_bf16 v[180:183], a[200:203], v[20:23], 0
    buffer_load_dwordx4 v74, s[20:23], s64 offen lds
    v_mfma_f32_16x16x32_bf16 v[212:215], a[200:203], v[24:27], 0
    s_waitcnt lgkmcnt(2)
    s_add_u32 m0, s61, 106496
    s_add_u32 s64, s101, 0
    ds_read_b64_tr_b16 a[200:201], v58 offset:8192
    ds_read_b64_tr_b16 a[202:203], v58 offset:8704
    v_mfma_f32_16x16x32_bf16 v[120:123], a[204:207], v[12:15], 0
    buffer_load_dwordx4 v72, s[16:19], s64 offen lds
    v_mfma_f32_16x16x32_bf16 v[152:155], a[204:207], v[16:19], 0
    s_add_u32 m0, s61, 107520
    s_add_u32 s64, s101, 8192
    v_add_u32 v64, 0xd000, v54
    v_add_u32 v65, 0xd000, v55
    v_mfma_f32_16x16x32_bf16 v[184:187], a[204:207], v[20:23], 0
    buffer_load_dwordx4 v73, s[16:19], s64 offen lds
    v_mfma_f32_16x16x32_bf16 v[216:219], a[204:207], v[24:27], 0
    s_add_u32 m0, s61, 108544
    s_add_u32 s64, s101, 16384
    ds_read_b64_tr_b16 a[204:205], v59 offset:8192
    ds_read_b64_tr_b16 a[206:207], v59 offset:8704
    v_mfma_f32_16x16x32_bf16 v[124:127], a[208:211], v[12:15], 0
    buffer_load_dwordx4 v72, s[16:19], s64 offen lds
    v_mfma_f32_16x16x32_bf16 v[156:159], a[208:211], v[16:19], 0
    s_add_u32 m0, s61, 109568
    s_add_u32 s64, s101, 24576
    v_add_u32 v66, 0xd000, v56
    v_add_u32 v67, 0xd000, v57
    v_mfma_f32_16x16x32_bf16 v[188:191], a[208:211], v[20:23], 0
    buffer_load_dwordx4 v73, s[16:19], s64 offen lds
    v_mfma_f32_16x16x32_bf16 v[220:223], a[208:211], v[24:27], 0
    s_add_u32 m0, s61, 110592
    s_add_u32 s64, s101, 32768
    ds_read_b64_tr_b16 a[208:209], v56 offset:9216
    ds_read_b64_tr_b16 a[210:211], v56 offset:9728
    v_mfma_f32_16x16x32_bf16 v[128:131], a[212:215], v[12:15], 0
    buffer_load_dwordx4 v72, s[16:19], s64 offen lds
    v_mfma_f32_16x16x32_bf16 v[160:163], a[212:215], v[16:19], 0
    s_add_u32 m0, s61, 111616
    s_add_u32 s64, s101, 40960
    v_add_u32 v68, 0xd000, v58
    v_add_u32 v69, 0xd000, v59
    v_mfma_f32_16x16x32_bf16 v[192:195], a[212:215], v[20:23], 0
    buffer_load_dwordx4 v73, s[16:19], s64 offen lds
    v_mfma_f32_16x16x32_bf16 v[224:227], a[212:215], v[24:27], 0
    s_add_u32 m0, s61, 112640
    s_add_u32 s64, s101, 49152
    ds_read_b64_tr_b16 a[212:213], v57 offset:9216
    ds_read_b64_tr_b16 a[214:215], v57 offset:9728
    v_mfma_f32_16x16x32_bf16 v[132:135], a[216:219], v[12:15], 0
    buffer_load_dwordx4 v72, s[16:19], s64 offen lds
    v_mfma_f32_16x16x32_bf16 v[164:167], a[216:219], v[16:19], 0
    s_add_u32 m0, s61, 113664
    s_add_u32 s64, s101, 57344
    v_add_u32 v70, 0xd000, v60
    v_add_u32 v71, 0xd000, v61
    v_mfma_f32_16x16x32_bf16 v[196:199], a[216:219], v[20:23], 0
    buffer_load_dwordx4 v73, s[16:19], s64 offen lds
    v_mfma_f32_16x16x32_bf16 v[228:231], a[216:219], v[24:27], 0
    s_add_u32 m0, s61, 114688
    s_add_u32 s64, s101, 65536
    ds_read_b64_tr_b16 a[216:217], v58 offset:9216
    ds_read_b64_tr_b16 a[218:219], v58 offset:9728
    v_mfma_f32_16x16x32_bf16 v[136:139], a[220:223], v[12:15], 0
    buffer_load_dwordx4 v72, s[16:19], s64 offen lds
    v_mfma_f32_16x16x32_bf16 v[168:171], a[220:223], v[16:19], 0
    v_accvgpr_write_b32 a4, 0
    v_accvgpr_write_b32 a5, 0
    v_mfma_f32_16x16x32_bf16 v[200:203], a[220:223], v[20:23], 0
    v_accvgpr_write_b32 a6, 0
    v_accvgpr_write_b32 a7, 0
    v_mfma_f32_16x16x32_bf16 v[232:235], a[220:223], v[24:27], 0
    ds_read_b64_tr_b16 a[220:221], v59 offset:9216
    ds_read_b64_tr_b16 a[222:223], v59 offset:9728
    v_mfma_f32_16x16x32_bf16 v[236:239], a[224:227], v[44:47], 0
    v_accvgpr_write_b32 a8, 0
    v_accvgpr_write_b32 a9, 0
    v_mfma_f32_16x16x32_bf16 v[244:247], a[224:227], v[48:51], 0
    v_accvgpr_write_b32 a10, 0
    v_accvgpr_write_b32 a11, 0
    v_mfma_f32_16x16x32_bf16 v[240:243], a[228:231], v[44:47], 0
    v_accvgpr_write_b32 a12, 0
    v_accvgpr_write_b32 a13, 0
    v_mfma_f32_16x16x32_bf16 v[248:251], a[228:231], v[48:51], 0
    v_accvgpr_write_b32 a14, 0
    v_accvgpr_write_b32 a15, 0
    v_mfma_f32_16x16x32_bf16 v[108:111], a[192:195], v[28:31], v[108:111]
    ds_read_b64_tr_b16 a[224:225], v60 offset:8192
    ds_read_b64_tr_b16 a[226:227], v60 offset:8704
    v_mfma_f32_16x16x32_bf16 v[140:143], a[192:195], v[32:35], v[140:143]
    ds_read_b128 v[44:47], v53 offset:32768
    ds_read_b128 v[48:51], v53 offset:34816
    v_mfma_f32_16x16x32_bf16 v[172:175], a[192:195], v[36:39], v[172:175]
    ds_read_b64_tr_b16 a[228:229], v61 offset:8192
    ds_read_b64_tr_b16 a[230:231], v61 offset:8704
    v_mfma_f32_16x16x32_bf16 v[204:207], a[192:195], v[40:43], v[204:207]
    s_waitcnt lgkmcnt(6)
    v_accvgpr_write_b32 a16, 0
    v_accvgpr_write_b32 a17, 0
    v_mfma_f32_16x16x32_bf16 v[112:115], a[196:199], v[28:31], v[112:115]
    v_accvgpr_write_b32 a18, 0
    v_accvgpr_write_b32 a19, 0
    v_mfma_f32_16x16x32_bf16 v[144:147], a[196:199], v[32:35], v[144:147]
    v_accvgpr_write_b32 a20, 0
    v_accvgpr_write_b32 a21, 0
    v_mfma_f32_16x16x32_bf16 v[176:179], a[196:199], v[36:39], v[176:179]
    v_accvgpr_write_b32 a22, 0
    v_accvgpr_write_b32 a23, 0
    v_mfma_f32_16x16x32_bf16 v[208:211], a[196:199], v[40:43], v[208:211]
    v_accvgpr_write_b32 a24, 0
    v_accvgpr_write_b32 a25, 0
    v_mfma_f32_16x16x32_bf16 v[116:119], a[200:203], v[28:31], v[116:119]
    v_accvgpr_write_b32 a26, 0
    v_accvgpr_write_b32 a27, 0
    v_mfma_f32_16x16x32_bf16 v[148:151], a[200:203], v[32:35], v[148:151]
    s_waitcnt vmcnt(13) lgkmcnt(0)
    s_barrier
    ds_read_b128 v[12:15], v64 offset:0
    ds_read_b128 v[16:19], v64 offset:2048
    v_mfma_f32_16x16x32_bf16 v[180:183], a[200:203], v[36:39], v[180:183]
    ds_read_b128 v[20:23], v64 offset:4096
    ds_read_b128 v[24:27], v64 offset:6144
    v_mfma_f32_16x16x32_bf16 v[212:215], a[200:203], v[40:43], v[212:215]
    ds_read_b64_tr_b16 a[192:193], v66 offset:0
    ds_read_b64_tr_b16 a[194:195], v66 offset:512
    v_mfma_f32_16x16x32_bf16 v[120:123], a[204:207], v[28:31], v[120:123]
    ds_read_b64_tr_b16 a[196:197], v67 offset:0
    ds_read_b64_tr_b16 a[198:199], v67 offset:512
    v_mfma_f32_16x16x32_bf16 v[152:155], a[204:207], v[32:35], v[152:155]
    s_xor_b32 s101, s100, 3
    s_lshl_b32 s66, s101, 19
    s_add_u32 s66, s66, s62
    s_lshl_b32 s101, s101, 7
    s_add_u32 s101, s101, s60
    s_add_u32 m0, s63, 0
    s_add_u32 s64, s66, 0
    ds_read_b64_tr_b16 a[200:201], v68 offset:0
    ds_read_b64_tr_b16 a[202:203], v68 offset:512
    v_mfma_f32_16x16x32_bf16 v[184:187], a[204:207], v[36:39], v[184:187]
    buffer_load_dwordx4 v74, s[20:23], s64 offen lds
    v_mfma_f32_16x16x32_bf16 v[216:219], a[204:207], v[40:43], v[216:219]
    ds_read_b64_tr_b16 a[204:205], v69 offset:0
    ds_read_b64_tr_b16 a[206:207], v69 offset:512
    v_mfma_f32_16x16x32_bf16 v[124:127], a[208:211], v[28:31], v[124:127]
    v_accvgpr_write_b32 a28, 0
    v_accvgpr_write_b32 a29, 0
    v_mfma_f32_16x16x32_bf16 v[156:159], a[208:211], v[32:35], v[156:159]
    v_accvgpr_write_b32 a30, 0
    v_accvgpr_write_b32 a31, 0
    v_mfma_f32_16x16x32_bf16 v[188:191], a[208:211], v[36:39], v[188:191]
    v_accvgpr_write_b32 a32, 0
    v_accvgpr_write_b32 a33, 0
    v_mfma_f32_16x16x32_bf16 v[220:223], a[208:211], v[40:43], v[220:223]
    s_add_u32 m0, s63, 1024
    s_add_u32 s64, s66, 128
    ds_read_b64_tr_b16 a[208:209], v66 offset:1024
    ds_read_b64_tr_b16 a[210:211], v66 offset:1536
    v_mfma_f32_16x16x32_bf16 v[128:131], a[212:215], v[28:31], v[128:131]
    buffer_load_dwordx4 v74, s[20:23], s64 offen lds
    v_mfma_f32_16x16x32_bf16 v[160:163], a[212:215], v[32:35], v[160:163]
    v_accvgpr_write_b32 a34, 0
    v_accvgpr_write_b32 a35, 0
    v_mfma_f32_16x16x32_bf16 v[192:195], a[212:215], v[36:39], v[192:195]
    v_accvgpr_write_b32 a36, 0
    v_accvgpr_write_b32 a37, 0
    v_mfma_f32_16x16x32_bf16 v[224:227], a[212:215], v[40:43], v[224:227]
    ds_read_b64_tr_b16 a[212:213], v67 offset:1024
    ds_read_b64_tr_b16 a[214:215], v67 offset:1536
    v_mfma_f32_16x16x32_bf16 v[132:135], a[216:219], v[28:31], v[132:135]
    s_add_u32 m0, s63, 8192
    s_add_u32 s64, s66, 262144
    v_accvgpr_write_b32 a38, 0
    v_accvgpr_write_b32 a39, 0
    v_mfma_f32_16x16x32_bf16 v[164:167], a[216:219], v[32:35], v[164:167]
    buffer_load_dwordx4 v74, s[20:23], s64 offen lds
    v_mfma_f32_16x16x32_bf16 v[196:199], a[216:219], v[36:39], v[196:199]
    v_accvgpr_write_b32 a40, 0
    v_accvgpr_write_b32 a41, 0
    v_mfma_f32_16x16x32_bf16 v[228:231], a[216:219], v[40:43], v[228:231]
    ds_read_b64_tr_b16 a[216:217], v68 offset:1024
    ds_read_b64_tr_b16 a[218:219], v68 offset:1536
    v_mfma_f32_16x16x32_bf16 v[136:139], a[220:223], v[28:31], v[136:139]
    v_accvgpr_write_b32 a42, 0
    v_accvgpr_write_b32 a43, 0
    v_mfma_f32_16x16x32_bf16 v[168:171], a[220:223], v[32:35], v[168:171]
    s_add_u32 m0, s63, 9216
    s_add_u32 s64, s66, 262272
    v_accvgpr_write_b32 a44, 0
    v_accvgpr_write_b32 a45, 0
    v_mfma_f32_16x16x32_bf16 v[200:203], a[220:223], v[36:39], v[200:203]
    buffer_load_dwordx4 v74, s[20:23], s64 offen lds
    v_mfma_f32_16x16x32_bf16 v[232:235], a[220:223], v[40:43], v[232:235]
    ds_read_b64_tr_b16 a[220:221], v69 offset:1024
    ds_read_b64_tr_b16 a[222:223], v69 offset:1536
    v_mfma_f32_16x16x32_bf16 v[236:239], a[224:227], v[44:47], v[236:239]
    v_accvgpr_write_b32 a46, 0
    v_accvgpr_write_b32 a47, 0
    v_mfma_f32_16x16x32_bf16 v[244:247], a[224:227], v[48:51], v[244:247]
    v_accvgpr_write_b32 a48, 0
    v_accvgpr_write_b32 a49, 0
    v_mfma_f32_16x16x32_bf16 v[240:243], a[228:231], v[44:47], v[240:243]
    s_add_u32 m0, s61, 0
    s_add_u32 s64, s101, 0
    v_accvgpr_write_b32 a50, 0
    v_accvgpr_write_b32 a51, 0
    v_mfma_f32_16x16x32_bf16 v[248:251], a[228:231], v[48:51], v[248:251]
    s_waitcnt lgkmcnt(2)
    buffer_load_dwordx4 v72, s[16:19], s64 offen lds
    v_mfma_f32_16x16x32_bf16 v[108:111], a[192:195], v[12:15], v[108:111]
    ds_read_b64_tr_b16 a[224:225], v70 offset:0
    ds_read_b64_tr_b16 a[226:227], v70 offset:512
    v_mfma_f32_16x16x32_bf16 v[140:143], a[192:195], v[16:19], v[140:143]
    ds_read_b128 v[44:47], v62 offset:32768
    ds_read_b128 v[48:51], v62 offset:34816
    v_mfma_f32_16x16x32_bf16 v[172:175], a[192:195], v[20:23], v[172:175]
    ds_read_b64_tr_b16 a[228:229], v71 offset:0
    ds_read_b64_tr_b16 a[230:231], v71 offset:512
    v_mfma_f32_16x16x32_bf16 v[204:207], a[192:195], v[24:27], v[204:207]
    ds_read_b128 v[28:31], v65 offset:0
    ds_read_b128 v[32:35], v65 offset:2048
    v_mfma_f32_16x16x32_bf16 v[112:115], a[196:199], v[12:15], v[112:115]
    ds_read_b128 v[36:39], v65 offset:4096
    ds_read_b128 v[40:43], v65 offset:6144
    v_mfma_f32_16x16x32_bf16 v[144:147], a[196:199], v[16:19], v[144:147]
    s_add_u32 m0, s61, 1024
    s_add_u32 s64, s101, 8192
    ds_read_b64_tr_b16 a[192:193], v66 offset:8192
    ds_read_b64_tr_b16 a[194:195], v66 offset:8704
    v_mfma_f32_16x16x32_bf16 v[176:179], a[196:199], v[20:23], v[176:179]
    buffer_load_dwordx4 v73, s[16:19], s64 offen lds
    v_mfma_f32_16x16x32_bf16 v[208:211], a[196:199], v[24:27], v[208:211]
    ds_read_b64_tr_b16 a[196:197], v67 offset:8192
    ds_read_b64_tr_b16 a[198:199], v67 offset:8704
    v_mfma_f32_16x16x32_bf16 v[116:119], a[200:203], v[12:15], v[116:119]
    v_add_u32 v52, 0xd000, v62
    v_add_u32 v53, 0xd000, v63
    v_mfma_f32_16x16x32_bf16 v[148:151], a[200:203], v[16:19], v[148:151]
    v_add_u32 v54, 0xd000, v64
    v_add_u32 v55, 0xd000, v65
    v_mfma_f32_16x16x32_bf16 v[180:183], a[200:203], v[20:23], v[180:183]
    v_add_u32 v56, 0xd000, v66
    v_add_u32 v57, 0xd000, v67
    v_mfma_f32_16x16x32_bf16 v[212:215], a[200:203], v[24:27], v[212:215]
    s_add_u32 m0, s61, 2048
    s_add_u32 s64, s101, 16384
    ds_read_b64_tr_b16 a[200:201], v68 offset:8192
    ds_read_b64_tr_b16 a[202:203], v68 offset:8704
    v_mfma_f32_16x16x32_bf16 v[120:123], a[204:207], v[12:15], v[120:123]
    buffer_load_dwordx4 v72, s[16:19], s64 offen lds
    v_mfma_f32_16x16x32_bf16 v[152:155], a[204:207], v[16:19], v[152:155]
    v_add_u32 v58, 0xd000, v68
    v_add_u32 v59, 0xd000, v69
    v_mfma_f32_16x16x32_bf16 v[184:187], a[204:207], v[20:23], v[184:187]
    v_add_u32 v60, 0xd000, v70
    v_add_u32 v61, 0xd000, v71
    v_mfma_f32_16x16x32_bf16 v[216:219], a[204:207], v[24:27], v[216:219]
    ds_read_b64_tr_b16 a[204:205], v69 offset:8192
    ds_read_b64_tr_b16 a[206:207], v69 offset:8704
    v_mfma_f32_16x16x32_bf16 v[124:127], a[208:211], v[12:15], v[124:127]
    s_add_u32 m0, s61, 3072
    s_add_u32 s64, s101, 24576
    v_accvgpr_write_b32 a52, 0
    v_accvgpr_write_b32 a53, 0
    v_mfma_f32_16x16x32_bf16 v[156:159], a[208:211], v[16:19], v[156:159]
    buffer_load_dwordx4 v73, s[16:19], s64 offen lds
    v_mfma_f32_16x16x32_bf16 v[188:191], a[208:211], v[20:23], v[188:191]
    v_accvgpr_write_b32 a54, 0
    v_accvgpr_write_b32 a55, 0
    v_mfma_f32_16x16x32_bf16 v[220:223], a[208:211], v[24:27], v[220:223]
    ds_read_b64_tr_b16 a[208:209], v66 offset:9216
    ds_read_b64_tr_b16 a[210:211], v66 offset:9728
    v_mfma_f32_16x16x32_bf16 v[128:131], a[212:215], v[12:15], v[128:131]
    v_accvgpr_write_b32 a56, 0
    v_accvgpr_write_b32 a57, 0
    v_mfma_f32_16x16x32_bf16 v[160:163], a[212:215], v[16:19], v[160:163]
    s_add_u32 m0, s61, 4096
    s_add_u32 s64, s101, 32768
    v_accvgpr_write_b32 a58, 0
    v_accvgpr_write_b32 a59, 0
    v_mfma_f32_16x16x32_bf16 v[192:195], a[212:215], v[20:23], v[192:195]
    buffer_load_dwordx4 v72, s[16:19], s64 offen lds
    v_mfma_f32_16x16x32_bf16 v[224:227], a[212:215], v[24:27], v[224:227]
    ds_read_b64_tr_b16 a[212:213], v67 offset:9216
    ds_read_b64_tr_b16 a[214:215], v67 offset:9728
    v_mfma_f32_16x16x32_bf16 v[132:135], a[216:219], v[12:15], v[132:135]
    v_accvgpr_write_b32 a60, 0
    v_accvgpr_write_b32 a61, 0
    v_mfma_f32_16x16x32_bf16 v[164:167], a[216:219], v[16:19], v[164:167]
    v_accvgpr_write_b32 a62, 0
    v_accvgpr_write_b32 a63, 0
    v_mfma_f32_16x16x32_bf16 v[196:199], a[216:219], v[20:23], v[196:199]
    v_accvgpr_write_b32 a64, 0
    v_accvgpr_write_b32 a65, 0
    v_mfma_f32_16x16x32_bf16 v[228:231], a[216:219], v[24:27], v[228:231]
    s_waitcnt lgkmcnt(2)
    s_add_u32 m0, s61, 5120
    s_add_u32 s64, s101, 40960
    ds_read_b64_tr_b16 a[216:217], v68 offset:9216
    ds_read_b64_tr_b16 a[218:219], v68 offset:9728
    v_mfma_f32_16x16x32_bf16 v[136:139], a[220:223], v[12:15], v[136:139]
    buffer_load_dwordx4 v73, s[16:19], s64 offen lds
    v_mfma_f32_16x16x32_bf16 v[168:171], a[220:223], v[16:19], v[168:171]
    v_accvgpr_write_b32 a66, 0
    v_accvgpr_write_b32 a67, 0
    v_mfma_f32_16x16x32_bf16 v[200:203], a[220:223], v[20:23], v[200:203]
    v_accvgpr_write_b32 a68, 0
    v_accvgpr_write_b32 a69, 0
    v_mfma_f32_16x16x32_bf16 v[232:235], a[220:223], v[24:27], v[232:235]
    ds_read_b64_tr_b16 a[220:221], v69 offset:9216
    ds_read_b64_tr_b16 a[222:223], v69 offset:9728
    v_mfma_f32_16x16x32_bf16 v[236:239], a[224:227], v[44:47], v[236:239]
    s_add_u32 m0, s61, 6144
    s_add_u32 s64, s101, 49152
    v_accvgpr_write_b32 a70, 0
    v_accvgpr_write_b32 a71, 0
    v_mfma_f32_16x16x32_bf16 v[244:247], a[224:227], v[48:51], v[244:247]
    buffer_load_dwordx4 v72, s[16:19], s64 offen lds
    v_mfma_f32_16x16x32_bf16 v[240:243], a[228:231], v[44:47], v[240:243]
    v_accvgpr_write_b32 a72, 0
    v_accvgpr_write_b32 a73, 0
    v_mfma_f32_16x16x32_bf16 v[248:251], a[228:231], v[48:51], v[248:251]
    v_accvgpr_write_b32 a74, 0
    v_accvgpr_write_b32 a75, 0
    v_mfma_f32_16x16x32_bf16 v[108:111], a[192:195], v[28:31], v[108:111]
    ds_read_b64_tr_b16 a[224:225], v70 offset:8192
    ds_read_b64_tr_b16 a[226:227], v70 offset:8704
    v_mfma_f32_16x16x32_bf16 v[140:143], a[192:195], v[32:35], v[140:143]
    ds_read_b128 v[44:47], v63 offset:32768
    ds_read_b128 v[48:51], v63 offset:34816
    v_mfma_f32_16x16x32_bf16 v[172:175], a[192:195], v[36:39], v[172:175]
    s_add_u32 m0, s61, 7168
    s_add_u32 s64, s101, 57344
    ds_read_b64_tr_b16 a[228:229], v71 offset:8192
    ds_read_b64_tr_b16 a[230:231], v71 offset:8704
    v_mfma_f32_16x16x32_bf16 v[204:207], a[192:195], v[40:43], v[204:207]
    buffer_load_dwordx4 v73, s[16:19], s64 offen lds
    v_mfma_f32_16x16x32_bf16 v[112:115], a[196:199], v[28:31], v[112:115]
    v_accvgpr_write_b32 a76, 0
    v_accvgpr_write_b32 a77, 0
    v_mfma_f32_16x16x32_bf16 v[144:147], a[196:199], v[32:35], v[144:147]
    v_accvgpr_write_b32 a78, 0
    v_accvgpr_write_b32 a79, 0
    v_mfma_f32_16x16x32_bf16 v[176:179], a[196:199], v[36:39], v[176:179]
    v_accvgpr_write_b32 a80, 0
    v_accvgpr_write_b32 a81, 0
    v_mfma_f32_16x16x32_bf16 v[208:211], a[196:199], v[40:43], v[208:211]
    s_add_u32 m0, s61, 8192
    s_add_u32 s64, s101, 65536
    v_accvgpr_write_b32 a82, 0
    v_accvgpr_write_b32 a83, 0
    v_mfma_f32_16x16x32_bf16 v[116:119], a[200:203], v[28:31], v[116:119]
    buffer_load_dwordx4 v72, s[16:19], s64 offen lds
    v_mfma_f32_16x16x32_bf16 v[148:151], a[200:203], v[32:35], v[148:151]
    s_waitcnt vmcnt(13) lgkmcnt(0)
    s_barrier
    ds_read_b128 v[12:15], v54 offset:0
    ds_read_b128 v[16:19], v54 offset:2048
    v_mfma_f32_16x16x32_bf16 v[180:183], a[200:203], v[36:39], v[180:183]
    ds_read_b128 v[20:23], v54 offset:4096
    ds_read_b128 v[24:27], v54 offset:6144
    v_mfma_f32_16x16x32_bf16 v[212:215], a[200:203], v[40:43], v[212:215]
    ds_read_b64_tr_b16 a[192:193], v56 offset:0
    ds_read_b64_tr_b16 a[194:195], v56 offset:512
    v_mfma_f32_16x16x32_bf16 v[120:123], a[204:207], v[28:31], v[120:123]
    ds_read_b64_tr_b16 a[196:197], v57 offset:0
    ds_read_b64_tr_b16 a[198:199], v57 offset:512
    v_mfma_f32_16x16x32_bf16 v[152:155], a[204:207], v[32:35], v[152:155]
    s_xor_b32 s101, s100, 4
    s_lshl_b32 s66, s101, 19
    s_add_u32 s66, s66, s62
    s_lshl_b32 s101, s101, 7
    s_add_u32 s101, s101, s60
    s_add_u32 m0, s63, 53248
    s_add_u32 s64, s66, 0
    ds_read_b64_tr_b16 a[200:201], v58 offset:0
    ds_read_b64_tr_b16 a[202:203], v58 offset:512
    v_mfma_f32_16x16x32_bf16 v[184:187], a[204:207], v[36:39], v[184:187]
    buffer_load_dwordx4 v74, s[20:23], s64 offen lds
    v_mfma_f32_16x16x32_bf16 v[216:219], a[204:207], v[40:43], v[216:219]
    ds_read_b64_tr_b16 a[204:205], v59 offset:0
    ds_read_b64_tr_b16 a[206:207], v59 offset:512
    v_mfma_f32_16x16x32_bf16 v[124:127], a[208:211], v[28:31], v[124:127]
    v_accvgpr_write_b32 a84, 0
    v_accvgpr_write_b32 a85, 0
    v_mfma_f32_16x16x32_bf16 v[156:159], a[208:211], v[32:35], v[156:159]
    v_accvgpr_write_b32 a86, 0
    v_accvgpr_write_b32 a87, 0
    v_mfma_f32_16x16x32_bf16 v[188:191], a[208:211], v[36:39], v[188:191]
    v_accvgpr_write_b32 a88, 0
    v_accvgpr_write_b32 a89, 0
    v_mfma_f32_16x16x32_bf16 v[220:223], a[208:211], v[40:43], v[220:223]
    s_add_u32 m0, s63, 54272
    s_add_u32 s64, s66, 128
    ds_read_b64_tr_b16 a[208:209], v56 offset:1024
    ds_read_b64_tr_b16 a[210:211], v56 offset:1536
    v_mfma_f32_16x16x32_bf16 v[128:131], a[212:215], v[28:31], v[128:131]
    buffer_load_dwordx4 v74, s[20:23], s64 offen lds
    v_mfma_f32_16x16x32_bf16 v[160:163], a[212:215], v[32:35], v[160:163]
    v_accvgpr_write_b32 a90, 0
    v_accvgpr_write_b32 a91, 0
    v_mfma_f32_16x16x32_bf16 v[192:195], a[212:215], v[36:39], v[192:195]
    v_accvgpr_write_b32 a92, 0
    v_accvgpr_write_b32 a93, 0
    v_mfma_f32_16x16x32_bf16 v[224:227], a[212:215], v[40:43], v[224:227]
    ds_read_b64_tr_b16 a[212:213], v57 offset:1024
    ds_read_b64_tr_b16 a[214:215], v57 offset:1536
    v_mfma_f32_16x16x32_bf16 v[132:135], a[216:219], v[28:31], v[132:135]
    s_add_u32 m0, s63, 61440
    s_add_u32 s64, s66, 262144
    v_accvgpr_write_b32 a94, 0
    v_accvgpr_write_b32 a95, 0
    v_mfma_f32_16x16x32_bf16 v[164:167], a[216:219], v[32:35], v[164:167]
    buffer_load_dwordx4 v74, s[20:23], s64 offen lds
    v_mfma_f32_16x16x32_bf16 v[196:199], a[216:219], v[36:39], v[196:199]
    v_accvgpr_write_b32 a96, 0
    v_accvgpr_write_b32 a97, 0
    v_mfma_f32_16x16x32_bf16 v[228:231], a[216:219], v[40:43], v[228:231]
    ds_read_b64_tr_b16 a[216:217], v58 offset:1024
    ds_read_b64_tr_b16 a[218:219], v58 offset:1536
    v_mfma_f32_16x16x32_bf16 v[136:139], a[220:223], v[28:31], v[136:139]
    v_accvgpr_write_b32 a98, 0
    v_accvgpr_write_b32 a99, 0
    v_mfma_f32_16x16x32_bf16 v[168:171], a[220:223], v[32:35], v[168:171]
    s_add_u32 m0, s63, 62464
    s_add_u32 s64, s66, 262272
    v_accvgpr_write_b32 a100, 0
    v_accvgpr_write_b32 a101, 0
    v_mfma_f32_16x16x32_bf16 v[200:203], a[220:223], v[36:39], v[200:203]
    buffer_load_dwordx4 v74, s[20:23], s64 offen lds
    v_mfma_f32_16x16x32_bf16 v[232:235], a[220:223], v[40:43], v[232:235]
    ds_read_b64_tr_b16 a[220:221], v59 offset:1024
    ds_read_b64_tr_b16 a[222:223], v59 offset:1536
    v_mfma_f32_16x16x32_bf16 v[236:239], a[224:227], v[44:47], v[236:239]
    v_accvgpr_write_b32 a102, 0
    v_accvgpr_write_b32 a103, 0
    v_mfma_f32_16x16x32_bf16 v[244:247], a[224:227], v[48:51], v[244:247]
    v_accvgpr_write_b32 a104, 0
    v_accvgpr_write_b32 a105, 0
    v_mfma_f32_16x16x32_bf16 v[240:243], a[228:231], v[44:47], v[240:243]
    s_add_u32 m0, s61, 53248
    s_add_u32 s64, s101, 0
    v_accvgpr_write_b32 a106, 0
    v_accvgpr_write_b32 a107, 0
    v_mfma_f32_16x16x32_bf16 v[248:251], a[228:231], v[48:51], v[248:251]
    s_waitcnt lgkmcnt(2)
    buffer_load_dwordx4 v72, s[16:19], s64 offen lds
    v_mfma_f32_16x16x32_bf16 v[108:111], a[192:195], v[12:15], v[108:111]
    ds_read_b64_tr_b16 a[224:225], v60 offset:0
    ds_read_b64_tr_b16 a[226:227], v60 offset:512
    v_mfma_f32_16x16x32_bf16 v[140:143], a[192:195], v[16:19], v[140:143]
    ds_read_b128 v[44:47], v52 offset:32768
    ds_read_b128 v[48:51], v52 offset:34816
    v_mfma_f32_16x16x32_bf16 v[172:175], a[192:195], v[20:23], v[172:175]
    ds_read_b64_tr_b16 a[228:229], v61 offset:0
    ds_read_b64_tr_b16 a[230:231], v61 offset:512
    v_mfma_f32_16x16x32_bf16 v[204:207], a[192:195], v[24:27], v[204:207]
    ds_read_b128 v[28:31], v55 offset:0
    ds_read_b128 v[32:35], v55 offset:2048
    v_mfma_f32_16x16x32_bf16 v[112:115], a[196:199], v[12:15], v[112:115]
    ds_read_b128 v[36:39], v55 offset:4096
    ds_read_b128 v[40:43], v55 offset:6144
    v_mfma_f32_16x16x32_bf16 v[144:147], a[196:199], v[16:19], v[144:147]
    s_add_u32 m0, s61, 54272
    s_add_u32 s64, s101, 8192
    ds_read_b64_tr_b16 a[192:193], v56 offset:8192
    ds_read_b64_tr_b16 a[194:195], v56 offset:8704
    v_mfma_f32_16x16x32_bf16 v[176:179], a[196:199], v[20:23], v[176:179]
    buffer_load_dwordx4 v73, s[16:19], s64 offen lds
    v_mfma_f32_16x16x32_bf16 v[208:211], a[196:199], v[24:27], v[208:211]
    ds_read_b64_tr_b16 a[196:197], v57 offset:8192
    ds_read_b64_tr_b16 a[198:199], v57 offset:8704
    v_mfma_f32_16x16x32_bf16 v[116:119], a[200:203], v[12:15], v[116:119]
    v_add_u32 v62, 0xfffe6000, v52
    v_add_u32 v63, 0xfffe6000, v53
    v_mfma_f32_16x16x32_bf16 v[148:151], a[200:203], v[16:19], v[148:151]
    v_add_u32 v64, 0xfffe6000, v54
    v_add_u32 v65, 0xfffe6000, v55
    v_mfma_f32_16x16x32_bf16 v[180:183], a[200:203], v[20:23], v[180:183]
    v_add_u32 v66, 0xfffe6000, v56
    v_add_u32 v67, 0xfffe6000, v57
    v_mfma_f32_16x16x32_bf16 v[212:215], a[200:203], v[24:27], v[212:215]
    s_add_u32 m0, s61, 55296
    s_add_u32 s64, s101, 16384
    ds_read_b64_tr_b16 a[200:201], v58 offset:8192
    ds_read_b64_tr_b16 a[202:203], v58 offset:8704
    v_mfma_f32_16x16x32_bf16 v[120:123], a[204:207], v[12:15], v[120:123]
    buffer_load_dwordx4 v72, s[16:19], s64 offen lds
    v_mfma_f32_16x16x32_bf16 v[152:155], a[204:207], v[16:19], v[152:155]
    v_add_u32 v68, 0xfffe6000, v58
    v_add_u32 v69, 0xfffe6000, v59
    v_mfma_f32_16x16x32_bf16 v[184:187], a[204:207], v[20:23], v[184:187]
    v_add_u32 v70, 0xfffe6000, v60
    v_add_u32 v71, 0xfffe6000, v61
    v_mfma_f32_16x16x32_bf16 v[216:219], a[204:207], v[24:27], v[216:219]
    ds_read_b64_tr_b16 a[204:205], v59 offset:8192
    ds_read_b64_tr_b16 a[206:207], v59 offset:8704
    v_mfma_f32_16x16x32_bf16 v[124:127], a[208:211], v[12:15], v[124:127]
    s_add_u32 m0, s61, 56320
    s_add_u32 s64, s101, 24576
    v_accvgpr_write_b32 a108, 0
    v_accvgpr_write_b32 a109, 0
    v_mfma_f32_16x16x32_bf16 v[156:159], a[208:211], v[16:19], v[156:159]
    buffer_load_dwordx4 v73, s[16:19], s64 offen lds
    v_mfma_f32_16x16x32_bf16 v[188:191], a[208:211], v[20:23], v[188:191]
    v_accvgpr_write_b32 a110, 0
    v_accvgpr_write_b32 a111, 0
    v_mfma_f32_16x16x32_bf16 v[220:223], a[208:211], v[24:27], v[220:223]
    ds_read_b64_tr_b16 a[208:209], v56 offset:9216
    ds_read_b64_tr_b16 a[210:211], v56 offset:9728
    v_mfma_f32_16x16x32_bf16 v[128:131], a[212:215], v[12:15], v[128:131]
    v_accvgpr_write_b32 a112, 0
    v_accvgpr_write_b32 a113, 0
    v_mfma_f32_16x16x32_bf16 v[160:163], a[212:215], v[16:19], v[160:163]
    s_add_u32 m0, s61, 57344
    s_add_u32 s64, s101, 32768
    v_accvgpr_write_b32 a114, 0
    v_accvgpr_write_b32 a115, 0
    v_mfma_f32_16x16x32_bf16 v[192:195], a[212:215], v[20:23], v[192:195]
    buffer_load_dwordx4 v72, s[16:19], s64 offen lds
    v_mfma_f32_16x16x32_bf16 v[224:227], a[212:215], v[24:27], v[224:227]
    ds_read_b64_tr_b16 a[212:213], v57 offset:9216
    ds_read_b64_tr_b16 a[214:215], v57 offset:9728
    v_mfma_f32_16x16x32_bf16 v[132:135], a[216:219], v[12:15], v[132:135]
    v_accvgpr_write_b32 a116, 0
    v_accvgpr_write_b32 a117, 0
    v_mfma_f32_16x16x32_bf16 v[164:167], a[216:219], v[16:19], v[164:167]
    v_accvgpr_write_b32 a118, 0
    v_accvgpr_write_b32 a119, 0
    v_mfma_f32_16x16x32_bf16 v[196:199], a[216:219], v[20:23], v[196:199]
    v_accvgpr_write_b32 a120, 0
    v_accvgpr_write_b32 a121, 0
    v_mfma_f32_16x16x32_bf16 v[228:231], a[216:219], v[24:27], v[228:231]
    s_waitcnt lgkmcnt(2)
    s_add_u32 m0, s61, 58368
    s_add_u32 s64, s101, 40960
    ds_read_b64_tr_b16 a[216:217], v58 offset:9216
    ds_read_b64_tr_b16 a[218:219], v58 offset:9728
    v_mfma_f32_16x16x32_bf16 v[136:139], a[220:223], v[12:15], v[136:139]
    buffer_load_dwordx4 v73, s[16:19], s64 offen lds
    v_mfma_f32_16x16x32_bf16 v[168:171], a[220:223], v[16:19], v[168:171]
    v_accvgpr_write_b32 a122, 0
    v_accvgpr_write_b32 a123, 0
    v_mfma_f32_16x16x32_bf16 v[200:203], a[220:223], v[20:23], v[200:203]
    v_accvgpr_write_b32 a124, 0
    v_accvgpr_write_b32 a125, 0
    v_mfma_f32_16x16x32_bf16 v[232:235], a[220:223], v[24:27], v[232:235]
    ds_read_b64_tr_b16 a[220:221], v59 offset:9216
    ds_read_b64_tr_b16 a[222:223], v59 offset:9728
    v_mfma_f32_16x16x32_bf16 v[236:239], a[224:227], v[44:47], v[236:239]
    s_add_u32 m0, s61, 59392
    s_add_u32 s64, s101, 49152
    v_accvgpr_write_b32 a126, 0
    v_accvgpr_write_b32 a127, 0
    v_mfma_f32_16x16x32_bf16 v[244:247], a[224:227], v[48:51], v[244:247]
    buffer_load_dwordx4 v72, s[16:19], s64 offen lds
    v_mfma_f32_16x16x32_bf16 v[240:243], a[228:231], v[44:47], v[240:243]
    v_accvgpr_write_b32 a128, 0
    v_accvgpr_write_b32 a129, 0
    v_mfma_f32_16x16x32_bf16 v[248:251], a[228:231], v[48:51], v[248:251]
    v_accvgpr_write_b32 a130, 0
    v_accvgpr_write_b32 a131, 0
    v_mfma_f32_16x16x32_bf16 v[108:111], a[192:195], v[28:31], v[108:111]
    ds_read_b64_tr_b16 a[224:225], v60 offset:8192
    ds_read_b64_tr_b16 a[226:227], v60 offset:8704
    v_mfma_f32_16x16x32_bf16 v[140:143], a[192:195], v[32:35], v[140:143]
    ds_read_b128 v[44:47], v53 offset:32768
    ds_read_b128 v[48:51], v53 offset:34816
    v_mfma_f32_16x16x32_bf16 v[172:175], a[192:195], v[36:39], v[172:175]
    s_add_u32 m0, s61, 60416
    s_add_u32 s64, s101, 57344
    ds_read_b64_tr_b16 a[228:229], v61 offset:8192
    ds_read_b64_tr_b16 a[230:231], v61 offset:8704
    v_mfma_f32_16x16x32_bf16 v[204:207], a[192:195], v[40:43], v[204:207]
    buffer_load_dwordx4 v73, s[16:19], s64 offen lds
    v_mfma_f32_16x16x32_bf16 v[112:115], a[196:199], v[28:31], v[112:115]
    v_accvgpr_write_b32 a132, 0
    v_accvgpr_write_b32 a133, 0
    v_mfma_f32_16x16x32_bf16 v[144:147], a[196:199], v[32:35], v[144:147]
    v_accvgpr_write_b32 a134, 0
    v_accvgpr_write_b32 a135, 0
    v_mfma_f32_16x16x32_bf16 v[176:179], a[196:199], v[36:39], v[176:179]
    v_accvgpr_write_b32 a136, 0
    v_accvgpr_write_b32 a137, 0
    v_mfma_f32_16x16x32_bf16 v[208:211], a[196:199], v[40:43], v[208:211]
    s_add_u32 m0, s61, 61440
    s_add_u32 s64, s101, 65536
    v_accvgpr_write_b32 a138, 0
    v_accvgpr_write_b32 a139, 0
    v_mfma_f32_16x16x32_bf16 v[116:119], a[200:203], v[28:31], v[116:119]
    buffer_load_dwordx4 v72, s[16:19], s64 offen lds
    v_mfma_f32_16x16x32_bf16 v[148:151], a[200:203], v[32:35], v[148:151]
    s_waitcnt vmcnt(13) lgkmcnt(0)
    s_barrier
    ds_read_b128 v[12:15], v64 offset:0
    ds_read_b128 v[16:19], v64 offset:2048
    v_mfma_f32_16x16x32_bf16 v[180:183], a[200:203], v[36:39], v[180:183]
    ds_read_b128 v[20:23], v64 offset:4096
    ds_read_b128 v[24:27], v64 offset:6144
    v_mfma_f32_16x16x32_bf16 v[212:215], a[200:203], v[40:43], v[212:215]
    ds_read_b64_tr_b16 a[192:193], v66 offset:0
    ds_read_b64_tr_b16 a[194:195], v66 offset:512
    v_mfma_f32_16x16x32_bf16 v[120:123], a[204:207], v[28:31], v[120:123]
    ds_read_b64_tr_b16 a[196:197], v67 offset:0
    ds_read_b64_tr_b16 a[198:199], v67 offset:512
    v_mfma_f32_16x16x32_bf16 v[152:155], a[204:207], v[32:35], v[152:155]
    s_xor_b32 s101, s100, 5
    s_lshl_b32 s66, s101, 19
    s_add_u32 s66, s66, s62
    s_lshl_b32 s101, s101, 7
    s_add_u32 s101, s101, s60
    s_add_u32 m0, s63, 106496
    s_add_u32 s64, s66, 0
    ds_read_b64_tr_b16 a[200:201], v68 offset:0
    ds_read_b64_tr_b16 a[202:203], v68 offset:512
    v_mfma_f32_16x16x32_bf16 v[184:187], a[204:207], v[36:39], v[184:187]
    buffer_load_dwordx4 v74, s[20:23], s64 offen lds
    v_mfma_f32_16x16x32_bf16 v[216:219], a[204:207], v[40:43], v[216:219]
    ds_read_b64_tr_b16 a[204:205], v69 offset:0
    ds_read_b64_tr_b16 a[206:207], v69 offset:512
    v_mfma_f32_16x16x32_bf16 v[124:127], a[208:211], v[28:31], v[124:127]
    v_accvgpr_write_b32 a140, 0
    v_accvgpr_write_b32 a141, 0
    v_mfma_f32_16x16x32_bf16 v[156:159], a[208:211], v[32:35], v[156:159]
    v_accvgpr_write_b32 a142, 0
    v_accvgpr_write_b32 a143, 0
    v_mfma_f32_16x16x32_bf16 v[188:191], a[208:211], v[36:39], v[188:191]
    v_accvgpr_write_b32 a144, 0
    v_accvgpr_write_b32 a145, 0
    v_mfma_f32_16x16x32_bf16 v[220:223], a[208:211], v[40:43], v[220:223]
    s_add_u32 m0, s63, 107520
    s_add_u32 s64, s66, 128
    ds_read_b64_tr_b16 a[208:209], v66 offset:1024
    ds_read_b64_tr_b16 a[210:211], v66 offset:1536
    v_mfma_f32_16x16x32_bf16 v[128:131], a[212:215], v[28:31], v[128:131]
    buffer_load_dwordx4 v74, s[20:23], s64 offen lds
    v_mfma_f32_16x16x32_bf16 v[160:163], a[212:215], v[32:35], v[160:163]
    v_accvgpr_write_b32 a146, 0
    v_accvgpr_write_b32 a147, 0
    v_mfma_f32_16x16x32_bf16 v[192:195], a[212:215], v[36:39], v[192:195]
    v_accvgpr_write_b32 a148, 0
    v_accvgpr_write_b32 a149, 0
    v_mfma_f32_16x16x32_bf16 v[224:227], a[212:215], v[40:43], v[224:227]
    ds_read_b64_tr_b16 a[212:213], v67 offset:1024
    ds_read_b64_tr_b16 a[214:215], v67 offset:1536
    v_mfma_f32_16x16x32_bf16 v[132:135], a[216:219], v[28:31], v[132:135]
    s_add_u32 m0, s63, 114688
    s_add_u32 s64, s66, 262144
    v_accvgpr_write_b32 a150, 0
    v_accvgpr_write_b32 a151, 0
    v_mfma_f32_16x16x32_bf16 v[164:167], a[216:219], v[32:35], v[164:167]
    buffer_load_dwordx4 v74, s[20:23], s64 offen lds
    v_mfma_f32_16x16x32_bf16 v[196:199], a[216:219], v[36:39], v[196:199]
    v_accvgpr_write_b32 a152, 0
    v_accvgpr_write_b32 a153, 0
    v_mfma_f32_16x16x32_bf16 v[228:231], a[216:219], v[40:43], v[228:231]
    ds_read_b64_tr_b16 a[216:217], v68 offset:1024
    ds_read_b64_tr_b16 a[218:219], v68 offset:1536
    v_mfma_f32_16x16x32_bf16 v[136:139], a[220:223], v[28:31], v[136:139]
    v_accvgpr_write_b32 a154, 0
    v_accvgpr_write_b32 a155, 0
    v_mfma_f32_16x16x32_bf16 v[168:171], a[220:223], v[32:35], v[168:171]
    s_add_u32 m0, s63, 115712
    s_add_u32 s64, s66, 262272
    v_accvgpr_write_b32 a156, 0
    v_accvgpr_write_b32 a157, 0
    v_mfma_f32_16x16x32_bf16 v[200:203], a[220:223], v[36:39], v[200:203]
    buffer_load_dwordx4 v74, s[20:23], s64 offen lds
    v_mfma_f32_16x16x32_bf16 v[232:235], a[220:223], v[40:43], v[232:235]
    ds_read_b64_tr_b16 a[220:221], v69 offset:1024
    ds_read_b64_tr_b16 a[222:223], v69 offset:1536
    v_mfma_f32_16x16x32_bf16 v[236:239], a[224:227], v[44:47], v[236:239]
    v_accvgpr_write_b32 a158, 0
    v_accvgpr_write_b32 a159, 0
    v_mfma_f32_16x16x32_bf16 v[244:247], a[224:227], v[48:51], v[244:247]
    v_accvgpr_write_b32 a160, 0
    v_accvgpr_write_b32 a161, 0
    v_mfma_f32_16x16x32_bf16 v[240:243], a[228:231], v[44:47], v[240:243]
    s_add_u32 m0, s61, 106496
    s_add_u32 s64, s101, 0
    v_accvgpr_write_b32 a162, 0
    v_accvgpr_write_b32 a163, 0
    v_mfma_f32_16x16x32_bf16 v[248:251], a[228:231], v[48:51], v[248:251]
    s_waitcnt lgkmcnt(2)
    buffer_load_dwordx4 v72, s[16:19], s64 offen lds
    v_mfma_f32_16x16x32_bf16 v[108:111], a[192:195], v[12:15], v[108:111]
    ds_read_b64_tr_b16 a[224:225], v70 offset:0
    ds_read_b64_tr_b16 a[226:227], v70 offset:512
    v_mfma_f32_16x16x32_bf16 v[140:143], a[192:195], v[16:19], v[140:143]
    ds_read_b128 v[44:47], v62 offset:32768
    ds_read_b128 v[48:51], v62 offset:34816
    v_mfma_f32_16x16x32_bf16 v[172:175], a[192:195], v[20:23], v[172:175]
    ds_read_b64_tr_b16 a[228:229], v71 offset:0
    ds_read_b64_tr_b16 a[230:231], v71 offset:512
    v_mfma_f32_16x16x32_bf16 v[204:207], a[192:195], v[24:27], v[204:207]
    ds_read_b128 v[28:31], v65 offset:0
    ds_read_b128 v[32:35], v65 offset:2048
    v_mfma_f32_16x16x32_bf16 v[112:115], a[196:199], v[12:15], v[112:115]
    ds_read_b128 v[36:39], v65 offset:4096
    ds_read_b128 v[40:43], v65 offset:6144
    v_mfma_f32_16x16x32_bf16 v[144:147], a[196:199], v[16:19], v[144:147]
    s_add_u32 m0, s61, 107520
    s_add_u32 s64, s101, 8192
    ds_read_b64_tr_b16 a[192:193], v66 offset:8192
    ds_read_b64_tr_b16 a[194:195], v66 offset:8704
    v_mfma_f32_16x16x32_bf16 v[176:179], a[196:199], v[20:23], v[176:179]
    buffer_load_dwordx4 v73, s[16:19], s64 offen lds
    v_mfma_f32_16x16x32_bf16 v[208:211], a[196:199], v[24:27], v[208:211]
    ds_read_b64_tr_b16 a[196:197], v67 offset:8192
    ds_read_b64_tr_b16 a[198:199], v67 offset:8704
    v_mfma_f32_16x16x32_bf16 v[116:119], a[200:203], v[12:15], v[116:119]
    v_add_u32 v52, 0xd000, v62
    v_add_u32 v53, 0xd000, v63
    v_mfma_f32_16x16x32_bf16 v[148:151], a[200:203], v[16:19], v[148:151]
    v_add_u32 v54, 0xd000, v64
    v_add_u32 v55, 0xd000, v65
    v_mfma_f32_16x16x32_bf16 v[180:183], a[200:203], v[20:23], v[180:183]
    v_add_u32 v56, 0xd000, v66
    v_add_u32 v57, 0xd000, v67
    v_mfma_f32_16x16x32_bf16 v[212:215], a[200:203], v[24:27], v[212:215]
    s_add_u32 m0, s61, 108544
    s_add_u32 s64, s101, 16384
    ds_read_b64_tr_b16 a[200:201], v68 offset:8192
    ds_read_b64_tr_b16 a[202:203], v68 offset:8704
    v_mfma_f32_16x16x32_bf16 v[120:123], a[204:207], v[12:15], v[120:123]
    buffer_load_dwordx4 v72, s[16:19], s64 offen lds
    v_mfma_f32_16x16x32_bf16 v[152:155], a[204:207], v[16:19], v[152:155]
    v_add_u32 v58, 0xd000, v68
    v_add_u32 v59, 0xd000, v69
    v_mfma_f32_16x16x32_bf16 v[184:187], a[204:207], v[20:23], v[184:187]
    v_add_u32 v60, 0xd000, v70
    v_add_u32 v61, 0xd000, v71
    v_mfma_f32_16x16x32_bf16 v[216:219], a[204:207], v[24:27], v[216:219]
    ds_read_b64_tr_b16 a[204:205], v69 offset:8192
    ds_read_b64_tr_b16 a[206:207], v69 offset:8704
    v_mfma_f32_16x16x32_bf16 v[124:127], a[208:211], v[12:15], v[124:127]
    s_add_u32 m0, s61, 109568
    s_add_u32 s64, s101, 24576
    v_accvgpr_write_b32 a164, 0
    v_accvgpr_write_b32 a165, 0
    v_mfma_f32_16x16x32_bf16 v[156:159], a[208:211], v[16:19], v[156:159]
    buffer_load_dwordx4 v73, s[16:19], s64 offen lds
    v_mfma_f32_16x16x32_bf16 v[188:191], a[208:211], v[20:23], v[188:191]
    v_accvgpr_write_b32 a166, 0
    v_accvgpr_write_b32 a167, 0
    v_mfma_f32_16x16x32_bf16 v[220:223], a[208:211], v[24:27], v[220:223]
    ds_read_b64_tr_b16 a[208:209], v66 offset:9216
    ds_read_b64_tr_b16 a[210:211], v66 offset:9728
    v_mfma_f32_16x16x32_bf16 v[128:131], a[212:215], v[12:15], v[128:131]
    v_accvgpr_write_b32 a168, 0
    v_accvgpr_write_b32 a169, 0
    v_mfma_f32_16x16x32_bf16 v[160:163], a[212:215], v[16:19], v[160:163]
    s_add_u32 m0, s61, 110592
    s_add_u32 s64, s101, 32768
    v_accvgpr_write_b32 a170, 0
    v_accvgpr_write_b32 a171, 0
    v_mfma_f32_16x16x32_bf16 v[192:195], a[212:215], v[20:23], v[192:195]
    buffer_load_dwordx4 v72, s[16:19], s64 offen lds
    v_mfma_f32_16x16x32_bf16 v[224:227], a[212:215], v[24:27], v[224:227]
    ds_read_b64_tr_b16 a[212:213], v67 offset:9216
    ds_read_b64_tr_b16 a[214:215], v67 offset:9728
    v_mfma_f32_16x16x32_bf16 v[132:135], a[216:219], v[12:15], v[132:135]
    v_accvgpr_write_b32 a172, 0
    v_accvgpr_write_b32 a173, 0
    v_mfma_f32_16x16x32_bf16 v[164:167], a[216:219], v[16:19], v[164:167]
    v_accvgpr_write_b32 a174, 0
    v_accvgpr_write_b32 a175, 0
    v_mfma_f32_16x16x32_bf16 v[196:199], a[216:219], v[20:23], v[196:199]
    v_accvgpr_write_b32 a176, 0
    v_accvgpr_write_b32 a177, 0
    v_mfma_f32_16x16x32_bf16 v[228:231], a[216:219], v[24:27], v[228:231]
    s_waitcnt lgkmcnt(2)
    s_add_u32 m0, s61, 111616
    s_add_u32 s64, s101, 40960
    ds_read_b64_tr_b16 a[216:217], v68 offset:9216
    ds_read_b64_tr_b16 a[218:219], v68 offset:9728
    v_mfma_f32_16x16x32_bf16 v[136:139], a[220:223], v[12:15], v[136:139]
    buffer_load_dwordx4 v73, s[16:19], s64 offen lds
    v_mfma_f32_16x16x32_bf16 v[168:171], a[220:223], v[16:19], v[168:171]
    v_accvgpr_write_b32 a178, 0
    v_accvgpr_write_b32 a179, 0
    v_mfma_f32_16x16x32_bf16 v[200:203], a[220:223], v[20:23], v[200:203]
    v_accvgpr_write_b32 a180, 0
    v_accvgpr_write_b32 a181, 0
    v_mfma_f32_16x16x32_bf16 v[232:235], a[220:223], v[24:27], v[232:235]
    ds_read_b64_tr_b16 a[220:221], v69 offset:9216
    ds_read_b64_tr_b16 a[222:223], v69 offset:9728
    v_mfma_f32_16x16x32_bf16 v[236:239], a[224:227], v[44:47], v[236:239]
    s_add_u32 m0, s61, 112640
    s_add_u32 s64, s101, 49152
    v_accvgpr_write_b32 a182, 0
    v_accvgpr_write_b32 a183, 0
    v_mfma_f32_16x16x32_bf16 v[244:247], a[224:227], v[48:51], v[244:247]
    buffer_load_dwordx4 v72, s[16:19], s64 offen lds
    v_mfma_f32_16x16x32_bf16 v[240:243], a[228:231], v[44:47], v[240:243]
    v_accvgpr_write_b32 a184, 0
    v_accvgpr_write_b32 a185, 0
    v_mfma_f32_16x16x32_bf16 v[248:251], a[228:231], v[48:51], v[248:251]
    v_accvgpr_write_b32 a186, 0
    v_accvgpr_write_b32 a187, 0
    v_mfma_f32_16x16x32_bf16 v[108:111], a[192:195], v[28:31], v[108:111]
    ds_read_b64_tr_b16 a[224:225], v70 offset:8192
    ds_read_b64_tr_b16 a[226:227], v70 offset:8704
    v_mfma_f32_16x16x32_bf16 v[140:143], a[192:195], v[32:35], v[140:143]
    ds_read_b128 v[44:47], v63 offset:32768
    ds_read_b128 v[48:51], v63 offset:34816
    v_mfma_f32_16x16x32_bf16 v[172:175], a[192:195], v[36:39], v[172:175]
    s_add_u32 m0, s61, 113664
    s_add_u32 s64, s101, 57344
    ds_read_b64_tr_b16 a[228:229], v71 offset:8192
    ds_read_b64_tr_b16 a[230:231], v71 offset:8704
    v_mfma_f32_16x16x32_bf16 v[204:207], a[192:195], v[40:43], v[204:207]
    buffer_load_dwordx4 v73, s[16:19], s64 offen lds
    v_mfma_f32_16x16x32_bf16 v[112:115], a[196:199], v[28:31], v[112:115]
    v_accvgpr_write_b32 a188, 0
    v_accvgpr_write_b32 a189, 0
    v_mfma_f32_16x16x32_bf16 v[144:147], a[196:199], v[32:35], v[144:147]
    v_accvgpr_write_b32 a190, 0
    v_accvgpr_write_b32 a191, 0
    v_mfma_f32_16x16x32_bf16 v[176:179], a[196:199], v[36:39], v[176:179]
    v_mfma_f32_16x16x32_bf16 v[208:211], a[196:199], v[40:43], v[208:211]
    s_add_u32 m0, s61, 114688
    s_add_u32 s64, s101, 65536
    v_mfma_f32_16x16x32_bf16 v[116:119], a[200:203], v[28:31], v[116:119]
    buffer_load_dwordx4 v72, s[16:19], s64 offen lds
    v_mfma_f32_16x16x32_bf16 v[148:151], a[200:203], v[32:35], v[148:151]
    s_waitcnt vmcnt(13) lgkmcnt(0)
    s_barrier
    ds_read_b128 v[12:15], v54 offset:0
    ds_read_b128 v[16:19], v54 offset:2048
    v_mfma_f32_16x16x32_bf16 v[180:183], a[200:203], v[36:39], v[180:183]
    ds_read_b128 v[20:23], v54 offset:4096
    ds_read_b128 v[24:27], v54 offset:6144
    v_mfma_f32_16x16x32_bf16 v[212:215], a[200:203], v[40:43], v[212:215]
    ds_read_b64_tr_b16 a[192:193], v56 offset:0
    ds_read_b64_tr_b16 a[194:195], v56 offset:512
    v_mfma_f32_16x16x32_bf16 v[120:123], a[204:207], v[28:31], v[120:123]
    ds_read_b64_tr_b16 a[196:197], v57 offset:0
    ds_read_b64_tr_b16 a[198:199], v57 offset:512
    v_mfma_f32_16x16x32_bf16 v[152:155], a[204:207], v[32:35], v[152:155]
    s_xor_b32 s101, s100, 6
    s_lshl_b32 s66, s101, 19
    s_add_u32 s66, s66, s62
    s_lshl_b32 s101, s101, 7
    s_add_u32 s101, s101, s60
    s_add_u32 m0, s63, 0
    s_add_u32 s64, s66, 0
    ds_read_b64_tr_b16 a[200:201], v58 offset:0
    ds_read_b64_tr_b16 a[202:203], v58 offset:512
    v_mfma_f32_16x16x32_bf16 v[184:187], a[204:207], v[36:39], v[184:187]
    buffer_load_dwordx4 v74, s[20:23], s64 offen lds
    v_mfma_f32_16x16x32_bf16 v[216:219], a[204:207], v[40:43], v[216:219]
    ds_read_b64_tr_b16 a[204:205], v59 offset:0
    ds_read_b64_tr_b16 a[206:207], v59 offset:512
    v_mfma_f32_16x16x32_bf16 v[124:127], a[208:211], v[28:31], v[124:127]
    v_mfma_f32_16x16x32_bf16 v[156:159], a[208:211], v[32:35], v[156:159]
    v_mfma_f32_16x16x32_bf16 v[188:191], a[208:211], v[36:39], v[188:191]
    v_mfma_f32_16x16x32_bf16 v[220:223], a[208:211], v[40:43], v[220:223]
    s_add_u32 m0, s63, 1024
    s_add_u32 s64, s66, 128
    ds_read_b64_tr_b16 a[208:209], v56 offset:1024
    ds_read_b64_tr_b16 a[210:211], v56 offset:1536
    v_mfma_f32_16x16x32_bf16 v[128:131], a[212:215], v[28:31], v[128:131]
    buffer_load_dwordx4 v74, s[20:23], s64 offen lds
    v_mfma_f32_16x16x32_bf16 v[160:163], a[212:215], v[32:35], v[160:163]
    v_mfma_f32_16x16x32_bf16 v[192:195], a[212:215], v[36:39], v[192:195]
    v_mfma_f32_16x16x32_bf16 v[224:227], a[212:215], v[40:43], v[224:227]
    ds_read_b64_tr_b16 a[212:213], v57 offset:1024
    ds_read_b64_tr_b16 a[214:215], v57 offset:1536
    v_mfma_f32_16x16x32_bf16 v[132:135], a[216:219], v[28:31], v[132:135]
    s_add_u32 m0, s63, 8192
    s_add_u32 s64, s66, 262144
    v_mfma_f32_16x16x32_bf16 v[164:167], a[216:219], v[32:35], v[164:167]
    buffer_load_dwordx4 v74, s[20:23], s64 offen lds
    v_mfma_f32_16x16x32_bf16 v[196:199], a[216:219], v[36:39], v[196:199]
    v_mfma_f32_16x16x32_bf16 v[228:231], a[216:219], v[40:43], v[228:231]
    ds_read_b64_tr_b16 a[216:217], v58 offset:1024
    ds_read_b64_tr_b16 a[218:219], v58 offset:1536
    v_mfma_f32_16x16x32_bf16 v[136:139], a[220:223], v[28:31], v[136:139]
    v_mfma_f32_16x16x32_bf16 v[168:171], a[220:223], v[32:35], v[168:171]
    s_add_u32 m0, s63, 9216
    s_add_u32 s64, s66, 262272
    v_mfma_f32_16x16x32_bf16 v[200:203], a[220:223], v[36:39], v[200:203]
    buffer_load_dwordx4 v74, s[20:23], s64 offen lds
    v_mfma_f32_16x16x32_bf16 v[232:235], a[220:223], v[40:43], v[232:235]
    ds_read_b64_tr_b16 a[220:221], v59 offset:1024
    ds_read_b64_tr_b16 a[222:223], v59 offset:1536
    v_mfma_f32_16x16x32_bf16 v[236:239], a[224:227], v[44:47], v[236:239]
    v_mfma_f32_16x16x32_bf16 v[244:247], a[224:227], v[48:51], v[244:247]
    v_mfma_f32_16x16x32_bf16 v[240:243], a[228:231], v[44:47], v[240:243]
    s_add_u32 m0, s61, 0
    s_add_u32 s64, s101, 0
    v_mfma_f32_16x16x32_bf16 v[248:251], a[228:231], v[48:51], v[248:251]
    s_waitcnt lgkmcnt(2)
    buffer_load_dwordx4 v72, s[16:19], s64 offen lds
    v_mfma_f32_16x16x32_bf16 v[108:111], a[192:195], v[12:15], v[108:111]
    ds_read_b64_tr_b16 a[224:225], v60 offset:0
    ds_read_b64_tr_b16 a[226:227], v60 offset:512
    v_mfma_f32_16x16x32_bf16 v[140:143], a[192:195], v[16:19], v[140:143]
    ds_read_b128 v[44:47], v52 offset:32768
    ds_read_b128 v[48:51], v52 offset:34816
    v_mfma_f32_16x16x32_bf16 v[172:175], a[192:195], v[20:23], v[172:175]
    ds_read_b64_tr_b16 a[228:229], v61 offset:0
    ds_read_b64_tr_b16 a[230:231], v61 offset:512
    v_mfma_f32_16x16x32_bf16 v[204:207], a[192:195], v[24:27], v[204:207]
    ds_read_b128 v[28:31], v55 offset:0
    ds_read_b128 v[32:35], v55 offset:2048
    v_mfma_f32_16x16x32_bf16 v[112:115], a[196:199], v[12:15], v[112:115]
    ds_read_b128 v[36:39], v55 offset:4096
    ds_read_b128 v[40:43], v55 offset:6144
    v_mfma_f32_16x16x32_bf16 v[144:147], a[196:199], v[16:19], v[144:147]
    s_add_u32 m0, s61, 1024
    s_add_u32 s64, s101, 8192
    ds_read_b64_tr_b16 a[192:193], v56 offset:8192
    ds_read_b64_tr_b16 a[194:195], v56 offset:8704
    v_mfma_f32_16x16x32_bf16 v[176:179], a[196:199], v[20:23], v[176:179]
    buffer_load_dwordx4 v73, s[16:19], s64 offen lds
    v_mfma_f32_16x16x32_bf16 v[208:211], a[196:199], v[24:27], v[208:211]
    ds_read_b64_tr_b16 a[196:197], v57 offset:8192
    ds_read_b64_tr_b16 a[198:199], v57 offset:8704
    v_mfma_f32_16x16x32_bf16 v[116:119], a[200:203], v[12:15], v[116:119]
    v_add_u32 v62, 0xd000, v52
    v_add_u32 v63, 0xd000, v53
    v_mfma_f32_16x16x32_bf16 v[148:151], a[200:203], v[16:19], v[148:151]
    v_add_u32 v64, 0xd000, v54
    v_add_u32 v65, 0xd000, v55
    v_mfma_f32_16x16x32_bf16 v[180:183], a[200:203], v[20:23], v[180:183]
    v_add_u32 v66, 0xd000, v56
    v_add_u32 v67, 0xd000, v57
    v_mfma_f32_16x16x32_bf16 v[212:215], a[200:203], v[24:27], v[212:215]
    s_add_u32 m0, s61, 2048
    s_add_u32 s64, s101, 16384
    ds_read_b64_tr_b16 a[200:201], v58 offset:8192
    ds_read_b64_tr_b16 a[202:203], v58 offset:8704
    v_mfma_f32_16x16x32_bf16 v[120:123], a[204:207], v[12:15], v[120:123]
    buffer_load_dwordx4 v72, s[16:19], s64 offen lds
    v_mfma_f32_16x16x32_bf16 v[152:155], a[204:207], v[16:19], v[152:155]
    v_add_u32 v68, 0xd000, v58
    v_add_u32 v69, 0xd000, v59
    v_mfma_f32_16x16x32_bf16 v[184:187], a[204:207], v[20:23], v[184:187]
    v_add_u32 v70, 0xd000, v60
    v_add_u32 v71, 0xd000, v61
    v_mfma_f32_16x16x32_bf16 v[216:219], a[204:207], v[24:27], v[216:219]
    ds_read_b64_tr_b16 a[204:205], v59 offset:8192
    ds_read_b64_tr_b16 a[206:207], v59 offset:8704
    v_mfma_f32_16x16x32_bf16 v[124:127], a[208:211], v[12:15], v[124:127]
    s_add_u32 m0, s61, 3072
    s_add_u32 s64, s101, 24576
    v_mfma_f32_16x16x32_bf16 v[156:159], a[208:211], v[16:19], v[156:159]
    buffer_load_dwordx4 v73, s[16:19], s64 offen lds
    v_mfma_f32_16x16x32_bf16 v[188:191], a[208:211], v[20:23], v[188:191]
    v_mfma_f32_16x16x32_bf16 v[220:223], a[208:211], v[24:27], v[220:223]
    ds_read_b64_tr_b16 a[208:209], v56 offset:9216
    ds_read_b64_tr_b16 a[210:211], v56 offset:9728
    v_mfma_f32_16x16x32_bf16 v[128:131], a[212:215], v[12:15], v[128:131]
    v_mfma_f32_16x16x32_bf16 v[160:163], a[212:215], v[16:19], v[160:163]
    s_add_u32 m0, s61, 4096
    s_add_u32 s64, s101, 32768
    v_mfma_f32_16x16x32_bf16 v[192:195], a[212:215], v[20:23], v[192:195]
    buffer_load_dwordx4 v72, s[16:19], s64 offen lds
    v_mfma_f32_16x16x32_bf16 v[224:227], a[212:215], v[24:27], v[224:227]
    ds_read_b64_tr_b16 a[212:213], v57 offset:9216
    ds_read_b64_tr_b16 a[214:215], v57 offset:9728
    v_mfma_f32_16x16x32_bf16 v[132:135], a[216:219], v[12:15], v[132:135]
    v_mfma_f32_16x16x32_bf16 v[164:167], a[216:219], v[16:19], v[164:167]
    v_mfma_f32_16x16x32_bf16 v[196:199], a[216:219], v[20:23], v[196:199]
    v_mfma_f32_16x16x32_bf16 v[228:231], a[216:219], v[24:27], v[228:231]
    s_waitcnt lgkmcnt(2)
    s_add_u32 m0, s61, 5120
    s_add_u32 s64, s101, 40960
    ds_read_b64_tr_b16 a[216:217], v58 offset:9216
    ds_read_b64_tr_b16 a[218:219], v58 offset:9728
    v_mfma_f32_16x16x32_bf16 v[136:139], a[220:223], v[12:15], v[136:139]
    buffer_load_dwordx4 v73, s[16:19], s64 offen lds
    v_mfma_f32_16x16x32_bf16 v[168:171], a[220:223], v[16:19], v[168:171]
    v_mfma_f32_16x16x32_bf16 v[200:203], a[220:223], v[20:23], v[200:203]
    v_mfma_f32_16x16x32_bf16 v[232:235], a[220:223], v[24:27], v[232:235]
    ds_read_b64_tr_b16 a[220:221], v59 offset:9216
    ds_read_b64_tr_b16 a[222:223], v59 offset:9728
    v_mfma_f32_16x16x32_bf16 v[236:239], a[224:227], v[44:47], v[236:239]
    s_add_u32 m0, s61, 6144
    s_add_u32 s64, s101, 49152
    v_mfma_f32_16x16x32_bf16 v[244:247], a[224:227], v[48:51], v[244:247]
    buffer_load_dwordx4 v72, s[16:19], s64 offen lds
    v_mfma_f32_16x16x32_bf16 v[240:243], a[228:231], v[44:47], v[240:243]
    v_mfma_f32_16x16x32_bf16 v[248:251], a[228:231], v[48:51], v[248:251]
    v_mfma_f32_16x16x32_bf16 v[108:111], a[192:195], v[28:31], v[108:111]
    ds_read_b64_tr_b16 a[224:225], v60 offset:8192
    ds_read_b64_tr_b16 a[226:227], v60 offset:8704
    v_mfma_f32_16x16x32_bf16 v[140:143], a[192:195], v[32:35], v[140:143]
    ds_read_b128 v[44:47], v53 offset:32768
    ds_read_b128 v[48:51], v53 offset:34816
    v_mfma_f32_16x16x32_bf16 v[172:175], a[192:195], v[36:39], v[172:175]
    s_add_u32 m0, s61, 7168
    s_add_u32 s64, s101, 57344
    ds_read_b64_tr_b16 a[228:229], v61 offset:8192
    ds_read_b64_tr_b16 a[230:231], v61 offset:8704
    v_mfma_f32_16x16x32_bf16 v[204:207], a[192:195], v[40:43], v[204:207]
    buffer_load_dwordx4 v73, s[16:19], s64 offen lds
    v_mfma_f32_16x16x32_bf16 v[112:115], a[196:199], v[28:31], v[112:115]
    v_mfma_f32_16x16x32_bf16 v[144:147], a[196:199], v[32:35], v[144:147]
    v_mfma_f32_16x16x32_bf16 v[176:179], a[196:199], v[36:39], v[176:179]
    v_mfma_f32_16x16x32_bf16 v[208:211], a[196:199], v[40:43], v[208:211]
    s_add_u32 m0, s61, 8192
    s_add_u32 s64, s101, 65536
    v_mfma_f32_16x16x32_bf16 v[116:119], a[200:203], v[28:31], v[116:119]
    buffer_load_dwordx4 v72, s[16:19], s64 offen lds
    v_mfma_f32_16x16x32_bf16 v[148:151], a[200:203], v[32:35], v[148:151]
    s_waitcnt vmcnt(13) lgkmcnt(0)
    s_barrier
    ds_read_b128 v[12:15], v64 offset:0
    ds_read_b128 v[16:19], v64 offset:2048
    v_mfma_f32_16x16x32_bf16 v[180:183], a[200:203], v[36:39], v[180:183]
    ds_read_b128 v[20:23], v64 offset:4096
    ds_read_b128 v[24:27], v64 offset:6144
    v_mfma_f32_16x16x32_bf16 v[212:215], a[200:203], v[40:43], v[212:215]
    ds_read_b64_tr_b16 a[192:193], v66 offset:0
    ds_read_b64_tr_b16 a[194:195], v66 offset:512
    v_mfma_f32_16x16x32_bf16 v[120:123], a[204:207], v[28:31], v[120:123]
    ds_read_b64_tr_b16 a[196:197], v67 offset:0
    ds_read_b64_tr_b16 a[198:199], v67 offset:512
    v_mfma_f32_16x16x32_bf16 v[152:155], a[204:207], v[32:35], v[152:155]
    s_xor_b32 s101, s100, 7
    s_lshl_b32 s66, s101, 19
    s_add_u32 s66, s66, s62
    s_lshl_b32 s101, s101, 7
    s_add_u32 s101, s101, s60
    s_add_u32 m0, s63, 53248
    s_add_u32 s64, s66, 0
    ds_read_b64_tr_b16 a[200:201], v68 offset:0
    ds_read_b64_tr_b16 a[202:203], v68 offset:512
    v_mfma_f32_16x16x32_bf16 v[184:187], a[204:207], v[36:39], v[184:187]
    buffer_load_dwordx4 v74, s[20:23], s64 offen lds
    v_mfma_f32_16x16x32_bf16 v[216:219], a[204:207], v[40:43], v[216:219]
    ds_read_b64_tr_b16 a[204:205], v69 offset:0
    ds_read_b64_tr_b16 a[206:207], v69 offset:512
    v_mfma_f32_16x16x32_bf16 v[124:127], a[208:211], v[28:31], v[124:127]
    v_mfma_f32_16x16x32_bf16 v[156:159], a[208:211], v[32:35], v[156:159]
    v_mfma_f32_16x16x32_bf16 v[188:191], a[208:211], v[36:39], v[188:191]
    v_mfma_f32_16x16x32_bf16 v[220:223], a[208:211], v[40:43], v[220:223]
    s_add_u32 m0, s63, 54272
    s_add_u32 s64, s66, 128
    ds_read_b64_tr_b16 a[208:209], v66 offset:1024
    ds_read_b64_tr_b16 a[210:211], v66 offset:1536
    v_mfma_f32_16x16x32_bf16 v[128:131], a[212:215], v[28:31], v[128:131]
    buffer_load_dwordx4 v74, s[20:23], s64 offen lds
    v_mfma_f32_16x16x32_bf16 v[160:163], a[212:215], v[32:35], v[160:163]
    v_mfma_f32_16x16x32_bf16 v[192:195], a[212:215], v[36:39], v[192:195]
    v_mfma_f32_16x16x32_bf16 v[224:227], a[212:215], v[40:43], v[224:227]
    ds_read_b64_tr_b16 a[212:213], v67 offset:1024
    ds_read_b64_tr_b16 a[214:215], v67 offset:1536
    v_mfma_f32_16x16x32_bf16 v[132:135], a[216:219], v[28:31], v[132:135]
    s_add_u32 m0, s63, 61440
    s_add_u32 s64, s66, 262144
    v_mfma_f32_16x16x32_bf16 v[164:167], a[216:219], v[32:35], v[164:167]
    buffer_load_dwordx4 v74, s[20:23], s64 offen lds
    v_mfma_f32_16x16x32_bf16 v[196:199], a[216:219], v[36:39], v[196:199]
    v_mfma_f32_16x16x32_bf16 v[228:231], a[216:219], v[40:43], v[228:231]
    ds_read_b64_tr_b16 a[216:217], v68 offset:1024
    ds_read_b64_tr_b16 a[218:219], v68 offset:1536
    v_mfma_f32_16x16x32_bf16 v[136:139], a[220:223], v[28:31], v[136:139]
    v_mfma_f32_16x16x32_bf16 v[168:171], a[220:223], v[32:35], v[168:171]
    s_add_u32 m0, s63, 62464
    s_add_u32 s64, s66, 262272
    v_mfma_f32_16x16x32_bf16 v[200:203], a[220:223], v[36:39], v[200:203]
    buffer_load_dwordx4 v74, s[20:23], s64 offen lds
    v_mfma_f32_16x16x32_bf16 v[232:235], a[220:223], v[40:43], v[232:235]
    ds_read_b64_tr_b16 a[220:221], v69 offset:1024
    ds_read_b64_tr_b16 a[222:223], v69 offset:1536
    v_mfma_f32_16x16x32_bf16 v[236:239], a[224:227], v[44:47], v[236:239]
    v_mfma_f32_16x16x32_bf16 v[244:247], a[224:227], v[48:51], v[244:247]
    v_mfma_f32_16x16x32_bf16 v[240:243], a[228:231], v[44:47], v[240:243]
    s_add_u32 m0, s61, 53248
    s_add_u32 s64, s101, 0
    v_mfma_f32_16x16x32_bf16 v[248:251], a[228:231], v[48:51], v[248:251]
    s_waitcnt lgkmcnt(2)
    buffer_load_dwordx4 v72, s[16:19], s64 offen lds
    v_mfma_f32_16x16x32_bf16 v[108:111], a[192:195], v[12:15], v[108:111]
    ds_read_b64_tr_b16 a[224:225], v70 offset:0
    ds_read_b64_tr_b16 a[226:227], v70 offset:512
    v_mfma_f32_16x16x32_bf16 v[140:143], a[192:195], v[16:19], v[140:143]
    ds_read_b128 v[44:47], v62 offset:32768
    ds_read_b128 v[48:51], v62 offset:34816
    v_mfma_f32_16x16x32_bf16 v[172:175], a[192:195], v[20:23], v[172:175]
    ds_read_b64_tr_b16 a[228:229], v71 offset:0
    ds_read_b64_tr_b16 a[230:231], v71 offset:512
    v_mfma_f32_16x16x32_bf16 v[204:207], a[192:195], v[24:27], v[204:207]
    ds_read_b128 v[28:31], v65 offset:0
    ds_read_b128 v[32:35], v65 offset:2048
    v_mfma_f32_16x16x32_bf16 v[112:115], a[196:199], v[12:15], v[112:115]
    ds_read_b128 v[36:39], v65 offset:4096
    ds_read_b128 v[40:43], v65 offset:6144
    v_mfma_f32_16x16x32_bf16 v[144:147], a[196:199], v[16:19], v[144:147]
    s_add_u32 m0, s61, 54272
    s_add_u32 s64, s101, 8192
    ds_read_b64_tr_b16 a[192:193], v66 offset:8192
    ds_read_b64_tr_b16 a[194:195], v66 offset:8704
    v_mfma_f32_16x16x32_bf16 v[176:179], a[196:199], v[20:23], v[176:179]
    buffer_load_dwordx4 v73, s[16:19], s64 offen lds
    v_mfma_f32_16x16x32_bf16 v[208:211], a[196:199], v[24:27], v[208:211]
    ds_read_b64_tr_b16 a[196:197], v67 offset:8192
    ds_read_b64_tr_b16 a[198:199], v67 offset:8704
    v_mfma_f32_16x16x32_bf16 v[116:119], a[200:203], v[12:15], v[116:119]
    v_add_u32 v52, 0xfffe6000, v62
    v_add_u32 v53, 0xfffe6000, v63
    v_mfma_f32_16x16x32_bf16 v[148:151], a[200:203], v[16:19], v[148:151]
    v_add_u32 v54, 0xfffe6000, v64
    v_add_u32 v55, 0xfffe6000, v65
    v_mfma_f32_16x16x32_bf16 v[180:183], a[200:203], v[20:23], v[180:183]
    v_add_u32 v56, 0xfffe6000, v66
    v_add_u32 v57, 0xfffe6000, v67
    v_mfma_f32_16x16x32_bf16 v[212:215], a[200:203], v[24:27], v[212:215]
    s_add_u32 m0, s61, 55296
    s_add_u32 s64, s101, 16384
    ds_read_b64_tr_b16 a[200:201], v68 offset:8192
    ds_read_b64_tr_b16 a[202:203], v68 offset:8704
    v_mfma_f32_16x16x32_bf16 v[120:123], a[204:207], v[12:15], v[120:123]
    buffer_load_dwordx4 v72, s[16:19], s64 offen lds
    v_mfma_f32_16x16x32_bf16 v[152:155], a[204:207], v[16:19], v[152:155]
    v_add_u32 v58, 0xfffe6000, v68
    v_add_u32 v59, 0xfffe6000, v69
    v_mfma_f32_16x16x32_bf16 v[184:187], a[204:207], v[20:23], v[184:187]
    v_add_u32 v60, 0xfffe6000, v70
    v_add_u32 v61, 0xfffe6000, v71
    v_mfma_f32_16x16x32_bf16 v[216:219], a[204:207], v[24:27], v[216:219]
    ds_read_b64_tr_b16 a[204:205], v69 offset:8192
    ds_read_b64_tr_b16 a[206:207], v69 offset:8704
    v_mfma_f32_16x16x32_bf16 v[124:127], a[208:211], v[12:15], v[124:127]
    s_add_u32 m0, s61, 56320
    s_add_u32 s64, s101, 24576
    v_mfma_f32_16x16x32_bf16 v[156:159], a[208:211], v[16:19], v[156:159]
    buffer_load_dwordx4 v73, s[16:19], s64 offen lds
    v_mfma_f32_16x16x32_bf16 v[188:191], a[208:211], v[20:23], v[188:191]
    v_mfma_f32_16x16x32_bf16 v[220:223], a[208:211], v[24:27], v[220:223]
    ds_read_b64_tr_b16 a[208:209], v66 offset:9216
    ds_read_b64_tr_b16 a[210:211], v66 offset:9728
    v_mfma_f32_16x16x32_bf16 v[128:131], a[212:215], v[12:15], v[128:131]
    v_mfma_f32_16x16x32_bf16 v[160:163], a[212:215], v[16:19], v[160:163]
    s_add_u32 m0, s61, 57344
    s_add_u32 s64, s101, 32768
    v_mfma_f32_16x16x32_bf16 v[192:195], a[212:215], v[20:23], v[192:195]
    buffer_load_dwordx4 v72, s[16:19], s64 offen lds
    v_mfma_f32_16x16x32_bf16 v[224:227], a[212:215], v[24:27], v[224:227]
    ds_read_b64_tr_b16 a[212:213], v67 offset:9216
    ds_read_b64_tr_b16 a[214:215], v67 offset:9728
    v_mfma_f32_16x16x32_bf16 v[132:135], a[216:219], v[12:15], v[132:135]
    v_mfma_f32_16x16x32_bf16 v[164:167], a[216:219], v[16:19], v[164:167]
    v_mfma_f32_16x16x32_bf16 v[196:199], a[216:219], v[20:23], v[196:199]
    v_mfma_f32_16x16x32_bf16 v[228:231], a[216:219], v[24:27], v[228:231]
    s_waitcnt lgkmcnt(2)
    s_add_u32 m0, s61, 58368
    s_add_u32 s64, s101, 40960
    ds_read_b64_tr_b16 a[216:217], v68 offset:9216
    ds_read_b64_tr_b16 a[218:219], v68 offset:9728
    v_mfma_f32_16x16x32_bf16 v[136:139], a[220:223], v[12:15], v[136:139]
    buffer_load_dwordx4 v73, s[16:19], s64 offen lds
    v_mfma_f32_16x16x32_bf16 v[168:171], a[220:223], v[16:19], v[168:171]
    v_mfma_f32_16x16x32_bf16 v[200:203], a[220:223], v[20:23], v[200:203]
    v_mfma_f32_16x16x32_bf16 v[232:235], a[220:223], v[24:27], v[232:235]
    ds_read_b64_tr_b16 a[220:221], v69 offset:9216
    ds_read_b64_tr_b16 a[222:223], v69 offset:9728
    v_mfma_f32_16x16x32_bf16 v[236:239], a[224:227], v[44:47], v[236:239]
    s_add_u32 m0, s61, 59392
    s_add_u32 s64, s101, 49152
    v_mfma_f32_16x16x32_bf16 v[244:247], a[224:227], v[48:51], v[244:247]
    buffer_load_dwordx4 v72, s[16:19], s64 offen lds
    v_mfma_f32_16x16x32_bf16 v[240:243], a[228:231], v[44:47], v[240:243]
    v_mfma_f32_16x16x32_bf16 v[248:251], a[228:231], v[48:51], v[248:251]
    v_mfma_f32_16x16x32_bf16 v[108:111], a[192:195], v[28:31], v[108:111]
    ds_read_b64_tr_b16 a[224:225], v70 offset:8192
    ds_read_b64_tr_b16 a[226:227], v70 offset:8704
    v_mfma_f32_16x16x32_bf16 v[140:143], a[192:195], v[32:35], v[140:143]
    ds_read_b128 v[44:47], v63 offset:32768
    ds_read_b128 v[48:51], v63 offset:34816
    v_mfma_f32_16x16x32_bf16 v[172:175], a[192:195], v[36:39], v[172:175]
    s_add_u32 m0, s61, 60416
    s_add_u32 s64, s101, 57344
    ds_read_b64_tr_b16 a[228:229], v71 offset:8192
    ds_read_b64_tr_b16 a[230:231], v71 offset:8704
    v_mfma_f32_16x16x32_bf16 v[204:207], a[192:195], v[40:43], v[204:207]
    buffer_load_dwordx4 v73, s[16:19], s64 offen lds
    v_mfma_f32_16x16x32_bf16 v[112:115], a[196:199], v[28:31], v[112:115]
    v_mfma_f32_16x16x32_bf16 v[144:147], a[196:199], v[32:35], v[144:147]
    v_mfma_f32_16x16x32_bf16 v[176:179], a[196:199], v[36:39], v[176:179]
    v_mfma_f32_16x16x32_bf16 v[208:211], a[196:199], v[40:43], v[208:211]
    s_add_u32 m0, s61, 61440
    s_add_u32 s64, s101, 65536
    v_mfma_f32_16x16x32_bf16 v[116:119], a[200:203], v[28:31], v[116:119]
    buffer_load_dwordx4 v72, s[16:19], s64 offen lds
    v_mfma_f32_16x16x32_bf16 v[148:151], a[200:203], v[32:35], v[148:151]
    s_waitcnt vmcnt(13) lgkmcnt(0)
    s_barrier
    ds_read_b128 v[12:15], v54 offset:0
    ds_read_b128 v[16:19], v54 offset:2048
    v_mfma_f32_16x16x32_bf16 v[180:183], a[200:203], v[36:39], v[180:183]
    ds_read_b128 v[20:23], v54 offset:4096
    ds_read_b128 v[24:27], v54 offset:6144
    v_mfma_f32_16x16x32_bf16 v[212:215], a[200:203], v[40:43], v[212:215]
    ds_read_b64_tr_b16 a[192:193], v56 offset:0
    ds_read_b64_tr_b16 a[194:195], v56 offset:512
    v_mfma_f32_16x16x32_bf16 v[120:123], a[204:207], v[28:31], v[120:123]
    ds_read_b64_tr_b16 a[196:197], v57 offset:0
    ds_read_b64_tr_b16 a[198:199], v57 offset:512
    v_mfma_f32_16x16x32_bf16 v[152:155], a[204:207], v[32:35], v[152:155]
    s_mov_b32 m0, s68
    ds_read_b64_tr_b16 a[200:201], v58 offset:0
    ds_read_b64_tr_b16 a[202:203], v58 offset:512
    v_mfma_f32_16x16x32_bf16 v[184:187], a[204:207], v[36:39], v[184:187]
    buffer_load_dwordx4 v1, s[8:11], s48 offen nt lds
    v_mfma_f32_16x16x32_bf16 v[216:219], a[204:207], v[40:43], v[216:219]
    ds_read_b64_tr_b16 a[204:205], v59 offset:0
    ds_read_b64_tr_b16 a[206:207], v59 offset:512
    v_mfma_f32_16x16x32_bf16 v[124:127], a[208:211], v[28:31], v[124:127]
    v_mfma_f32_16x16x32_bf16 v[156:159], a[208:211], v[32:35], v[156:159]
    v_mfma_f32_16x16x32_bf16 v[188:191], a[208:211], v[36:39], v[188:191]
    v_mfma_f32_16x16x32_bf16 v[220:223], a[208:211], v[40:43], v[220:223]
    ds_read_b64_tr_b16 a[208:209], v56 offset:1024
    ds_read_b64_tr_b16 a[210:211], v56 offset:1536
    v_mfma_f32_16x16x32_bf16 v[128:131], a[212:215], v[28:31], v[128:131]
    buffer_load_dwordx4 v2, s[8:11], s48 offen offset:1024 nt lds
    v_mfma_f32_16x16x32_bf16 v[160:163], a[212:215], v[32:35], v[160:163]
    v_mfma_f32_16x16x32_bf16 v[192:195], a[212:215], v[36:39], v[192:195]
    v_mfma_f32_16x16x32_bf16 v[224:227], a[212:215], v[40:43], v[224:227]
    ds_read_b64_tr_b16 a[212:213], v57 offset:1024
    ds_read_b64_tr_b16 a[214:215], v57 offset:1536
    v_mfma_f32_16x16x32_bf16 v[132:135], a[216:219], v[28:31], v[132:135]
    v_mfma_f32_16x16x32_bf16 v[164:167], a[216:219], v[32:35], v[164:167]
    buffer_load_dwordx4 v3, s[8:11], s48 offen offset:2048 nt lds
    v_mfma_f32_16x16x32_bf16 v[196:199], a[216:219], v[36:39], v[196:199]
    v_mfma_f32_16x16x32_bf16 v[228:231], a[216:219], v[40:43], v[228:231]
    ds_read_b64_tr_b16 a[216:217], v58 offset:1024
    ds_read_b64_tr_b16 a[218:219], v58 offset:1536
    v_mfma_f32_16x16x32_bf16 v[136:139], a[220:223], v[28:31], v[136:139]
    v_mfma_f32_16x16x32_bf16 v[168:171], a[220:223], v[32:35], v[168:171]
    v_mfma_f32_16x16x32_bf16 v[200:203], a[220:223], v[36:39], v[200:203]
    buffer_load_dwordx4 v4, s[8:11], s48 offen offset:3072 nt lds
    v_mfma_f32_16x16x32_bf16 v[232:235], a[220:223], v[40:43], v[232:235]
    ds_read_b64_tr_b16 a[220:221], v59 offset:1024
    ds_read_b64_tr_b16 a[222:223], v59 offset:1536
    v_mfma_f32_16x16x32_bf16 v[236:239], a[224:227], v[44:47], v[236:239]
    v_mfma_f32_16x16x32_bf16 v[244:247], a[224:227], v[48:51], v[244:247]
    v_mfma_f32_16x16x32_bf16 v[240:243], a[228:231], v[44:47], v[240:243]
    s_add_u32 m0, s68, 4096
    v_mfma_f32_16x16x32_bf16 v[248:251], a[228:231], v[48:51], v[248:251]
    s_waitcnt lgkmcnt(2)
    buffer_load_dwordx4 v1, s[8:11], s49 offen nt lds
    v_mfma_f32_16x16x32_bf16 v[108:111], a[192:195], v[12:15], v[108:111]
    ds_read_b64_tr_b16 a[224:225], v60 offset:0
    ds_read_b64_tr_b16 a[226:227], v60 offset:512
    v_mfma_f32_16x16x32_bf16 v[140:143], a[192:195], v[16:19], v[140:143]
    ds_read_b128 v[44:47], v52 offset:32768
    ds_read_b128 v[48:51], v52 offset:34816
    v_mfma_f32_16x16x32_bf16 v[172:175], a[192:195], v[20:23], v[172:175]
    ds_read_b64_tr_b16 a[228:229], v61 offset:0
    ds_read_b64_tr_b16 a[230:231], v61 offset:512
    v_mfma_f32_16x16x32_bf16 v[204:207], a[192:195], v[24:27], v[204:207]
    ds_read_b128 v[28:31], v55 offset:0
    ds_read_b128 v[32:35], v55 offset:2048
    v_mfma_f32_16x16x32_bf16 v[112:115], a[196:199], v[12:15], v[112:115]
    ds_read_b128 v[36:39], v55 offset:4096
    ds_read_b128 v[40:43], v55 offset:6144
    v_mfma_f32_16x16x32_bf16 v[144:147], a[196:199], v[16:19], v[144:147]
    ds_read_b64_tr_b16 a[192:193], v56 offset:8192
    ds_read_b64_tr_b16 a[194:195], v56 offset:8704
    v_mfma_f32_16x16x32_bf16 v[176:179], a[196:199], v[20:23], v[176:179]
    buffer_load_dwordx4 v2, s[8:11], s49 offen offset:1024 nt lds
    v_mfma_f32_16x16x32_bf16 v[208:211], a[196:199], v[24:27], v[208:211]
    ds_read_b64_tr_b16 a[196:197], v57 offset:8192
    ds_read_b64_tr_b16 a[198:199], v57 offset:8704
    v_mfma_f32_16x16x32_bf16 v[116:119], a[200:203], v[12:15], v[116:119]
    v_add_u32 v62, 0xd000, v52
    v_add_u32 v63, 0xd000, v53
    v_mfma_f32_16x16x32_bf16 v[148:151], a[200:203], v[16:19], v[148:151]
    v_add_u32 v64, 0xd000, v54
    v_add_u32 v65, 0xd000, v55
    v_mfma_f32_16x16x32_bf16 v[180:183], a[200:203], v[20:23], v[180:183]
    v_add_u32 v66, 0xd000, v56
    v_add_u32 v67, 0xd000, v57
    v_mfma_f32_16x16x32_bf16 v[212:215], a[200:203], v[24:27], v[212:215]
    ds_read_b64_tr_b16 a[200:201], v58 offset:8192
    ds_read_b64_tr_b16 a[202:203], v58 offset:8704
    v_mfma_f32_16x16x32_bf16 v[120:123], a[204:207], v[12:15], v[120:123]
    buffer_load_dwordx4 v3, s[8:11], s49 offen offset:2048 nt lds
    v_mfma_f32_16x16x32_bf16 v[152:155], a[204:207], v[16:19], v[152:155]
    v_add_u32 v68, 0xd000, v58
    v_add_u32 v69, 0xd000, v59
    v_mfma_f32_16x16x32_bf16 v[184:187], a[204:207], v[20:23], v[184:187]
    v_add_u32 v70, 0xd000, v60
    v_add_u32 v71, 0xd000, v61
    v_mfma_f32_16x16x32_bf16 v[216:219], a[204:207], v[24:27], v[216:219]
    ds_read_b64_tr_b16 a[204:205], v59 offset:8192
    ds_read_b64_tr_b16 a[206:207], v59 offset:8704
    v_mfma_f32_16x16x32_bf16 v[124:127], a[208:211], v[12:15], v[124:127]
    v_mfma_f32_16x16x32_bf16 v[156:159], a[208:211], v[16:19], v[156:159]
    buffer_load_dwordx4 v4, s[8:11], s49 offen offset:3072 nt lds
    v_mfma_f32_16x16x32_bf16 v[188:191], a[208:211], v[20:23], v[188:191]
    v_mfma_f32_16x16x32_bf16 v[220:223], a[208:211], v[24:27], v[220:223]
    ds_read_b64_tr_b16 a[208:209], v56 offset:9216
    ds_read_b64_tr_b16 a[210:211], v56 offset:9728
    v_mfma_f32_16x16x32_bf16 v[128:131], a[212:215], v[12:15], v[128:131]
    v_mfma_f32_16x16x32_bf16 v[160:163], a[212:215], v[16:19], v[160:163]
    v_mfma_f32_16x16x32_bf16 v[192:195], a[212:215], v[20:23], v[192:195]
    v_mfma_f32_16x16x32_bf16 v[224:227], a[212:215], v[24:27], v[224:227]
    ds_read_b64_tr_b16 a[212:213], v57 offset:9216
    ds_read_b64_tr_b16 a[214:215], v57 offset:9728
    v_mfma_f32_16x16x32_bf16 v[132:135], a[216:219], v[12:15], v[132:135]
    v_mfma_f32_16x16x32_bf16 v[164:167], a[216:219], v[16:19], v[164:167]
    v_mfma_f32_16x16x32_bf16 v[196:199], a[216:219], v[20:23], v[196:199]
    v_mfma_f32_16x16x32_bf16 v[228:231], a[216:219], v[24:27], v[228:231]
    s_waitcnt lgkmcnt(2)
    ds_read_b64_tr_b16 a[216:217], v58 offset:9216
    ds_read_b64_tr_b16 a[218:219], v58 offset:9728
    v_mfma_f32_16x16x32_bf16 v[136:139], a[220:223], v[12:15], v[136:139]
    v_mfma_f32_16x16x32_bf16 v[168:171], a[220:223], v[16:19], v[168:171]
    v_mfma_f32_16x16x32_bf16 v[200:203], a[220:223], v[20:23], v[200:203]
    v_mfma_f32_16x16x32_bf16 v[232:235], a[220:223], v[24:27], v[232:235]
    ds_read_b64_tr_b16 a[220:221], v59 offset:9216
    ds_read_b64_tr_b16 a[222:223], v59 offset:9728
    v_mfma_f32_16x16x32_bf16 v[236:239], a[224:227], v[44:47], v[236:239]
    v_mfma_f32_16x16x32_bf16 v[244:247], a[224:227], v[48:51], v[244:247]
    v_mfma_f32_16x16x32_bf16 v[240:243], a[228:231], v[44:47], v[240:243]
    v_mfma_f32_16x16x32_bf16 v[248:251], a[228:231], v[48:51], v[248:251]
    v_mfma_f32_16x16x32_bf16 v[108:111], a[192:195], v[28:31], v[108:111]
    ds_read_b64_tr_b16 a[224:225], v60 offset:8192
    ds_read_b64_tr_b16 a[226:227], v60 offset:8704
    v_mfma_f32_16x16x32_bf16 v[140:143], a[192:195], v[32:35], v[140:143]
    ds_read_b128 v[44:47], v53 offset:32768
    ds_read_b128 v[48:51], v53 offset:34816
    v_mfma_f32_16x16x32_bf16 v[172:175], a[192:195], v[36:39], v[172:175]
    ds_read_b64_tr_b16 a[228:229], v61 offset:8192
    ds_read_b64_tr_b16 a[230:231], v61 offset:8704
    v_mfma_f32_16x16x32_bf16 v[204:207], a[192:195], v[40:43], v[204:207]
    v_mfma_f32_16x16x32_bf16 v[112:115], a[196:199], v[28:31], v[112:115]
    v_mfma_f32_16x16x32_bf16 v[144:147], a[196:199], v[32:35], v[144:147]
    v_mfma_f32_16x16x32_bf16 v[176:179], a[196:199], v[36:39], v[176:179]
    v_mfma_f32_16x16x32_bf16 v[208:211], a[196:199], v[40:43], v[208:211]
    v_mfma_f32_16x16x32_bf16 v[116:119], a[200:203], v[28:31], v[116:119]
    v_mfma_f32_16x16x32_bf16 v[148:151], a[200:203], v[32:35], v[148:151]
    s_waitcnt vmcnt(8) lgkmcnt(0)
    s_barrier
    ds_read_b128 v[12:15], v64 offset:0
    ds_read_b128 v[16:19], v64 offset:2048
    v_mfma_f32_16x16x32_bf16 v[180:183], a[200:203], v[36:39], v[180:183]
    ds_read_b128 v[20:23], v64 offset:4096
    ds_read_b128 v[24:27], v64 offset:6144
    v_mfma_f32_16x16x32_bf16 v[212:215], a[200:203], v[40:43], v[212:215]
    ds_read_b64_tr_b16 a[192:193], v66 offset:0
    ds_read_b64_tr_b16 a[194:195], v66 offset:512
    v_mfma_f32_16x16x32_bf16 v[120:123], a[204:207], v[28:31], v[120:123]
    ds_read_b64_tr_b16 a[196:197], v67 offset:0
    ds_read_b64_tr_b16 a[198:199], v67 offset:512
    v_mfma_f32_16x16x32_bf16 v[152:155], a[204:207], v[32:35], v[152:155]
    s_mov_b32 m0, s54
    ds_read_b64_tr_b16 a[200:201], v68 offset:0
    ds_read_b64_tr_b16 a[202:203], v68 offset:512
    v_mfma_f32_16x16x32_bf16 v[184:187], a[204:207], v[36:39], v[184:187]
    buffer_load_dwordx4 v5, s[12:15], s50 offen nt lds
    v_mfma_f32_16x16x32_bf16 v[216:219], a[204:207], v[40:43], v[216:219]
    ds_read_b64_tr_b16 a[204:205], v69 offset:0
    ds_read_b64_tr_b16 a[206:207], v69 offset:512
    v_mfma_f32_16x16x32_bf16 v[124:127], a[208:211], v[28:31], v[124:127]
    v_mfma_f32_16x16x32_bf16 v[156:159], a[208:211], v[32:35], v[156:159]
    v_mfma_f32_16x16x32_bf16 v[188:191], a[208:211], v[36:39], v[188:191]
    v_mfma_f32_16x16x32_bf16 v[220:223], a[208:211], v[40:43], v[220:223]
    ds_read_b64_tr_b16 a[208:209], v66 offset:1024
    ds_read_b64_tr_b16 a[210:211], v66 offset:1536
    v_mfma_f32_16x16x32_bf16 v[128:131], a[212:215], v[28:31], v[128:131]
    buffer_load_dwordx4 v6, s[12:15], s50 offen offset:1024 nt lds
    v_mfma_f32_16x16x32_bf16 v[160:163], a[212:215], v[32:35], v[160:163]
    v_mfma_f32_16x16x32_bf16 v[192:195], a[212:215], v[36:39], v[192:195]
    v_mfma_f32_16x16x32_bf16 v[224:227], a[212:215], v[40:43], v[224:227]
    ds_read_b64_tr_b16 a[212:213], v67 offset:1024
    ds_read_b64_tr_b16 a[214:215], v67 offset:1536
    v_mfma_f32_16x16x32_bf16 v[132:135], a[216:219], v[28:31], v[132:135]
    v_mfma_f32_16x16x32_bf16 v[164:167], a[216:219], v[32:35], v[164:167]
    buffer_load_dwordx4 v7, s[12:15], s50 offen offset:2048 nt lds
    v_mfma_f32_16x16x32_bf16 v[196:199], a[216:219], v[36:39], v[196:199]
    v_mfma_f32_16x16x32_bf16 v[228:231], a[216:219], v[40:43], v[228:231]
    ds_read_b64_tr_b16 a[216:217], v68 offset:1024
    ds_read_b64_tr_b16 a[218:219], v68 offset:1536
    v_mfma_f32_16x16x32_bf16 v[136:139], a[220:223], v[28:31], v[136:139]
    v_mfma_f32_16x16x32_bf16 v[168:171], a[220:223], v[32:35], v[168:171]
    v_mfma_f32_16x16x32_bf16 v[200:203], a[220:223], v[36:39], v[200:203]
    buffer_load_dwordx4 v8, s[12:15], s50 offen offset:3072 nt lds
    v_mfma_f32_16x16x32_bf16 v[232:235], a[220:223], v[40:43], v[232:235]
    ds_read_b64_tr_b16 a[220:221], v69 offset:1024
    ds_read_b64_tr_b16 a[222:223], v69 offset:1536
    v_mfma_f32_16x16x32_bf16 v[236:239], a[224:227], v[44:47], v[236:239]
    v_mfma_f32_16x16x32_bf16 v[244:247], a[224:227], v[48:51], v[244:247]
    v_mfma_f32_16x16x32_bf16 v[240:243], a[228:231], v[44:47], v[240:243]
    s_mov_b32 m0, s55
    v_mfma_f32_16x16x32_bf16 v[248:251], a[228:231], v[48:51], v[248:251]
    s_waitcnt lgkmcnt(2)
    buffer_load_dwordx4 v5, s[12:15], s51 offen nt lds
    v_mfma_f32_16x16x32_bf16 v[108:111], a[192:195], v[12:15], v[108:111]
    ds_read_b64_tr_b16 a[224:225], v70 offset:0
    ds_read_b64_tr_b16 a[226:227], v70 offset:512
    v_mfma_f32_16x16x32_bf16 v[140:143], a[192:195], v[16:19], v[140:143]
    ds_read_b128 v[44:47], v62 offset:32768
    ds_read_b128 v[48:51], v62 offset:34816
    v_mfma_f32_16x16x32_bf16 v[172:175], a[192:195], v[20:23], v[172:175]
    ds_read_b64_tr_b16 a[228:229], v71 offset:0
    ds_read_b64_tr_b16 a[230:231], v71 offset:512
    v_mfma_f32_16x16x32_bf16 v[204:207], a[192:195], v[24:27], v[204:207]
    ds_read_b128 v[28:31], v65 offset:0
    ds_read_b128 v[32:35], v65 offset:2048
    v_mfma_f32_16x16x32_bf16 v[112:115], a[196:199], v[12:15], v[112:115]
    ds_read_b128 v[36:39], v65 offset:4096
    ds_read_b128 v[40:43], v65 offset:6144
    v_mfma_f32_16x16x32_bf16 v[144:147], a[196:199], v[16:19], v[144:147]
    ds_read_b64_tr_b16 a[192:193], v66 offset:8192
    ds_read_b64_tr_b16 a[194:195], v66 offset:8704
    v_mfma_f32_16x16x32_bf16 v[176:179], a[196:199], v[20:23], v[176:179]
    buffer_load_dwordx4 v6, s[12:15], s51 offen offset:1024 nt lds
    v_mfma_f32_16x16x32_bf16 v[208:211], a[196:199], v[24:27], v[208:211]
    ds_read_b64_tr_b16 a[196:197], v67 offset:8192
    ds_read_b64_tr_b16 a[198:199], v67 offset:8704
    v_mfma_f32_16x16x32_bf16 v[116:119], a[200:203], v[12:15], v[116:119]
    v_mfma_f32_16x16x32_bf16 v[148:151], a[200:203], v[16:19], v[148:151]
    v_mfma_f32_16x16x32_bf16 v[180:183], a[200:203], v[20:23], v[180:183]
    v_mfma_f32_16x16x32_bf16 v[212:215], a[200:203], v[24:27], v[212:215]
    ds_read_b64_tr_b16 a[200:201], v68 offset:8192
    ds_read_b64_tr_b16 a[202:203], v68 offset:8704
    v_mfma_f32_16x16x32_bf16 v[120:123], a[204:207], v[12:15], v[120:123]
    buffer_load_dwordx4 v7, s[12:15], s51 offen offset:2048 nt lds
    v_mfma_f32_16x16x32_bf16 v[152:155], a[204:207], v[16:19], v[152:155]
    v_mfma_f32_16x16x32_bf16 v[184:187], a[204:207], v[20:23], v[184:187]
    v_mfma_f32_16x16x32_bf16 v[216:219], a[204:207], v[24:27], v[216:219]
    ds_read_b64_tr_b16 a[204:205], v69 offset:8192
    ds_read_b64_tr_b16 a[206:207], v69 offset:8704
    v_mfma_f32_16x16x32_bf16 v[124:127], a[208:211], v[12:15], v[124:127]
    v_mfma_f32_16x16x32_bf16 v[156:159], a[208:211], v[16:19], v[156:159]
    buffer_load_dwordx4 v8, s[12:15], s51 offen offset:3072 nt lds
    v_mfma_f32_16x16x32_bf16 v[188:191], a[208:211], v[20:23], v[188:191]
    v_mfma_f32_16x16x32_bf16 v[220:223], a[208:211], v[24:27], v[220:223]
    ds_read_b64_tr_b16 a[208:209], v66 offset:9216
    ds_read_b64_tr_b16 a[210:211], v66 offset:9728
    v_mfma_f32_16x16x32_bf16 v[128:131], a[212:215], v[12:15], v[128:131]
    v_mfma_f32_16x16x32_bf16 v[160:163], a[212:215], v[16:19], v[160:163]
    v_mfma_f32_16x16x32_bf16 v[192:195], a[212:215], v[20:23], v[192:195]
    v_mfma_f32_16x16x32_bf16 v[224:227], a[212:215], v[24:27], v[224:227]
    ds_read_b64_tr_b16 a[212:213], v67 offset:9216
    ds_read_b64_tr_b16 a[214:215], v67 offset:9728
    v_mfma_f32_16x16x32_bf16 v[132:135], a[216:219], v[12:15], v[132:135]
    v_mfma_f32_16x16x32_bf16 v[164:167], a[216:219], v[16:19], v[164:167]
    v_mfma_f32_16x16x32_bf16 v[196:199], a[216:219], v[20:23], v[196:199]
    v_mfma_f32_16x16x32_bf16 v[228:231], a[216:219], v[24:27], v[228:231]
    s_waitcnt lgkmcnt(2)
    ds_read_b64_tr_b16 a[216:217], v68 offset:9216
    ds_read_b64_tr_b16 a[218:219], v68 offset:9728
    v_mfma_f32_16x16x32_bf16 v[136:139], a[220:223], v[12:15], v[136:139]
    v_mfma_f32_16x16x32_bf16 v[168:171], a[220:223], v[16:19], v[168:171]
    v_mfma_f32_16x16x32_bf16 v[200:203], a[220:223], v[20:23], v[200:203]
    v_mfma_f32_16x16x32_bf16 v[232:235], a[220:223], v[24:27], v[232:235]
    ds_read_b64_tr_b16 a[220:221], v69 offset:9216
    ds_read_b64_tr_b16 a[222:223], v69 offset:9728
    v_mfma_f32_16x16x32_bf16 v[236:239], a[224:227], v[44:47], v[236:239]
    v_mfma_f32_16x16x32_bf16 v[244:247], a[224:227], v[48:51], v[244:247]
    v_mfma_f32_16x16x32_bf16 v[240:243], a[228:231], v[44:47], v[240:243]
    v_mfma_f32_16x16x32_bf16 v[248:251], a[228:231], v[48:51], v[248:251]
    v_mfma_f32_16x16x32_bf16 v[108:111], a[192:195], v[28:31], v[108:111]
    ds_read_b64_tr_b16 a[224:225], v70 offset:8192
    ds_read_b64_tr_b16 a[226:227], v70 offset:8704
    v_mfma_f32_16x16x32_bf16 v[140:143], a[192:195], v[32:35], v[140:143]
    ds_read_b128 v[44:47], v63 offset:32768
    ds_read_b128 v[48:51], v63 offset:34816
    v_mfma_f32_16x16x32_bf16 v[172:175], a[192:195], v[36:39], v[172:175]
    ds_read_b64_tr_b16 a[228:229], v71 offset:8192
    ds_read_b64_tr_b16 a[230:231], v71 offset:8704
    v_mfma_f32_16x16x32_bf16 v[204:207], a[192:195], v[40:43], v[204:207]
    v_mfma_f32_16x16x32_bf16 v[112:115], a[196:199], v[28:31], v[112:115]
    v_mfma_f32_16x16x32_bf16 v[144:147], a[196:199], v[32:35], v[144:147]
    v_mfma_f32_16x16x32_bf16 v[176:179], a[196:199], v[36:39], v[176:179]
    v_mfma_f32_16x16x32_bf16 v[208:211], a[196:199], v[40:43], v[208:211]
    v_mfma_f32_16x16x32_bf16 v[116:119], a[200:203], v[28:31], v[116:119]
    v_mfma_f32_16x16x32_bf16 v[148:151], a[200:203], v[32:35], v[148:151]
    s_waitcnt lgkmcnt(0)
    s_barrier
    v_mfma_f32_16x16x32_bf16 v[180:183], a[200:203], v[36:39], v[180:183]
    v_mfma_f32_16x16x32_bf16 v[212:215], a[200:203], v[40:43], v[212:215]
    v_mfma_f32_16x16x32_bf16 v[120:123], a[204:207], v[28:31], v[120:123]
    v_mfma_f32_16x16x32_bf16 v[152:155], a[204:207], v[32:35], v[152:155]
    v_mfma_f32_16x16x32_bf16 v[184:187], a[204:207], v[36:39], v[184:187]
    v_mfma_f32_16x16x32_bf16 v[216:219], a[204:207], v[40:43], v[216:219]
    v_mfma_f32_16x16x32_bf16 v[124:127], a[208:211], v[28:31], v[124:127]
    v_mfma_f32_16x16x32_bf16 v[156:159], a[208:211], v[32:35], v[156:159]
    v_mfma_f32_16x16x32_bf16 v[188:191], a[208:211], v[36:39], v[188:191]
    v_mfma_f32_16x16x32_bf16 v[220:223], a[208:211], v[40:43], v[220:223]
    v_mfma_f32_16x16x32_bf16 v[128:131], a[212:215], v[28:31], v[128:131]
    v_mfma_f32_16x16x32_bf16 v[160:163], a[212:215], v[32:35], v[160:163]
    v_mfma_f32_16x16x32_bf16 v[192:195], a[212:215], v[36:39], v[192:195]
    v_mfma_f32_16x16x32_bf16 v[224:227], a[212:215], v[40:43], v[224:227]
    v_mfma_f32_16x16x32_bf16 v[132:135], a[216:219], v[28:31], v[132:135]
    v_mfma_f32_16x16x32_bf16 v[164:167], a[216:219], v[32:35], v[164:167]
    v_mfma_f32_16x16x32_bf16 v[196:199], a[216:219], v[36:39], v[196:199]
    v_mfma_f32_16x16x32_bf16 v[228:231], a[216:219], v[40:43], v[228:231]
    v_mfma_f32_16x16x32_bf16 v[136:139], a[220:223], v[28:31], v[136:139]
    v_mfma_f32_16x16x32_bf16 v[168:171], a[220:223], v[32:35], v[168:171]
    v_mfma_f32_16x16x32_bf16 v[200:203], a[220:223], v[36:39], v[200:203]
    v_mfma_f32_16x16x32_bf16 v[232:235], a[220:223], v[40:43], v[232:235]
    v_mfma_f32_16x16x32_bf16 v[236:239], a[224:227], v[44:47], v[236:239]
    v_mfma_f32_16x16x32_bf16 v[244:247], a[224:227], v[48:51], v[244:247]
    v_mfma_f32_16x16x32_bf16 v[240:243], a[228:231], v[44:47], v[240:243]
    v_mfma_f32_16x16x32_bf16 v[248:251], a[228:231], v[48:51], v[248:251]
    v_pk_mul_f32 v[108:109], v[108:109], v[252:253]
    v_pk_mul_f32 v[110:111], v[110:111], v[252:253]
    v_pk_mul_f32 v[112:113], v[112:113], v[252:253]
    v_pk_mul_f32 v[114:115], v[114:115], v[252:253]
    v_cvt_pk_bf16_f32 v12, v108, v109
    v_cvt_pk_bf16_f32 v13, v110, v111
    v_cvt_pk_bf16_f32 v14, v112, v113
    v_cvt_pk_bf16_f32 v15, v114, v115
    v_pk_mul_f32 v[140:141], v[140:141], v[252:253]
    v_pk_mul_f32 v[142:143], v[142:143], v[252:253]
    v_permlane32_swap_b32 v12, v14
    v_permlane32_swap_b32 v13, v15
    v_pk_mul_f32 v[144:145], v[144:145], v[252:253]
    v_pk_mul_f32 v[146:147], v[146:147], v[252:253]
    v_permlane16_swap_b32 v12, v14
    v_permlane16_swap_b32 v13, v15
    v_cvt_pk_bf16_f32 v28, v140, v141
    v_cvt_pk_bf16_f32 v29, v142, v143
    v_cvt_pk_bf16_f32 v30, v144, v145
    v_cvt_pk_bf16_f32 v31, v146, v147
    v_pk_mul_f32 v[236:237], v[236:237], v[252:253]
    v_pk_mul_f32 v[238:239], v[238:239], v[252:253]
    v_permlane32_swap_b32 v28, v30
    v_permlane32_swap_b32 v29, v31
    v_pk_mul_f32 v[240:241], v[240:241], v[252:253]
    v_pk_mul_f32 v[242:243], v[242:243], v[252:253]
    v_permlane16_swap_b32 v28, v30
    v_permlane16_swap_b32 v29, v31
    v_cvt_pk_bf16_f32 v76, v236, v237
    v_cvt_pk_bf16_f32 v77, v238, v239
    v_cvt_pk_bf16_f32 v78, v240, v241
    v_cvt_pk_bf16_f32 v79, v242, v243
    s_add_u32 s48, s48, s52
    s_add_u32 s49, s49, s52
    s_and_b32 s48, s48, s32
    s_and_b32 s49, s49, s32
    s_add_u32 s68, s91, 98304
    s_mov_b32 m0, s68
    s_nop 0
    buffer_load_dwordx4 v1, s[8:11], s48 offen nt lds
    v_pk_mul_f32 v[244:245], v[244:245], v[252:253]
    v_pk_mul_f32 v[246:247], v[246:247], v[252:253]
    v_permlane32_swap_b32 v76, v78
    v_permlane32_swap_b32 v77, v79
    v_pk_mul_f32 v[248:249], v[248:249], v[252:253]
    v_pk_mul_f32 v[250:251], v[250:251], v[252:253]
    v_permlane16_swap_b32 v76, v78
    v_permlane16_swap_b32 v77, v79
    v_cvt_pk_bf16_f32 v80, v244, v245
    v_cvt_pk_bf16_f32 v81, v246, v247
    v_cvt_pk_bf16_f32 v82, v248, v249
    v_cvt_pk_bf16_f32 v83, v250, v251
    v_pk_mul_f32 v[172:173], v[172:173], v[252:253]
    v_pk_mul_f32 v[174:175], v[174:175], v[252:253]
    v_permlane32_swap_b32 v80, v82
    v_permlane32_swap_b32 v81, v83
    v_pk_mul_f32 v[176:177], v[176:177], v[252:253]
    v_pk_mul_f32 v[178:179], v[178:179], v[252:253]
    v_permlane16_swap_b32 v80, v82
    v_permlane16_swap_b32 v81, v83
    v_cvt_pk_bf16_f32 v44, v172, v173
    v_cvt_pk_bf16_f32 v45, v174, v175
    v_cvt_pk_bf16_f32 v46, v176, v177
    v_cvt_pk_bf16_f32 v47, v178, v179
    buffer_load_dwordx4 v2, s[8:11], s48 offen offset:1024 nt lds
    v_lshlrev_b32 v10, 4, v0
    s_lshl_b32 s6, s3, 10
    s_add_u32 s6, s6, 65536
    v_add_u32 v11, s6, v10
    v_add_u32 v10, 65536, v10
    ds_write_b128 v11, v[76:79]
    ds_write_b128 v11, v[80:83] offset:4096
    v_pk_mul_f32 v[204:205], v[204:205], v[252:253]
    v_pk_mul_f32 v[206:207], v[206:207], v[252:253]
    v_permlane32_swap_b32 v44, v46
    v_permlane32_swap_b32 v45, v47
    v_pk_mul_f32 v[208:209], v[208:209], v[252:253]
    v_pk_mul_f32 v[210:211], v[210:211], v[252:253]
    v_permlane16_swap_b32 v44, v46
    v_permlane16_swap_b32 v45, v47
    v_cvt_pk_bf16_f32 v60, v204, v205
    v_cvt_pk_bf16_f32 v61, v206, v207
    v_cvt_pk_bf16_f32 v62, v208, v209
    v_cvt_pk_bf16_f32 v63, v210, v211
    v_pk_mul_f32 v[116:117], v[116:117], v[252:253]
    v_pk_mul_f32 v[118:119], v[118:119], v[252:253]
    v_permlane32_swap_b32 v60, v62
    v_permlane32_swap_b32 v61, v63
    v_pk_mul_f32 v[120:121], v[120:121], v[252:253]
    v_pk_mul_f32 v[122:123], v[122:123], v[252:253]
    v_permlane16_swap_b32 v60, v62
    v_permlane16_swap_b32 v61, v63
    v_cvt_pk_bf16_f32 v16, v116, v117
    v_cvt_pk_bf16_f32 v17, v118, v119
    v_cvt_pk_bf16_f32 v18, v120, v121
    v_cvt_pk_bf16_f32 v19, v122, v123
    buffer_load_dwordx4 v3, s[8:11], s48 offen offset:2048 nt lds
    v_pk_mul_f32 v[148:149], v[148:149], v[252:253]
    v_pk_mul_f32 v[150:151], v[150:151], v[252:253]
    v_permlane32_swap_b32 v16, v18
    v_permlane32_swap_b32 v17, v19
    v_pk_mul_f32 v[152:153], v[152:153], v[252:253]
    v_pk_mul_f32 v[154:155], v[154:155], v[252:253]
    v_permlane16_swap_b32 v16, v18
    v_permlane16_swap_b32 v17, v19
    v_cvt_pk_bf16_f32 v32, v148, v149
    v_cvt_pk_bf16_f32 v33, v150, v151
    v_cvt_pk_bf16_f32 v34, v152, v153
    v_cvt_pk_bf16_f32 v35, v154, v155
    v_pk_mul_f32 v[180:181], v[180:181], v[252:253]
    v_pk_mul_f32 v[182:183], v[182:183], v[252:253]
    v_permlane32_swap_b32 v32, v34
    v_permlane32_swap_b32 v33, v35
    v_pk_mul_f32 v[184:185], v[184:185], v[252:253]
    v_pk_mul_f32 v[186:187], v[186:187], v[252:253]
    v_permlane16_swap_b32 v32, v34
    v_permlane16_swap_b32 v33, v35
    v_cvt_pk_bf16_f32 v48, v180, v181
    v_cvt_pk_bf16_f32 v49, v182, v183
    v_cvt_pk_bf16_f32 v50, v184, v185
    v_cvt_pk_bf16_f32 v51, v186, v187
    buffer_load_dwordx4 v4, s[8:11], s48 offen offset:3072 nt lds
    v_pk_mul_f32 v[212:213], v[212:213], v[252:253]
    v_pk_mul_f32 v[214:215], v[214:215], v[252:253]
    v_permlane32_swap_b32 v48, v50
    v_permlane32_swap_b32 v49, v51
    v_pk_mul_f32 v[216:217], v[216:217], v[252:253]
    v_pk_mul_f32 v[218:219], v[218:219], v[252:253]
    v_permlane16_swap_b32 v48, v50
    v_permlane16_swap_b32 v49, v51
    v_cvt_pk_bf16_f32 v64, v212, v213
    v_cvt_pk_bf16_f32 v65, v214, v215
    v_cvt_pk_bf16_f32 v66, v216, v217
    v_cvt_pk_bf16_f32 v67, v218, v219
    v_pk_mul_f32 v[124:125], v[124:125], v[252:253]
    v_pk_mul_f32 v[126:127], v[126:127], v[252:253]
    v_permlane32_swap_b32 v64, v66
    v_permlane32_swap_b32 v65, v67
    v_pk_mul_f32 v[128:129], v[128:129], v[252:253]
    v_pk_mul_f32 v[130:131], v[130:131], v[252:253]
    v_permlane16_swap_b32 v64, v66
    v_permlane16_swap_b32 v65, v67
    v_cvt_pk_bf16_f32 v20, v124, v125
    v_cvt_pk_bf16_f32 v21, v126, v127
    v_cvt_pk_bf16_f32 v22, v128, v129
    v_cvt_pk_bf16_f32 v23, v130, v131
    s_add_u32 m0, s68, 4096
    s_nop 0
    buffer_load_dwordx4 v1, s[8:11], s49 offen nt lds
    v_pk_mul_f32 v[156:157], v[156:157], v[252:253]
    v_pk_mul_f32 v[158:159], v[158:159], v[252:253]
    v_permlane32_swap_b32 v20, v22
    v_permlane32_swap_b32 v21, v23
    v_pk_mul_f32 v[160:161], v[160:161], v[252:253]
    v_pk_mul_f32 v[162:163], v[162:163], v[252:253]
    v_permlane16_swap_b32 v20, v22
    v_permlane16_swap_b32 v21, v23
    v_cvt_pk_bf16_f32 v36, v156, v157
    v_cvt_pk_bf16_f32 v37, v158, v159
    v_cvt_pk_bf16_f32 v38, v160, v161
    v_cvt_pk_bf16_f32 v39, v162, v163
    v_pk_mul_f32 v[188:189], v[188:189], v[252:253]
    v_pk_mul_f32 v[190:191], v[190:191], v[252:253]
    v_permlane32_swap_b32 v36, v38
    v_permlane32_swap_b32 v37, v39
    v_pk_mul_f32 v[192:193], v[192:193], v[252:253]
    v_pk_mul_f32 v[194:195], v[194:195], v[252:253]
    v_permlane16_swap_b32 v36, v38
    v_permlane16_swap_b32 v37, v39
    v_cvt_pk_bf16_f32 v52, v188, v189
    v_cvt_pk_bf16_f32 v53, v190, v191
    v_cvt_pk_bf16_f32 v54, v192, v193
    v_cvt_pk_bf16_f32 v55, v194, v195
    buffer_load_dwordx4 v2, s[8:11], s49 offen offset:1024 nt lds
    v_pk_mul_f32 v[220:221], v[220:221], v[252:253]
    v_pk_mul_f32 v[222:223], v[222:223], v[252:253]
    v_permlane32_swap_b32 v52, v54
    v_permlane32_swap_b32 v53, v55
    v_pk_mul_f32 v[224:225], v[224:225], v[252:253]
    v_pk_mul_f32 v[226:227], v[226:227], v[252:253]
    v_permlane16_swap_b32 v52, v54
    v_permlane16_swap_b32 v53, v55
    v_cvt_pk_bf16_f32 v68, v220, v221
    v_cvt_pk_bf16_f32 v69, v222, v223
    v_cvt_pk_bf16_f32 v70, v224, v225
    v_cvt_pk_bf16_f32 v71, v226, v227
    v_pk_mul_f32 v[132:133], v[132:133], v[252:253]
    v_pk_mul_f32 v[134:135], v[134:135], v[252:253]
    v_permlane32_swap_b32 v68, v70
    v_permlane32_swap_b32 v69, v71
    v_pk_mul_f32 v[136:137], v[136:137], v[252:253]
    v_pk_mul_f32 v[138:139], v[138:139], v[252:253]
    v_permlane16_swap_b32 v68, v70
    v_permlane16_swap_b32 v69, v71
    v_cvt_pk_bf16_f32 v24, v132, v133
    v_cvt_pk_bf16_f32 v25, v134, v135
    v_cvt_pk_bf16_f32 v26, v136, v137
    v_cvt_pk_bf16_f32 v27, v138, v139
    buffer_load_dwordx4 v3, s[8:11], s49 offen offset:2048 nt lds
    v_pk_mul_f32 v[164:165], v[164:165], v[252:253]
    v_pk_mul_f32 v[166:167], v[166:167], v[252:253]
    v_permlane32_swap_b32 v24, v26
    v_permlane32_swap_b32 v25, v27
    v_pk_mul_f32 v[168:169], v[168:169], v[252:253]
    v_pk_mul_f32 v[170:171], v[170:171], v[252:253]
    v_permlane16_swap_b32 v24, v26
    v_permlane16_swap_b32 v25, v27
    v_cvt_pk_bf16_f32 v40, v164, v165
    v_cvt_pk_bf16_f32 v41, v166, v167
    v_cvt_pk_bf16_f32 v42, v168, v169
    v_cvt_pk_bf16_f32 v43, v170, v171
    v_pk_mul_f32 v[196:197], v[196:197], v[252:253]
    v_pk_mul_f32 v[198:199], v[198:199], v[252:253]
    v_permlane32_swap_b32 v40, v42
    v_permlane32_swap_b32 v41, v43
    v_pk_mul_f32 v[200:201], v[200:201], v[252:253]
    v_pk_mul_f32 v[202:203], v[202:203], v[252:253]
    v_permlane16_swap_b32 v40, v42
    v_permlane16_swap_b32 v41, v43
    v_cvt_pk_bf16_f32 v56, v196, v197
    v_cvt_pk_bf16_f32 v57, v198, v199
    v_cvt_pk_bf16_f32 v58, v200, v201
    v_cvt_pk_bf16_f32 v59, v202, v203
    buffer_load_dwordx4 v4, s[8:11], s49 offen offset:3072 nt lds
    v_pk_mul_f32 v[228:229], v[228:229], v[252:253]
    v_pk_mul_f32 v[230:231], v[230:231], v[252:253]
    v_permlane32_swap_b32 v56, v58
    v_permlane32_swap_b32 v57, v59
    v_pk_mul_f32 v[232:233], v[232:233], v[252:253]
    v_pk_mul_f32 v[234:235], v[234:235], v[252:253]
    v_permlane16_swap_b32 v56, v58
    v_permlane16_swap_b32 v57, v59
    v_cvt_pk_bf16_f32 v72, v228, v229
    v_cvt_pk_bf16_f32 v73, v230, v231
    v_cvt_pk_bf16_f32 v74, v232, v233
    v_cvt_pk_bf16_f32 v75, v234, v235
    s_nop 0
    v_permlane32_swap_b32 v72, v74
    v_permlane32_swap_b32 v73, v75
    s_nop 0
    v_permlane16_swap_b32 v72, v74
    v_permlane16_swap_b32 v73, v75
    s_lshl_b32 s62, s4, 1
    s_lshr_b32 s6, s5, 4
    s_add_u32 s62, s62, s6
    s_lshl_b32 s62, s62, 11
    s_and_b32 s6, s5, 15
    s_lshl_b32 s6, s6, 7
    s_add_u32 s62, s62, s6
    s_add_u32 s62, s62, 19922944
    s_or_b32 s6, s3, s59
    s_cbranch_scc1 L_noclr
    v_mov_b32 v232, s62
    v_mov_b32 v233, 0
    s_mov_b64 exec, 1
    global_store_dword v232, v233, s[46:47] sc1
    s_mov_b64 exec, -1
L_noclr:
    v_and_b32 v235, 15, v0
    v_lshrrev_b32 v236, 4, v0
    v_lshrrev_b32 v232, 3, v235
    v_lshlrev_b32 v232, 11, v232
    v_and_b32 v233, 7, v235
    v_lshl_add_u32 v232, v233, 7, v232
    v_lshrrev_b32 v233, 1, v235
    v_xor_b32 v233, v233, v236
    v_lshl_add_u32 v239, v233, 4, v232
    v_add_u32 v239, 131072, v239
    v_xor_b32 v240, 64, v239
    v_and_b32 v11, 48, v0
    v_add_u32 v11, 131072, v11
    s_waitcnt vmcnt(16) lgkmcnt(0)
    s_barrier
    ds_read_b128 v[172:175], v11 offset:0
    ds_read_b128 v[176:179], v11 offset:64
    ds_read_b128 v[180:183], v11 offset:1024
    ds_read_b128 v[184:187], v11 offset:1088
    ds_read_b128 v[76:79], v10 offset:0
    ds_read_b128 v[80:83], v10 offset:1024
    ds_read_b128 v[84:87], v10 offset:2048
    ds_read_b128 v[88:91], v10 offset:3072
    ds_read_b128 v[92:95], v10 offset:4096
    ds_read_b128 v[96:99], v10 offset:5120
    ds_read_b128 v[100:103], v10 offset:6144
    ds_read_b128 v[104:107], v10 offset:7168
    s_cmp_lg_u32 s59, 0
    s_cbranch_scc1 L_truemax
    v_bfe_u32 v237, v0, 2, 2
    v_and_b32 v238, 3, v0
    v_and_b32 v232, 1, v236
    v_lshl_add_u32 v232, v232, 2, v237
    v_lshrrev_b32 v233, 1, v232
    v_lshlrev_b32 v233, 5, v233
    v_lshl_add_u32 v233, v232, 7, v233
    v_lshrrev_b32 v232, 1, v236
    v_lshl_add_u32 v233, v232, 11, v233
    v_lshl_add_u32 v234, v238, 3, v233
    s_add_u32 s6, s3, 0
    s_and_b32 s6, s6, 3
    s_lshl_b32 s6, s6, 13
    v_add_u32 v204, s6, v239
    v_add_u32 v205, s6, v240
    v_add_u32 v212, s6, v234
    s_waitcnt lgkmcnt(8)
    v_xor_b32 v172, 0x80008000, v172
    v_xor_b32 v173, 0x80008000, v173
    v_xor_b32 v174, 0x80008000, v174
    v_xor_b32 v175, 0x80008000, v175
    v_xor_b32 v176, 0x80008000, v176
    v_xor_b32 v177, 0x80008000, v177
    v_xor_b32 v178, 0x80008000, v178
    v_xor_b32 v179, 0x80008000, v179
    v_xor_b32 v180, 0x80008000, v180
    v_xor_b32 v181, 0x80008000, v181
    v_xor_b32 v182, 0x80008000, v182
    v_xor_b32 v183, 0x80008000, v183
    v_xor_b32 v184, 0x80008000, v184
    v_xor_b32 v185, 0x80008000, v185
    v_xor_b32 v186, 0x80008000, v186
    v_xor_b32 v187, 0x80008000, v187
    v_mfma_f32_16x16x32_bf16 v[108:111], v[172:175], v[12:15], 0
    ds_read_b128 a[192:195], v204 offset:0
    ds_read_b128 a[196:199], v205 offset:0
    v_mfma_f32_16x16x32_bf16 v[108:111], v[176:179], v[16:19], v[108:111]
    ds_read_b128 a[200:203], v204 offset:1024
    ds_read_b128 a[204:207], v205 offset:1024
    v_mfma_f32_16x16x32_bf16 v[108:111], v[180:183], v[20:23], v[108:111]
    ds_read_b128 a[208:211], v204 offset:4096
    ds_read_b128 a[212:215], v205 offset:4096
    v_mfma_f32_16x16x32_bf16 v[108:111], v[184:187], v[24:27], v[108:111]
    ds_read_b128 a[216:219], v204 offset:5120
    ds_read_b128 a[220:223], v205 offset:5120
    v_mfma_f32_16x16x32_bf16 v[112:115], v[172:175], v[28:31], 0
    v_xor_b32 v213, 32, v212
    v_xor_b32 v214, 64, v212
    v_mfma_f32_16x16x32_bf16 v[112:115], v[176:179], v[32:35], v[112:115]
    v_xor_b32 v215, 96, v212
    s_add_u32 s6, s3, 1
    s_and_b32 s6, s6, 3
    s_lshl_b32 s6, s6, 13
    v_add_u32 v206, s6, v239
    v_mfma_f32_16x16x32_bf16 v[112:115], v[180:183], v[36:39], v[112:115]
    v_add_u32 v207, s6, v240
    v_add_u32 v216, s6, v234
    v_mfma_f32_16x16x32_bf16 v[112:115], v[184:187], v[40:43], v[112:115]
    v_xor_b32 v217, 32, v216
    v_xor_b32 v218, 64, v216
    s_waitcnt lgkmcnt(0)
L_att:
    s_mov_b32 s58, 3
    s_mov_b32 s66, 65536
    s_mov_b32 s65, 0xffff8000
    s_add_u32 s68, s91, 65536
    v_mfma_f32_16x16x32_bf16 v[156:159], a[192:195], v[12:15], v[108:111]
    v_mov_b32 v132, 0
    v_mov_b32 v133, 0
    s_add_u32 s50, s50, s53
    s_add_u32 s51, s51, s53
    s_and_b32 s50, s50, s33
    s_and_b32 s51, s51, s33
    s_mov_b32 m0, s56
    v_mfma_f32_16x16x32_bf16 v[156:159], a[196:199], v[16:19], v[156:159]
    v_mov_b32 v134, 0
    v_mov_b32 v135, 0
    buffer_load_dwordx4 v5, s[12:15], s50 offen nt lds
    v_mfma_f32_16x16x32_bf16 v[156:159], a[200:203], v[20:23], v[156:159]
    v_xor_b32 v219, 96, v216
    s_add_u32 s6, s3, 2
    s_and_b32 s6, s6, 3
    s_lshl_b32 s6, s6, 13
    v_add_u32 v208, s6, v239
    v_mfma_f32_16x16x32_bf16 v[156:159], a[204:207], v[24:27], v[156:159]
    v_add_u32 v209, s6, v240
    v_add_u32 v220, s6, v234
    v_mfma_f32_16x16x32_bf16 v[160:163], a[208:211], v[12:15], v[108:111]
    v_xor_b32 v221, 32, v220
    v_xor_b32 v222, 64, v220
    v_mfma_f32_16x16x32_bf16 v[160:163], a[212:215], v[16:19], v[160:163]
    v_xor_b32 v223, 96, v220
    s_add_u32 s6, s3, 3
    s_and_b32 s6, s6, 3
    s_lshl_b32 s6, s6, 13
    v_add_u32 v210, s6, v239
    v_mfma_f32_16x16x32_bf16 v[160:163], a[216:219], v[20:23], v[160:163]
    v_add_u32 v211, s6, v240
    v_add_u32 v224, s6, v234
    v_mfma_f32_16x16x32_bf16 v[160:163], a[220:223], v[24:27], v[160:163]
    v_xor_b32 v225, 32, v224
    v_xor_b32 v226, 64, v224
    v_mfma_f32_16x16x32_bf16 v[164:167], a[192:195], v[28:31], v[112:115]
    v_xor_b32 v227, 96, v224
    v_mov_b32 v228, 0x3f803f80
    v_mfma_f32_16x16x32_bf16 v[164:167], a[196:199], v[32:35], v[164:167]
    v_mov_b32 v229, 0x3f803f80
    v_mov_b32 v230, 0x3f803f80
    v_exp_f32 v156, v156
    v_mfma_f32_16x16x32_bf16 v[164:167], a[200:203], v[36:39], v[164:167]
    v_mov_b32 v231, 0x3f803f80
    v_mov_b32 v136, 0
    v_mfma_f32_16x16x32_bf16 v[164:167], a[204:207], v[40:43], v[164:167]
    v_mov_b32 v137, 0
    v_mov_b32 v138, 0
    v_exp_f32 v157, v157
    v_mfma_f32_16x16x32_bf16 v[168:171], a[208:211], v[28:31], v[112:115]
    v_mov_b32 v139, 0
    v_mov_b32 v140, 0
    v_cvt_pk_bf16_f32 v188, v156, v157
    v_add_f32 v132, v132, v156
    v_mfma_f32_16x16x32_bf16 v[168:171], a[212:215], v[32:35], v[168:171]
    v_mov_b32 v141, 0
    v_mov_b32 v142, 0
    v_exp_f32 v158, v158
    v_mfma_f32_16x16x32_bf16 v[168:171], a[216:219], v[36:39], v[168:171]
    v_mov_b32 v143, 0
    v_mov_b32 v144, 0
    v_add_f32 v132, v132, v158
    v_mfma_f32_16x16x32_bf16 v[168:171], a[220:223], v[40:43], v[168:171]
    v_mov_b32 v145, 0
    v_mov_b32 v146, 0
    v_exp_f32 v159, v159
    v_mfma_f32_16x16x32_bf16 v[116:119], v[172:175], v[44:47], 0
    v_mov_b32 v147, 0
    v_mov_b32 v148, 0
    v_cvt_pk_bf16_f32 v189, v158, v159
    v_add_f32 v133, v133, v157
    v_mfma_f32_16x16x32_bf16 v[116:119], v[176:179], v[48:51], v[116:119]
    v_exp_f32 v160, v160
    v_mfma_f32_16x16x32_bf16 v[116:119], v[180:183], v[52:55], v[116:119]
    v_mov_b32 v149, 0
    v_mov_b32 v150, 0
    buffer_load_dwordx4 v6, s[12:15], s50 offen offset:1024 nt lds
    v_mfma_f32_16x16x32_bf16 v[116:119], v[184:187], v[56:59], v[116:119]
    v_exp_f32 v161, v161
    v_mfma_f32_16x16x32_bf16 v[120:123], v[172:175], v[60:63], 0
    v_mov_b32 v151, 0
    v_mov_b32 v152, 0
    v_cvt_pk_bf16_f32 v190, v160, v161
    v_add_f32 v133, v133, v159
    v_mfma_f32_16x16x32_bf16 v[120:123], v[176:179], v[64:67], v[120:123]
    v_exp_f32 v162, v162
    v_mfma_f32_16x16x32_bf16 v[120:123], v[180:183], v[68:71], v[120:123]
    v_mov_b32 v153, 0
    v_mov_b32 v154, 0
    v_add_f32 v132, v132, v160
    v_add_f32 v133, v133, v161
    v_mfma_f32_16x16x32_bf16 v[120:123], v[184:187], v[72:75], v[120:123]
    v_exp_f32 v163, v163
    v_mfma_f32_16x16x32_bf16 v[124:127], v[172:175], v[76:79], 0
    v_mov_b32 v155, 0
    s_waitcnt vmcnt(10)
    s_barrier
    ds_read_b64_tr_b16 a[224:225], v212 offset:0
    v_cvt_pk_bf16_f32 v191, v162, v163
    v_mfma_f32_16x16x32_bf16 v[124:127], v[176:179], v[80:83], v[124:127]
    v_exp_f32 v164, v164
    v_mfma_f32_16x16x32_bf16 v[124:127], v[180:183], v[84:87], v[124:127]
    ds_read_b64_tr_b16 a[228:229], v213 offset:0
    ds_read_b64_tr_b16 a[230:231], v213 offset:4096
    v_mfma_f32_16x16x32_bf16 v[124:127], v[184:187], v[88:91], v[124:127]
    v_exp_f32 v165, v165
    v_mfma_f32_16x16x32_bf16 v[128:131], v[172:175], v[92:95], 0
    ds_read_b64_tr_b16 a[226:227], v212 offset:4096
    v_cvt_pk_bf16_f32 v192, v164, v165
    v_mfma_f32_16x16x32_bf16 v[128:131], v[176:179], v[96:99], v[128:131]
    v_exp_f32 v166, v166
    v_mfma_f32_16x16x32_bf16 v[128:131], v[180:183], v[100:103], v[128:131]
    ds_read_b64_tr_b16 a[234:235], v214 offset:4096
    ds_read_b64_tr_b16 a[236:237], v215 offset:0
    v_mfma_f32_16x16x32_bf16 v[128:131], v[184:187], v[104:107], v[128:131]
    v_exp_f32 v167, v167
    ds_read_b64_tr_b16 a[232:233], v214 offset:0
    v_cvt_pk_bf16_f32 v193, v166, v167
L_loop:
    v_mfma_f32_16x16x32_bf16 v[172:175], a[192:195], v[44:47], v[116:119]
    v_exp_f32 v168, v168
    v_mfma_f32_16x16x32_bf16 v[172:175], a[196:199], v[48:51], v[172:175]
    ds_read_b64_tr_b16 a[240:241], v212 offset:1024
    ds_read_b64_tr_b16 a[242:243], v212 offset:5120
    v_mfma_f32_16x16x32_bf16 v[172:175], a[200:203], v[52:55], v[172:175]
    v_exp_f32 v169, v169
    v_mfma_f32_16x16x32_bf16 v[172:175], a[204:207], v[56:59], v[172:175]
    ds_read_b64_tr_b16 a[238:239], v215 offset:4096
    v_cvt_pk_bf16_f32 v194, v168, v169
    v_mfma_f32_16x16x32_bf16 v[176:179], a[208:211], v[44:47], v[116:119]
    v_exp_f32 v170, v170
    v_mfma_f32_16x16x32_bf16 v[176:179], a[212:215], v[48:51], v[176:179]
    ds_read_b64_tr_b16 a[246:247], v213 offset:5120
    ds_read_b64_tr_b16 a[248:249], v214 offset:1024
    v_mfma_f32_16x16x32_bf16 v[176:179], a[216:219], v[52:55], v[176:179]
    v_exp_f32 v171, v171
    v_mfma_f32_16x16x32_bf16 v[176:179], a[220:223], v[56:59], v[176:179]
    ds_read_b64_tr_b16 a[244:245], v213 offset:1024
    v_cvt_pk_bf16_f32 v195, v170, v171
    v_mfma_f32_16x16x32_bf16 v[180:183], a[192:195], v[60:63], v[120:123]
    ds_read_b64_tr_b16 a[250:251], v214 offset:5120
    ds_read_b64_tr_b16 a[252:253], v215 offset:1024
    v_mfma_f32_16x16x32_bf16 v[180:183], a[196:199], v[64:67], v[180:183]
    v_exp_f32 v172, v172
    v_mfma_f32_16x16x32_bf16 v[180:183], a[200:203], v[68:71], v[180:183]
    buffer_load_dwordx4 v7, s[12:15], s50 offen offset:2048 nt lds
    v_mfma_f32_16x16x32_bf16 v[180:183], a[204:207], v[72:75], v[180:183]
    v_exp_f32 v173, v173
    v_mfma_f32_16x16x32_bf16 v[184:187], a[208:211], v[60:63], v[120:123]
    ds_read_b64_tr_b16 a[254:255], v215 offset:5120
    v_cvt_pk_bf16_f32 v196, v172, v173
    v_mfma_f32_16x16x32_bf16 v[184:187], a[212:215], v[64:67], v[184:187]
    v_exp_f32 v174, v174
    v_mfma_f32_16x16x32_bf16 v[184:187], a[216:219], v[68:71], v[184:187]
    buffer_load_dwordx4 v8, s[12:15], s50 offen offset:3072 nt lds
    v_mfma_f32_16x16x32_bf16 v[184:187], a[220:223], v[72:75], v[184:187]
    s_waitcnt lgkmcnt(1)
    v_exp_f32 v175, v175
    v_mfma_f32_16x16x32_bf16 a[0:3], a[224:227], v[188:191], a[0:3]
    v_cvt_pk_bf16_f32 v197, v174, v175
    v_add_f32 v140, v140, v172
    v_mfma_f32_16x16x32_bf16 a[4:7], a[228:231], v[188:191], a[4:7]
    v_exp_f32 v176, v176
    v_mfma_f32_16x16x32_bf16 a[8:11], a[232:235], v[188:191], a[8:11]
    v_add_f32 v140, v140, v174
    v_add_f32 v141, v141, v175
    v_mfma_f32_16x16x32_bf16 a[12:15], a[236:239], v[188:191], a[12:15]
    v_exp_f32 v177, v177
    v_mfma_f32_16x16x32_bf16 a[16:19], a[240:243], v[188:191], a[16:19]
    v_cvt_pk_bf16_f32 v198, v176, v177
    v_add_f32 v141, v141, v173
    v_mfma_f32_16x16x32_bf16 a[20:23], a[244:247], v[188:191], a[20:23]
    v_exp_f32 v178, v178
    v_mfma_f32_16x16x32_bf16 a[24:27], a[248:251], v[188:191], a[24:27]
    s_waitcnt lgkmcnt(0)
    v_add_f32 v141, v141, v177
    v_add_f32 v140, v140, v178
    v_mfma_f32_16x16x32_bf16 a[28:31], a[252:255], v[188:191], a[28:31]
    v_exp_f32 v179, v179
    v_mfma_f32_16x16x32_bf16 a[32:35], a[224:227], v[192:195], a[32:35]
    v_cvt_pk_bf16_f32 v199, v178, v179
    v_add_f32 v140, v140, v176
    v_mfma_f32_16x16x32_bf16 a[36:39], a[228:231], v[192:195], a[36:39]
    v_exp_f32 v180, v180
    v_mfma_f32_16x16x32_bf16 a[40:43], a[232:235], v[192:195], a[40:43]
    v_add_f32 v132, v132, v162
    v_add_f32 v133, v133, v163
    v_mfma_f32_16x16x32_bf16 a[44:47], a[236:239], v[192:195], a[44:47]
    v_exp_f32 v181, v181
    v_mfma_f32_16x16x32_bf16 a[48:51], a[240:243], v[192:195], a[48:51]
    v_cvt_pk_bf16_f32 v200, v180, v181
    v_add_f32 v141, v141, v179
    v_mfma_f32_16x16x32_bf16 a[52:55], a[244:247], v[192:195], a[52:55]
    s_mov_b32 m0, s57
    v_exp_f32 v182, v182
    v_mfma_f32_16x16x32_bf16 a[56:59], a[248:251], v[192:195], a[56:59]
    buffer_load_dwordx4 v5, s[12:15], s51 offen nt lds
    v_mfma_f32_16x16x32_bf16 a[60:63], a[252:255], v[192:195], a[60:63]
    v_exp_f32 v183, v183
    v_mfma_f32_16x16x32_bf16 v[136:139], v[228:231], v[192:195], v[136:139]
    v_cvt_pk_bf16_f32 v201, v182, v183
    v_mfma_f32_16x16x32_bf16 v[156:159], a[192:195], v[76:79], v[124:127]
    v_exp_f32 v184, v184
    v_mfma_f32_16x16x32_bf16 v[156:159], a[196:199], v[80:83], v[156:159]
    v_mfma_f32_16x16x32_bf16 v[156:159], a[200:203], v[84:87], v[156:159]
    v_exp_f32 v185, v185
    v_mfma_f32_16x16x32_bf16 v[156:159], a[204:207], v[88:91], v[156:159]
    v_cvt_pk_bf16_f32 v202, v184, v185
    v_mfma_f32_16x16x32_bf16 v[160:163], a[208:211], v[76:79], v[124:127]
    v_exp_f32 v186, v186
    v_mfma_f32_16x16x32_bf16 v[160:163], a[212:215], v[80:83], v[160:163]
    v_mfma_f32_16x16x32_bf16 v[160:163], a[216:219], v[84:87], v[160:163]
    v_exp_f32 v187, v187
    v_mfma_f32_16x16x32_bf16 v[160:163], a[220:223], v[88:91], v[160:163]
    v_cvt_pk_bf16_f32 v203, v186, v187
    v_mfma_f32_16x16x32_bf16 v[164:167], a[192:195], v[92:95], v[128:131]
    ds_read_b128 a[192:195], v206 offset:0
    v_mfma_f32_16x16x32_bf16 v[164:167], a[196:199], v[96:99], v[164:167]
    v_exp_f32 v156, v156
    v_mfma_f32_16x16x32_bf16 v[164:167], a[200:203], v[100:103], v[164:167]
    ds_read_b128 a[200:203], v206 offset:1024
    v_add_f32 v148, v148, v156
    v_mfma_f32_16x16x32_bf16 v[164:167], a[204:207], v[104:107], v[164:167]
    v_exp_f32 v157, v157
    v_mfma_f32_16x16x32_bf16 v[168:171], a[208:211], v[92:95], v[128:131]
    ds_read_b128 a[196:199], v207 offset:0
    v_cvt_pk_bf16_f32 v188, v156, v157
    v_mfma_f32_16x16x32_bf16 v[168:171], a[212:215], v[96:99], v[168:171]
    v_exp_f32 v158, v158
    v_mfma_f32_16x16x32_bf16 v[168:171], a[216:219], v[100:103], v[168:171]
    ds_read_b128 a[208:211], v206 offset:4096
    ds_read_b128 a[212:215], v207 offset:4096
    v_mfma_f32_16x16x32_bf16 v[168:171], a[220:223], v[104:107], v[168:171]
    v_exp_f32 v159, v159
    v_mfma_f32_16x16x32_bf16 a[64:67], a[224:227], v[196:199], a[64:67]
    ds_read_b128 a[204:207], v207 offset:1024
    v_cvt_pk_bf16_f32 v189, v158, v159
    v_mfma_f32_16x16x32_bf16 a[68:71], a[228:231], v[196:199], a[68:71]
    v_exp_f32 v160, v160
    v_mfma_f32_16x16x32_bf16 a[72:75], a[232:235], v[196:199], a[72:75]
    ds_read_b128 a[220:223], v207 offset:5120
    v_add_f32 v149, v149, v157
    v_mfma_f32_16x16x32_bf16 a[76:79], a[236:239], v[196:199], a[76:79]
    v_exp_f32 v161, v161
    v_mfma_f32_16x16x32_bf16 a[80:83], a[240:243], v[196:199], a[80:83]
    ds_read_b128 a[216:219], v206 offset:5120
    v_cvt_pk_bf16_f32 v190, v160, v161
    v_mfma_f32_16x16x32_bf16 a[84:87], a[244:247], v[196:199], a[84:87]
    v_exp_f32 v162, v162
    v_mfma_f32_16x16x32_bf16 a[88:91], a[248:251], v[196:199], a[88:91]
    buffer_load_dwordx4 v6, s[12:15], s51 offen offset:1024 nt lds
    v_mfma_f32_16x16x32_bf16 a[92:95], a[252:255], v[196:199], a[92:95]
    v_exp_f32 v163, v163
    v_mfma_f32_16x16x32_bf16 a[96:99], a[224:227], v[200:203], a[96:99]
    v_cvt_pk_bf16_f32 v191, v162, v163
    v_add_f32 v148, v148, v158
    v_mfma_f32_16x16x32_bf16 a[100:103], a[228:231], v[200:203], a[100:103]
    v_exp_f32 v164, v164
    v_mfma_f32_16x16x32_bf16 a[104:107], a[232:235], v[200:203], a[104:107]
    buffer_load_dwordx4 v7, s[12:15], s51 offen offset:2048 nt lds
    v_mfma_f32_16x16x32_bf16 a[108:111], a[236:239], v[200:203], a[108:111]
    v_exp_f32 v165, v165
    v_mfma_f32_16x16x32_bf16 a[112:115], a[240:243], v[200:203], a[112:115]
    v_cvt_pk_bf16_f32 v192, v164, v165
    v_add_f32 v149, v149, v159
    v_mfma_f32_16x16x32_bf16 a[116:119], a[244:247], v[200:203], a[116:119]
    v_exp_f32 v166, v166
    v_mfma_f32_16x16x32_bf16 a[120:123], a[248:251], v[200:203], a[120:123]
    v_add_f32 v149, v149, v161
    v_add_f32 v148, v148, v162
    v_mfma_f32_16x16x32_bf16 a[124:127], a[252:255], v[200:203], a[124:127]
    v_exp_f32 v167, v167
    v_mfma_f32_16x16x32_bf16 v[144:147], v[228:231], v[200:203], v[144:147]
    s_waitcnt lgkmcnt(0)
    v_cvt_pk_bf16_f32 v193, v166, v167
    v_add_f32 v148, v148, v160
    v_mfma_f32_16x16x32_bf16 v[172:175], a[192:195], v[12:15], v[108:111]
    v_exp_f32 v168, v168
    v_mfma_f32_16x16x32_bf16 v[172:175], a[196:199], v[16:19], v[172:175]
    v_mfma_f32_16x16x32_bf16 v[172:175], a[200:203], v[20:23], v[172:175]
    v_exp_f32 v169, v169
    v_mfma_f32_16x16x32_bf16 v[172:175], a[204:207], v[24:27], v[172:175]
    v_cvt_pk_bf16_f32 v194, v168, v169
    v_add_f32 v149, v149, v163
    v_mfma_f32_16x16x32_bf16 v[176:179], a[208:211], v[12:15], v[108:111]
    v_exp_f32 v170, v170
    v_mfma_f32_16x16x32_bf16 v[176:179], a[212:215], v[16:19], v[176:179]
    v_mfma_f32_16x16x32_bf16 v[176:179], a[216:219], v[20:23], v[176:179]
    v_exp_f32 v171, v171
    v_mfma_f32_16x16x32_bf16 v[176:179], a[220:223], v[24:27], v[176:179]
    v_cvt_pk_bf16_f32 v195, v170, v171
    v_mfma_f32_16x16x32_bf16 v[180:183], a[192:195], v[28:31], v[112:115]
    buffer_load_dwordx4 v8, s[12:15], s51 offen offset:3072 nt lds
    v_mfma_f32_16x16x32_bf16 v[180:183], a[196:199], v[32:35], v[180:183]
    v_exp_f32 v172, v172
    v_mfma_f32_16x16x32_bf16 v[180:183], a[200:203], v[36:39], v[180:183]
    v_mfma_f32_16x16x32_bf16 v[180:183], a[204:207], v[40:43], v[180:183]
    v_exp_f32 v173, v173
    v_mfma_f32_16x16x32_bf16 v[184:187], a[208:211], v[28:31], v[112:115]
    v_cvt_pk_bf16_f32 v196, v172, v173
    v_add_f32 v132, v132, v172
    v_mfma_f32_16x16x32_bf16 v[184:187], a[212:215], v[32:35], v[184:187]
    v_exp_f32 v174, v174
    v_mfma_f32_16x16x32_bf16 v[184:187], a[216:219], v[36:39], v[184:187]
    v_add_f32 v132, v132, v174
    v_mfma_f32_16x16x32_bf16 v[184:187], a[220:223], v[40:43], v[184:187]
    v_exp_f32 v175, v175
    v_mfma_f32_16x16x32_bf16 a[128:131], a[224:227], v[188:191], a[128:131]
    v_cvt_pk_bf16_f32 v197, v174, v175
    v_add_f32 v133, v133, v173
    v_mfma_f32_16x16x32_bf16 a[132:135], a[228:231], v[188:191], a[132:135]
    v_exp_f32 v176, v176
    v_mfma_f32_16x16x32_bf16 a[136:139], a[232:235], v[188:191], a[136:139]
    v_add_f32 v132, v132, v176
    v_mfma_f32_16x16x32_bf16 a[140:143], a[236:239], v[188:191], a[140:143]
    v_exp_f32 v177, v177
    v_mfma_f32_16x16x32_bf16 a[144:147], a[240:243], v[188:191], a[144:147]
    v_cvt_pk_bf16_f32 v198, v176, v177
    v_add_f32 v133, v133, v175
    v_mfma_f32_16x16x32_bf16 a[148:151], a[244:247], v[188:191], a[148:151]
    v_exp_f32 v178, v178
    v_mfma_f32_16x16x32_bf16 a[152:155], a[248:251], v[188:191], a[152:155]
    v_add_f32 v133, v133, v177
    v_add_f32 v132, v132, v178
    v_mfma_f32_16x16x32_bf16 a[156:159], a[252:255], v[188:191], a[156:159]
    v_exp_f32 v179, v179
    v_mfma_f32_16x16x32_bf16 a[160:163], a[224:227], v[192:195], a[160:163]
    ds_read_b64_tr_b16 a[224:225], v216 offset:0
    v_cvt_pk_bf16_f32 v199, v178, v179
    v_mfma_f32_16x16x32_bf16 a[164:167], a[228:231], v[192:195], a[164:167]
    v_exp_f32 v180, v180
    v_mfma_f32_16x16x32_bf16 a[168:171], a[232:235], v[192:195], a[168:171]
    ds_read_b64_tr_b16 a[228:229], v217 offset:0
    ds_read_b64_tr_b16 a[230:231], v217 offset:4096
    v_mfma_f32_16x16x32_bf16 a[172:175], a[236:239], v[192:195], a[172:175]
    v_exp_f32 v181, v181
    v_mfma_f32_16x16x32_bf16 a[176:179], a[240:243], v[192:195], a[176:179]
    ds_read_b64_tr_b16 a[226:227], v216 offset:4096
    v_cvt_pk_bf16_f32 v200, v180, v181
    v_mfma_f32_16x16x32_bf16 a[180:183], a[244:247], v[192:195], a[180:183]
    v_exp_f32 v182, v182
    v_mfma_f32_16x16x32_bf16 a[184:187], a[248:251], v[192:195], a[184:187]
    ds_read_b64_tr_b16 a[234:235], v218 offset:4096
    ds_read_b64_tr_b16 a[236:237], v219 offset:0
    v_mfma_f32_16x16x32_bf16 a[188:191], a[252:255], v[192:195], a[188:191]
    v_exp_f32 v183, v183
    v_mfma_f32_16x16x32_bf16 v[152:155], v[228:231], v[192:195], v[152:155]
    ds_read_b64_tr_b16 a[232:233], v218 offset:0
    v_cvt_pk_bf16_f32 v201, v182, v183
    v_mfma_f32_16x16x32_bf16 v[156:159], a[192:195], v[44:47], v[116:119]
    v_exp_f32 v184, v184
    v_mfma_f32_16x16x32_bf16 v[156:159], a[196:199], v[48:51], v[156:159]
    ds_read_b64_tr_b16 a[240:241], v216 offset:1024
    ds_read_b64_tr_b16 a[242:243], v216 offset:5120
    v_mfma_f32_16x16x32_bf16 v[156:159], a[200:203], v[52:55], v[156:159]
    v_exp_f32 v185, v185
    v_mfma_f32_16x16x32_bf16 v[156:159], a[204:207], v[56:59], v[156:159]
    ds_read_b64_tr_b16 a[238:239], v219 offset:4096
    v_cvt_pk_bf16_f32 v202, v184, v185
    v_mfma_f32_16x16x32_bf16 v[160:163], a[208:211], v[44:47], v[116:119]
    v_exp_f32 v186, v186
    v_mfma_f32_16x16x32_bf16 v[160:163], a[212:215], v[48:51], v[160:163]
    ds_read_b64_tr_b16 a[246:247], v217 offset:5120
    ds_read_b64_tr_b16 a[248:249], v218 offset:1024
    v_mfma_f32_16x16x32_bf16 v[160:163], a[216:219], v[52:55], v[160:163]
    v_exp_f32 v187, v187
    v_mfma_f32_16x16x32_bf16 v[160:163], a[220:223], v[56:59], v[160:163]
    ds_read_b64_tr_b16 a[244:245], v217 offset:1024
    v_cvt_pk_bf16_f32 v203, v186, v187
    v_mfma_f32_16x16x32_bf16 v[164:167], a[192:195], v[60:63], v[120:123]
    ds_read_b64_tr_b16 a[250:251], v218 offset:5120
    ds_read_b64_tr_b16 a[252:253], v219 offset:1024
    v_mfma_f32_16x16x32_bf16 v[164:167], a[196:199], v[64:67], v[164:167]
    v_exp_f32 v156, v156
    v_mfma_f32_16x16x32_bf16 v[164:167], a[200:203], v[68:71], v[164:167]
    ds_read_b128 a[192:195], v208 offset:0
    ds_read_b128 a[196:199], v209 offset:0
    v_mfma_f32_16x16x32_bf16 v[164:167], a[204:207], v[72:75], v[164:167]
    v_exp_f32 v157, v157
    v_mfma_f32_16x16x32_bf16 v[168:171], a[208:211], v[60:63], v[120:123]
    ds_read_b64_tr_b16 a[254:255], v219 offset:5120
    v_cvt_pk_bf16_f32 v188, v156, v157
    v_mfma_f32_16x16x32_bf16 v[168:171], a[212:215], v[64:67], v[168:171]
    v_exp_f32 v158, v158
    v_mfma_f32_16x16x32_bf16 v[168:171], a[216:219], v[68:71], v[168:171]
    ds_read_b128 a[204:207], v209 offset:1024
    ds_read_b128 a[208:211], v208 offset:4096
    v_mfma_f32_16x16x32_bf16 v[168:171], a[220:223], v[72:75], v[168:171]
    s_waitcnt lgkmcnt(5)
    v_exp_f32 v159, v159
    v_mfma_f32_16x16x32_bf16 a[0:3], a[224:227], v[196:199], a[0:3]
    ds_read_b128 a[200:203], v208 offset:1024
    v_cvt_pk_bf16_f32 v189, v158, v159
    v_mfma_f32_16x16x32_bf16 a[4:7], a[228:231], v[196:199], a[4:7]
    v_exp_f32 v160, v160
    v_mfma_f32_16x16x32_bf16 a[8:11], a[232:235], v[196:199], a[8:11]
    ds_read_b128 a[216:219], v208 offset:5120
    ds_read_b128 a[220:223], v209 offset:5120
    v_mfma_f32_16x16x32_bf16 a[12:15], a[236:239], v[196:199], a[12:15]
    v_exp_f32 v161, v161
    v_mfma_f32_16x16x32_bf16 a[16:19], a[240:243], v[196:199], a[16:19]
    ds_read_b128 a[212:215], v209 offset:4096
    v_cvt_pk_bf16_f32 v190, v160, v161
    v_mfma_f32_16x16x32_bf16 a[20:23], a[244:247], v[196:199], a[20:23]
    s_add_u32 s48, s48, s52
    s_add_u32 s49, s49, s52
    s_and_b32 s48, s48, s32
    s_and_b32 s49, s49, s32
    s_mov_b32 m0, s68
    v_exp_f32 v162, v162
    v_mfma_f32_16x16x32_bf16 a[24:27], a[248:251], v[196:199], a[24:27]
    s_waitcnt lgkmcnt(3)
    buffer_load_dwordx4 v1, s[8:11], s48 offen nt lds
    v_mfma_f32_16x16x32_bf16 a[28:31], a[252:255], v[196:199], a[28:31]
    v_exp_f32 v163, v163
    v_mfma_f32_16x16x32_bf16 a[32:35], a[224:227], v[200:203], a[32:35]
    v_cvt_pk_bf16_f32 v191, v162, v163
    v_add_f32 v133, v133, v179
    v_mfma_f32_16x16x32_bf16 a[36:39], a[228:231], v[200:203], a[36:39]
    v_exp_f32 v164, v164
    v_mfma_f32_16x16x32_bf16 a[40:43], a[232:235], v[200:203], a[40:43]
    buffer_load_dwordx4 v2, s[8:11], s48 offen offset:1024 nt lds
    v_mfma_f32_16x16x32_bf16 a[44:47], a[236:239], v[200:203], a[44:47]
    v_exp_f32 v165, v165
    v_mfma_f32_16x16x32_bf16 a[48:51], a[240:243], v[200:203], a[48:51]
    v_cvt_pk_bf16_f32 v192, v164, v165
    v_add_f32 v140, v140, v156
    v_mfma_f32_16x16x32_bf16 a[52:55], a[244:247], v[200:203], a[52:55]
    v_exp_f32 v166, v166
    v_mfma_f32_16x16x32_bf16 a[56:59], a[248:251], v[200:203], a[56:59]
    buffer_load_dwordx4 v3, s[8:11], s48 offen offset:2048 nt lds
    v_mfma_f32_16x16x32_bf16 a[60:63], a[252:255], v[200:203], a[60:63]
    v_exp_f32 v167, v167
    v_mfma_f32_16x16x32_bf16 v[136:139], v[228:231], v[200:203], v[136:139]
    v_cvt_pk_bf16_f32 v193, v166, v167
    v_add_f32 v141, v141, v157
    v_mfma_f32_16x16x32_bf16 v[172:175], a[192:195], v[12:15], v[108:111]
    v_exp_f32 v168, v168
    v_mfma_f32_16x16x32_bf16 v[172:175], a[196:199], v[16:19], v[172:175]
    v_add_f32 v141, v141, v159
    v_add_f32 v140, v140, v160
    v_mfma_f32_16x16x32_bf16 v[172:175], a[200:203], v[20:23], v[172:175]
    v_exp_f32 v169, v169
    v_mfma_f32_16x16x32_bf16 v[172:175], a[204:207], v[24:27], v[172:175]
    v_cvt_pk_bf16_f32 v194, v168, v169
    v_add_f32 v140, v140, v158
    v_mfma_f32_16x16x32_bf16 v[176:179], a[208:211], v[12:15], v[108:111]
    s_waitcnt lgkmcnt(0)
    v_exp_f32 v170, v170
    v_mfma_f32_16x16x32_bf16 v[176:179], a[212:215], v[16:19], v[176:179]
    buffer_load_dwordx4 v4, s[8:11], s48 offen offset:3072 nt lds
    v_mfma_f32_16x16x32_bf16 v[176:179], a[216:219], v[20:23], v[176:179]
    v_exp_f32 v171, v171
    v_mfma_f32_16x16x32_bf16 v[176:179], a[220:223], v[24:27], v[176:179]
    v_cvt_pk_bf16_f32 v195, v170, v171
    v_add_f32 v141, v141, v161
    v_mfma_f32_16x16x32_bf16 v[180:183], a[192:195], v[28:31], v[112:115]
    v_add_f32 v140, v140, v162
    v_add_f32 v141, v141, v163
    v_mfma_f32_16x16x32_bf16 v[180:183], a[196:199], v[32:35], v[180:183]
    v_exp_f32 v172, v172
    v_mfma_f32_16x16x32_bf16 v[180:183], a[200:203], v[36:39], v[180:183]
    v_mfma_f32_16x16x32_bf16 v[180:183], a[204:207], v[40:43], v[180:183]
    v_exp_f32 v173, v173
    v_mfma_f32_16x16x32_bf16 v[184:187], a[208:211], v[28:31], v[112:115]
    v_cvt_pk_bf16_f32 v196, v172, v173
    v_add_f32 v132, v132, v172
    v_mfma_f32_16x16x32_bf16 v[184:187], a[212:215], v[32:35], v[184:187]
    v_exp_f32 v174, v174
    v_mfma_f32_16x16x32_bf16 v[184:187], a[216:219], v[36:39], v[184:187]
    v_add_f32 v132, v132, v174
    v_mfma_f32_16x16x32_bf16 v[184:187], a[220:223], v[40:43], v[184:187]
    v_exp_f32 v175, v175
    v_mfma_f32_16x16x32_bf16 a[64:67], a[224:227], v[188:191], a[64:67]
    v_cvt_pk_bf16_f32 v197, v174, v175
    v_add_f32 v133, v133, v173
    v_mfma_f32_16x16x32_bf16 a[68:71], a[228:231], v[188:191], a[68:71]
    v_exp_f32 v176, v176
    v_mfma_f32_16x16x32_bf16 a[72:75], a[232:235], v[188:191], a[72:75]
    v_add_f32 v132, v132, v176
    v_mfma_f32_16x16x32_bf16 a[76:79], a[236:239], v[188:191], a[76:79]
    v_exp_f32 v177, v177
    v_mfma_f32_16x16x32_bf16 a[80:83], a[240:243], v[188:191], a[80:83]
    v_cvt_pk_bf16_f32 v198, v176, v177
    v_add_f32 v133, v133, v175
    v_mfma_f32_16x16x32_bf16 a[84:87], a[244:247], v[188:191], a[84:87]
    s_add_u32 m0, s68, 4096
    v_exp_f32 v178, v178
    v_mfma_f32_16x16x32_bf16 a[88:91], a[248:251], v[188:191], a[88:91]
    buffer_load_dwordx4 v1, s[8:11], s49 offen nt lds
    v_mfma_f32_16x16x32_bf16 a[92:95], a[252:255], v[188:191], a[92:95]
    v_exp_f32 v179, v179
    v_mfma_f32_16x16x32_bf16 a[96:99], a[224:227], v[192:195], a[96:99]
    ds_read_b64_tr_b16 a[224:225], v220 offset:0
    v_cvt_pk_bf16_f32 v199, v178, v179
    v_add_f32 v133, v133, v179
    v_mfma_f32_16x16x32_bf16 a[100:103], a[228:231], v[192:195], a[100:103]
    v_exp_f32 v180, v180
    v_mfma_f32_16x16x32_bf16 a[104:107], a[232:235], v[192:195], a[104:107]
    ds_read_b64_tr_b16 a[228:229], v221 offset:0
    ds_read_b64_tr_b16 a[230:231], v221 offset:4096
    v_mfma_f32_16x16x32_bf16 a[108:111], a[236:239], v[192:195], a[108:111]
    v_exp_f32 v181, v181
    v_mfma_f32_16x16x32_bf16 a[112:115], a[240:243], v[192:195], a[112:115]
    ds_read_b64_tr_b16 a[226:227], v220 offset:4096
    v_cvt_pk_bf16_f32 v200, v180, v181
    v_mfma_f32_16x16x32_bf16 a[116:119], a[244:247], v[192:195], a[116:119]
    v_exp_f32 v182, v182
    v_mfma_f32_16x16x32_bf16 a[120:123], a[248:251], v[192:195], a[120:123]
    ds_read_b64_tr_b16 a[234:235], v222 offset:4096
    ds_read_b64_tr_b16 a[236:237], v223 offset:0
    v_mfma_f32_16x16x32_bf16 a[124:127], a[252:255], v[192:195], a[124:127]
    v_exp_f32 v183, v183
    v_mfma_f32_16x16x32_bf16 v[144:147], v[228:231], v[192:195], v[144:147]
    ds_read_b64_tr_b16 a[232:233], v222 offset:0
    v_cvt_pk_bf16_f32 v201, v182, v183
    v_mfma_f32_16x16x32_bf16 v[156:159], a[192:195], v[44:47], v[116:119]
    v_exp_f32 v184, v184
    v_mfma_f32_16x16x32_bf16 v[156:159], a[196:199], v[48:51], v[156:159]
    ds_read_b64_tr_b16 a[240:241], v220 offset:1024
    ds_read_b64_tr_b16 a[242:243], v220 offset:5120
    v_mfma_f32_16x16x32_bf16 v[156:159], a[200:203], v[52:55], v[156:159]
    v_exp_f32 v185, v185
    v_mfma_f32_16x16x32_bf16 v[156:159], a[204:207], v[56:59], v[156:159]
    ds_read_b64_tr_b16 a[238:239], v223 offset:4096
    v_cvt_pk_bf16_f32 v202, v184, v185
    v_mfma_f32_16x16x32_bf16 v[160:163], a[208:211], v[44:47], v[116:119]
    v_exp_f32 v186, v186
    v_mfma_f32_16x16x32_bf16 v[160:163], a[212:215], v[48:51], v[160:163]
    ds_read_b64_tr_b16 a[246:247], v221 offset:5120
    ds_read_b64_tr_b16 a[248:249], v222 offset:1024
    v_mfma_f32_16x16x32_bf16 v[160:163], a[216:219], v[52:55], v[160:163]
    v_exp_f32 v187, v187
    v_mfma_f32_16x16x32_bf16 v[160:163], a[220:223], v[56:59], v[160:163]
    ds_read_b64_tr_b16 a[244:245], v221 offset:1024
    v_cvt_pk_bf16_f32 v203, v186, v187
    v_mfma_f32_16x16x32_bf16 v[164:167], a[192:195], v[60:63], v[120:123]
    ds_read_b64_tr_b16 a[250:251], v222 offset:5120
    ds_read_b64_tr_b16 a[252:253], v223 offset:1024
    v_mfma_f32_16x16x32_bf16 v[164:167], a[196:199], v[64:67], v[164:167]
    v_exp_f32 v156, v156
    v_mfma_f32_16x16x32_bf16 v[164:167], a[200:203], v[68:71], v[164:167]
    ds_read_b128 a[192:195], v210 offset:0
    ds_read_b128 a[196:199], v211 offset:0
    v_mfma_f32_16x16x32_bf16 v[164:167], a[204:207], v[72:75], v[164:167]
    v_exp_f32 v157, v157
    v_mfma_f32_16x16x32_bf16 v[168:171], a[208:211], v[60:63], v[120:123]
    ds_read_b64_tr_b16 a[254:255], v223 offset:5120
    v_cvt_pk_bf16_f32 v188, v156, v157
    v_mfma_f32_16x16x32_bf16 v[168:171], a[212:215], v[64:67], v[168:171]
    v_exp_f32 v158, v158
    v_mfma_f32_16x16x32_bf16 v[168:171], a[216:219], v[68:71], v[168:171]
    ds_read_b128 a[204:207], v211 offset:1024
    ds_read_b128 a[208:211], v210 offset:4096
    v_mfma_f32_16x16x32_bf16 v[168:171], a[220:223], v[72:75], v[168:171]
    s_waitcnt lgkmcnt(5)
    v_exp_f32 v159, v159
    v_mfma_f32_16x16x32_bf16 a[0:3], a[224:227], v[196:199], a[0:3]
    ds_read_b128 a[200:203], v210 offset:1024
    v_cvt_pk_bf16_f32 v189, v158, v159
    v_mfma_f32_16x16x32_bf16 a[4:7], a[228:231], v[196:199], a[4:7]
    v_exp_f32 v160, v160
    v_mfma_f32_16x16x32_bf16 a[8:11], a[232:235], v[196:199], a[8:11]
    ds_read_b128 a[216:219], v210 offset:5120
    ds_read_b128 a[220:223], v211 offset:5120
    v_mfma_f32_16x16x32_bf16 a[12:15], a[236:239], v[196:199], a[12:15]
    v_exp_f32 v161, v161
    v_mfma_f32_16x16x32_bf16 a[16:19], a[240:243], v[196:199], a[16:19]
    ds_read_b128 a[212:215], v211 offset:4096
    v_cvt_pk_bf16_f32 v190, v160, v161
    v_mfma_f32_16x16x32_bf16 a[20:23], a[244:247], v[196:199], a[20:23]
    v_exp_f32 v162, v162
    v_mfma_f32_16x16x32_bf16 a[24:27], a[248:251], v[196:199], a[24:27]
    s_waitcnt lgkmcnt(3)
    buffer_load_dwordx4 v2, s[8:11], s49 offen offset:1024 nt lds
    v_mfma_f32_16x16x32_bf16 a[28:31], a[252:255], v[196:199], a[28:31]
    v_exp_f32 v163, v163
    v_mfma_f32_16x16x32_bf16 a[32:35], a[224:227], v[200:203], a[32:35]
    v_cvt_pk_bf16_f32 v191, v162, v163
    v_add_f32 v133, v133, v177
    v_mfma_f32_16x16x32_bf16 a[36:39], a[228:231], v[200:203], a[36:39]
    v_exp_f32 v164, v164
    v_mfma_f32_16x16x32_bf16 a[40:43], a[232:235], v[200:203], a[40:43]
    buffer_load_dwordx4 v3, s[8:11], s49 offen offset:2048 nt lds
    v_mfma_f32_16x16x32_bf16 a[44:47], a[236:239], v[200:203], a[44:47]
    v_exp_f32 v165, v165
    v_mfma_f32_16x16x32_bf16 a[48:51], a[240:243], v[200:203], a[48:51]
    v_cvt_pk_bf16_f32 v192, v164, v165
    v_add_f32 v132, v132, v178
    v_mfma_f32_16x16x32_bf16 a[52:55], a[244:247], v[200:203], a[52:55]
    v_exp_f32 v166, v166
    v_mfma_f32_16x16x32_bf16 a[56:59], a[248:251], v[200:203], a[56:59]
    v_add_f32 v141, v141, v157
    v_add_f32 v140, v140, v158
    v_mfma_f32_16x16x32_bf16 a[60:63], a[252:255], v[200:203], a[60:63]
    v_exp_f32 v167, v167
    v_mfma_f32_16x16x32_bf16 v[136:139], v[228:231], v[200:203], v[136:139]
    v_cvt_pk_bf16_f32 v193, v166, v167
    v_add_f32 v140, v140, v156
    v_mfma_f32_16x16x32_bf16 v[172:175], a[192:195], v[12:15], v[108:111]
    v_exp_f32 v168, v168
    v_mfma_f32_16x16x32_bf16 v[172:175], a[196:199], v[16:19], v[172:175]
    buffer_load_dwordx4 v4, s[8:11], s49 offen offset:3072 nt lds
    v_mfma_f32_16x16x32_bf16 v[172:175], a[200:203], v[20:23], v[172:175]
    v_exp_f32 v169, v169
    v_mfma_f32_16x16x32_bf16 v[172:175], a[204:207], v[24:27], v[172:175]
    v_cvt_pk_bf16_f32 v194, v168, v169
    v_add_f32 v141, v141, v159
    v_mfma_f32_16x16x32_bf16 v[176:179], a[208:211], v[12:15], v[108:111]
    s_waitcnt lgkmcnt(0)
    v_exp_f32 v170, v170
    v_mfma_f32_16x16x32_bf16 v[176:179], a[212:215], v[16:19], v[176:179]
    v_add_f32 v141, v141, v161
    v_add_f32 v140, v140, v162
    v_mfma_f32_16x16x32_bf16 v[176:179], a[216:219], v[20:23], v[176:179]
    v_exp_f32 v171, v171
    v_mfma_f32_16x16x32_bf16 v[176:179], a[220:223], v[24:27], v[176:179]
    v_cvt_pk_bf16_f32 v195, v170, v171
    v_add_f32 v140, v140, v160
    v_mfma_f32_16x16x32_bf16 v[180:183], a[192:195], v[28:31], v[112:115]
    v_add_f32 v141, v141, v163
    v_mfma_f32_16x16x32_bf16 v[180:183], a[196:199], v[32:35], v[180:183]
    s_mov_b32 s100, s67
    s_cmp_eq_u32 s67, s86
    s_cselect_b32 s69, s66, s65
    v_exp_f32 v172, v172
    v_mfma_f32_16x16x32_bf16 v[180:183], a[200:203], v[36:39], v[180:183]
    s_add_u32 s67, s67, s69
    v_add_f32 v132, v132, v172
    v_mfma_f32_16x16x32_bf16 v[180:183], a[204:207], v[40:43], v[180:183]
    v_exp_f32 v173, v173
    v_mfma_f32_16x16x32_bf16 v[184:187], a[208:211], v[28:31], v[112:115]
    v_cvt_pk_bf16_f32 v196, v172, v173
    v_add_u32 v204, s69, v204
    v_mfma_f32_16x16x32_bf16 v[184:187], a[212:215], v[32:35], v[184:187]
    v_exp_f32 v174, v174
    v_mfma_f32_16x16x32_bf16 v[184:187], a[216:219], v[36:39], v[184:187]
    v_add_u32 v206, s69, v206
    v_add_u32 v207, s69, v207
    v_mfma_f32_16x16x32_bf16 v[184:187], a[220:223], v[40:43], v[184:187]
    v_exp_f32 v175, v175
    v_mfma_f32_16x16x32_bf16 a[64:67], a[224:227], v[188:191], a[64:67]
    v_cvt_pk_bf16_f32 v197, v174, v175
    v_add_u32 v205, s69, v205
    v_mfma_f32_16x16x32_bf16 a[68:71], a[228:231], v[188:191], a[68:71]
    v_exp_f32 v176, v176
    v_mfma_f32_16x16x32_bf16 a[72:75], a[232:235], v[188:191], a[72:75]
    v_add_u32 v209, s69, v209
    v_add_u32 v210, s69, v210
    v_mfma_f32_16x16x32_bf16 a[76:79], a[236:239], v[188:191], a[76:79]
    v_exp_f32 v177, v177
    v_mfma_f32_16x16x32_bf16 a[80:83], a[240:243], v[188:191], a[80:83]
    v_cvt_pk_bf16_f32 v198, v176, v177
    v_add_u32 v208, s69, v208
    v_mfma_f32_16x16x32_bf16 a[84:87], a[244:247], v[188:191], a[84:87]
    v_exp_f32 v178, v178
    v_mfma_f32_16x16x32_bf16 a[88:91], a[248:251], v[188:191], a[88:91]
    v_add_u32 v211, s69, v211
    v_add_f32 v133, v133, v173
    v_add_f32 v132, v132, v178
    v_mfma_f32_16x16x32_bf16 a[92:95], a[252:255], v[188:191], a[92:95]
    v_exp_f32 v179, v179
    v_mfma_f32_16x16x32_bf16 a[96:99], a[224:227], v[192:195], a[96:99]
    ds_read_b64_tr_b16 a[224:225], v224 offset:0
    v_cvt_pk_bf16_f32 v199, v178, v179
    v_add_f32 v133, v133, v179
    v_mfma_f32_16x16x32_bf16 a[100:103], a[228:231], v[192:195], a[100:103]
    v_exp_f32 v180, v180
    v_mfma_f32_16x16x32_bf16 a[104:107], a[232:235], v[192:195], a[104:107]
    ds_read_b64_tr_b16 a[228:229], v225 offset:0
    ds_read_b64_tr_b16 a[230:231], v225 offset:4096
    v_mfma_f32_16x16x32_bf16 a[108:111], a[236:239], v[192:195], a[108:111]
    v_exp_f32 v181, v181
    v_mfma_f32_16x16x32_bf16 a[112:115], a[240:243], v[192:195], a[112:115]
    ds_read_b64_tr_b16 a[226:227], v224 offset:4096
    v_cvt_pk_bf16_f32 v200, v180, v181
    v_mfma_f32_16x16x32_bf16 a[116:119], a[244:247], v[192:195], a[116:119]
    v_exp_f32 v182, v182
    v_mfma_f32_16x16x32_bf16 a[120:123], a[248:251], v[192:195], a[120:123]
    ds_read_b64_tr_b16 a[234:235], v226 offset:4096
    ds_read_b64_tr_b16 a[236:237], v227 offset:0
    v_mfma_f32_16x16x32_bf16 a[124:127], a[252:255], v[192:195], a[124:127]
    v_exp_f32 v183, v183
    v_mfma_f32_16x16x32_bf16 v[144:147], v[228:231], v[192:195], v[144:147]
    ds_read_b64_tr_b16 a[232:233], v226 offset:0
    v_cvt_pk_bf16_f32 v201, v182, v183
    v_mfma_f32_16x16x32_bf16 v[156:159], a[192:195], v[44:47], v[116:119]
    v_exp_f32 v184, v184
    v_mfma_f32_16x16x32_bf16 v[156:159], a[196:199], v[48:51], v[156:159]
    ds_read_b64_tr_b16 a[240:241], v224 offset:1024
    ds_read_b64_tr_b16 a[242:243], v224 offset:5120
    v_mfma_f32_16x16x32_bf16 v[156:159], a[200:203], v[52:55], v[156:159]
    v_exp_f32 v185, v185
    v_mfma_f32_16x16x32_bf16 v[156:159], a[204:207], v[56:59], v[156:159]
    ds_read_b64_tr_b16 a[238:239], v227 offset:4096
    v_cvt_pk_bf16_f32 v202, v184, v185
    v_mfma_f32_16x16x32_bf16 v[160:163], a[208:211], v[44:47], v[116:119]
    v_exp_f32 v186, v186
    v_mfma_f32_16x16x32_bf16 v[160:163], a[212:215], v[48:51], v[160:163]
    ds_read_b64_tr_b16 a[246:247], v225 offset:5120
    ds_read_b64_tr_b16 a[248:249], v226 offset:1024
    v_mfma_f32_16x16x32_bf16 v[160:163], a[216:219], v[52:55], v[160:163]
    v_exp_f32 v187, v187
    v_mfma_f32_16x16x32_bf16 v[160:163], a[220:223], v[56:59], v[160:163]
    ds_read_b64_tr_b16 a[244:245], v225 offset:1024
    v_cvt_pk_bf16_f32 v203, v186, v187
    v_mfma_f32_16x16x32_bf16 v[164:167], a[192:195], v[60:63], v[120:123]
    ds_read_b64_tr_b16 a[250:251], v226 offset:5120
    ds_read_b64_tr_b16 a[252:253], v227 offset:1024
    v_mfma_f32_16x16x32_bf16 v[164:167], a[196:199], v[64:67], v[164:167]
    v_exp_f32 v156, v156
    v_mfma_f32_16x16x32_bf16 v[164:167], a[200:203], v[68:71], v[164:167]
    ds_read_b64_tr_b16 a[254:255], v227 offset:5120
    v_add_f32 v132, v132, v174
    v_mfma_f32_16x16x32_bf16 v[164:167], a[204:207], v[72:75], v[164:167]
    v_exp_f32 v157, v157
    v_mfma_f32_16x16x32_bf16 v[168:171], a[208:211], v[60:63], v[120:123]
    v_cvt_pk_bf16_f32 v188, v156, v157
    v_add_f32 v133, v133, v175
    v_mfma_f32_16x16x32_bf16 v[168:171], a[212:215], v[64:67], v[168:171]
    v_exp_f32 v158, v158
    v_mfma_f32_16x16x32_bf16 v[168:171], a[216:219], v[68:71], v[168:171]
    v_add_f32 v132, v132, v176
    v_add_f32 v133, v133, v177
    v_mfma_f32_16x16x32_bf16 v[168:171], a[220:223], v[72:75], v[168:171]
    s_waitcnt lgkmcnt(1)
    v_exp_f32 v159, v159
    v_mfma_f32_16x16x32_bf16 a[0:3], a[224:227], v[196:199], a[0:3]
    s_waitcnt vmcnt(8) lgkmcnt(0)
    s_barrier
    ds_read_b128 a[192:195], v204 offset:0
    v_cvt_pk_bf16_f32 v189, v158, v159
    v_mfma_f32_16x16x32_bf16 a[4:7], a[228:231], v[196:199], a[4:7]
    s_mov_b32 s68, s100
    v_exp_f32 v160, v160
    v_mfma_f32_16x16x32_bf16 a[8:11], a[232:235], v[196:199], a[8:11]
    ds_read_b128 a[200:203], v204 offset:1024
    ds_read_b128 a[204:207], v205 offset:1024
    v_mfma_f32_16x16x32_bf16 a[12:15], a[236:239], v[196:199], a[12:15]
    v_exp_f32 v161, v161
    v_mfma_f32_16x16x32_bf16 a[16:19], a[240:243], v[196:199], a[16:19]
    ds_read_b128 a[196:199], v205 offset:0
    v_cvt_pk_bf16_f32 v190, v160, v161
    v_mfma_f32_16x16x32_bf16 a[20:23], a[244:247], v[196:199], a[20:23]
    v_exp_f32 v162, v162
    v_mfma_f32_16x16x32_bf16 a[24:27], a[248:251], v[196:199], a[24:27]
    ds_read_b128 a[212:215], v205 offset:4096
    ds_read_b128 a[216:219], v204 offset:5120
    v_mfma_f32_16x16x32_bf16 a[28:31], a[252:255], v[196:199], a[28:31]
    v_exp_f32 v163, v163
    v_mfma_f32_16x16x32_bf16 a[32:35], a[224:227], v[200:203], a[32:35]
    ds_read_b128 a[208:211], v204 offset:4096
    v_cvt_pk_bf16_f32 v191, v162, v163
    v_mfma_f32_16x16x32_bf16 a[36:39], a[228:231], v[200:203], a[36:39]
    s_add_u32 s50, s50, s53
    s_add_u32 s51, s51, s53
    s_and_b32 s50, s50, s33
    s_and_b32 s51, s51, s33
    s_mov_b32 m0, s54
    v_exp_f32 v164, v164
    v_mfma_f32_16x16x32_bf16 a[40:43], a[232:235], v[200:203], a[40:43]
    buffer_load_dwordx4 v5, s[12:15], s50 offen nt lds
    v_mfma_f32_16x16x32_bf16 a[44:47], a[236:239], v[200:203], a[44:47]
    v_exp_f32 v165, v165
    v_mfma_f32_16x16x32_bf16 a[48:51], a[240:243], v[200:203], a[48:51]
    ds_read_b128 a[220:223], v205 offset:5120
    v_cvt_pk_bf16_f32 v192, v164, v165
    v_mfma_f32_16x16x32_bf16 a[52:55], a[244:247], v[200:203], a[52:55]
    v_exp_f32 v166, v166
    v_mfma_f32_16x16x32_bf16 a[56:59], a[248:251], v[200:203], a[56:59]
    v_add_f32 v141, v141, v157
    v_add_f32 v140, v140, v158
    v_mfma_f32_16x16x32_bf16 a[60:63], a[252:255], v[200:203], a[60:63]
    v_exp_f32 v167, v167
    v_mfma_f32_16x16x32_bf16 v[136:139], v[228:231], v[200:203], v[136:139]
    s_waitcnt lgkmcnt(1)
    v_cvt_pk_bf16_f32 v193, v166, v167
    v_add_f32 v140, v140, v156
    v_mfma_f32_16x16x32_bf16 v[172:175], a[192:195], v[12:15], v[108:111]
    v_exp_f32 v168, v168
    v_mfma_f32_16x16x32_bf16 v[172:175], a[196:199], v[16:19], v[172:175]
    buffer_load_dwordx4 v6, s[12:15], s50 offen offset:1024 nt lds
    v_mfma_f32_16x16x32_bf16 v[172:175], a[200:203], v[20:23], v[172:175]
    v_exp_f32 v169, v169
    v_mfma_f32_16x16x32_bf16 v[172:175], a[204:207], v[24:27], v[172:175]
    v_cvt_pk_bf16_f32 v194, v168, v169
    v_add_f32 v141, v141, v159
    v_mfma_f32_16x16x32_bf16 v[176:179], a[208:211], v[12:15], v[108:111]
    v_exp_f32 v170, v170
    v_mfma_f32_16x16x32_bf16 v[176:179], a[212:215], v[16:19], v[176:179]
    v_add_f32 v141, v141, v161
    v_add_f32 v140, v140, v162
    v_mfma_f32_16x16x32_bf16 v[176:179], a[216:219], v[20:23], v[176:179]
    s_waitcnt lgkmcnt(0)
    v_exp_f32 v171, v171
    v_mfma_f32_16x16x32_bf16 v[176:179], a[220:223], v[24:27], v[176:179]
    v_cvt_pk_bf16_f32 v195, v170, v171
    v_add_f32 v140, v140, v160
    v_mfma_f32_16x16x32_bf16 v[180:183], a[192:195], v[28:31], v[112:115]
    v_add_f32 v141, v141, v163
    v_mfma_f32_16x16x32_bf16 v[180:183], a[196:199], v[32:35], v[180:183]
    v_exp_f32 v172, v172
    v_mfma_f32_16x16x32_bf16 v[180:183], a[200:203], v[36:39], v[180:183]
    v_mfma_f32_16x16x32_bf16 v[180:183], a[204:207], v[40:43], v[180:183]
    v_exp_f32 v173, v173
    v_mfma_f32_16x16x32_bf16 v[184:187], a[208:211], v[28:31], v[112:115]
    v_cvt_pk_bf16_f32 v196, v172, v173
    v_add_f32 v132, v132, v172
    v_mfma_f32_16x16x32_bf16 v[184:187], a[212:215], v[32:35], v[184:187]
    v_exp_f32 v174, v174
    v_mfma_f32_16x16x32_bf16 v[184:187], a[216:219], v[36:39], v[184:187]
    v_add_f32 v132, v132, v174
    v_mfma_f32_16x16x32_bf16 v[184:187], a[220:223], v[40:43], v[184:187]
    v_exp_f32 v175, v175
    v_mfma_f32_16x16x32_bf16 a[64:67], a[224:227], v[188:191], a[64:67]
    v_cvt_pk_bf16_f32 v197, v174, v175
    v_add_f32 v133, v133, v173
    v_mfma_f32_16x16x32_bf16 a[68:71], a[228:231], v[188:191], a[68:71]
    v_exp_f32 v176, v176
    v_mfma_f32_16x16x32_bf16 a[72:75], a[232:235], v[188:191], a[72:75]
    buffer_load_dwordx4 v7, s[12:15], s50 offen offset:2048 nt lds
    v_mfma_f32_16x16x32_bf16 a[76:79], a[236:239], v[188:191], a[76:79]
    v_exp_f32 v177, v177
    v_mfma_f32_16x16x32_bf16 a[80:83], a[240:243], v[188:191], a[80:83]
    v_cvt_pk_bf16_f32 v198, v176, v177
    v_add_f32 v133, v133, v175
    v_mfma_f32_16x16x32_bf16 a[84:87], a[244:247], v[188:191], a[84:87]
    v_exp_f32 v178, v178
    v_mfma_f32_16x16x32_bf16 a[88:91], a[248:251], v[188:191], a[88:91]
    v_add_f32 v132, v132, v176
    v_add_f32 v133, v133, v177
    v_mfma_f32_16x16x32_bf16 a[92:95], a[252:255], v[188:191], a[92:95]
    v_exp_f32 v179, v179
    v_mfma_f32_16x16x32_bf16 a[96:99], a[224:227], v[192:195], a[96:99]
    ds_read_b64_tr_b16 a[224:225], v212 offset:32768
    v_cvt_pk_bf16_f32 v199, v178, v179
    v_mfma_f32_16x16x32_bf16 a[100:103], a[228:231], v[192:195], a[100:103]
    v_exp_f32 v180, v180
    v_mfma_f32_16x16x32_bf16 a[104:107], a[232:235], v[192:195], a[104:107]
    ds_read_b64_tr_b16 a[228:229], v213 offset:32768
    ds_read_b64_tr_b16 a[230:231], v213 offset:36864
    v_mfma_f32_16x16x32_bf16 a[108:111], a[236:239], v[192:195], a[108:111]
    v_exp_f32 v181, v181
    v_mfma_f32_16x16x32_bf16 a[112:115], a[240:243], v[192:195], a[112:115]
    ds_read_b64_tr_b16 a[226:227], v212 offset:36864
    v_cvt_pk_bf16_f32 v200, v180, v181
    v_mfma_f32_16x16x32_bf16 a[116:119], a[244:247], v[192:195], a[116:119]
    v_exp_f32 v182, v182
    v_mfma_f32_16x16x32_bf16 a[120:123], a[248:251], v[192:195], a[120:123]
    ds_read_b64_tr_b16 a[234:235], v214 offset:36864
    ds_read_b64_tr_b16 a[236:237], v215 offset:32768
    v_mfma_f32_16x16x32_bf16 a[124:127], a[252:255], v[192:195], a[124:127]
    v_exp_f32 v183, v183
    v_mfma_f32_16x16x32_bf16 v[144:147], v[228:231], v[192:195], v[144:147]
    ds_read_b64_tr_b16 a[232:233], v214 offset:32768
    v_cvt_pk_bf16_f32 v201, v182, v183
    v_mfma_f32_16x16x32_bf16 v[156:159], a[192:195], v[44:47], v[116:119]
    v_exp_f32 v184, v184
    v_mfma_f32_16x16x32_bf16 v[156:159], a[196:199], v[48:51], v[156:159]
    ds_read_b64_tr_b16 a[240:241], v212 offset:33792
    ds_read_b64_tr_b16 a[242:243], v212 offset:37888
    v_mfma_f32_16x16x32_bf16 v[156:159], a[200:203], v[52:55], v[156:159]
    v_exp_f32 v185, v185
    v_mfma_f32_16x16x32_bf16 v[156:159], a[204:207], v[56:59], v[156:159]
    ds_read_b64_tr_b16 a[238:239], v215 offset:36864
    v_cvt_pk_bf16_f32 v202, v184, v185
    v_mfma_f32_16x16x32_bf16 v[160:163], a[208:211], v[44:47], v[116:119]
    v_exp_f32 v186, v186
    v_mfma_f32_16x16x32_bf16 v[160:163], a[212:215], v[48:51], v[160:163]
    ds_read_b64_tr_b16 a[246:247], v213 offset:37888
    ds_read_b64_tr_b16 a[248:249], v214 offset:33792
    v_mfma_f32_16x16x32_bf16 v[160:163], a[216:219], v[52:55], v[160:163]
    v_exp_f32 v187, v187
    v_mfma_f32_16x16x32_bf16 v[160:163], a[220:223], v[56:59], v[160:163]
    ds_read_b64_tr_b16 a[244:245], v213 offset:33792
    v_cvt_pk_bf16_f32 v203, v186, v187
    v_mfma_f32_16x16x32_bf16 v[164:167], a[192:195], v[60:63], v[120:123]
    ds_read_b64_tr_b16 a[250:251], v214 offset:37888
    ds_read_b64_tr_b16 a[252:253], v215 offset:33792
    v_mfma_f32_16x16x32_bf16 v[164:167], a[196:199], v[64:67], v[164:167]
    v_exp_f32 v156, v156
    v_mfma_f32_16x16x32_bf16 v[164:167], a[200:203], v[68:71], v[164:167]
    buffer_load_dwordx4 v8, s[12:15], s50 offen offset:3072 nt lds
    v_mfma_f32_16x16x32_bf16 v[164:167], a[204:207], v[72:75], v[164:167]
    v_exp_f32 v157, v157
    v_mfma_f32_16x16x32_bf16 v[168:171], a[208:211], v[60:63], v[120:123]
    ds_read_b64_tr_b16 a[254:255], v215 offset:37888
    v_cvt_pk_bf16_f32 v188, v156, v157
    v_mfma_f32_16x16x32_bf16 v[168:171], a[212:215], v[64:67], v[168:171]
    v_exp_f32 v158, v158
    v_mfma_f32_16x16x32_bf16 v[168:171], a[216:219], v[68:71], v[168:171]
    v_add_f32 v133, v133, v179
    v_add_f32 v140, v140, v156
    v_mfma_f32_16x16x32_bf16 v[168:171], a[220:223], v[72:75], v[168:171]
    s_waitcnt lgkmcnt(1)
    v_exp_f32 v159, v159
    v_mfma_f32_16x16x32_bf16 a[0:3], a[224:227], v[196:199], a[0:3]
    v_cvt_pk_bf16_f32 v189, v158, v159
    v_add_f32 v132, v132, v178
    v_mfma_f32_16x16x32_bf16 a[4:7], a[228:231], v[196:199], a[4:7]
    s_mov_b32 m0, s55
    v_exp_f32 v160, v160
    v_mfma_f32_16x16x32_bf16 a[8:11], a[232:235], v[196:199], a[8:11]
    buffer_load_dwordx4 v5, s[12:15], s51 offen nt lds
    v_mfma_f32_16x16x32_bf16 a[12:15], a[236:239], v[196:199], a[12:15]
    v_exp_f32 v161, v161
    v_mfma_f32_16x16x32_bf16 a[16:19], a[240:243], v[196:199], a[16:19]
    v_cvt_pk_bf16_f32 v190, v160, v161
    v_add_f32 v141, v141, v157
    v_mfma_f32_16x16x32_bf16 a[20:23], a[244:247], v[196:199], a[20:23]
    v_exp_f32 v162, v162
    v_mfma_f32_16x16x32_bf16 a[24:27], a[248:251], v[196:199], a[24:27]
    s_waitcnt lgkmcnt(0)
    v_add_f32 v141, v141, v159
    v_add_f32 v140, v140, v160
    v_mfma_f32_16x16x32_bf16 a[28:31], a[252:255], v[196:199], a[28:31]
    v_exp_f32 v163, v163
    v_mfma_f32_16x16x32_bf16 a[32:35], a[224:227], v[200:203], a[32:35]
    v_cvt_pk_bf16_f32 v191, v162, v163
    v_add_f32 v140, v140, v158
    v_mfma_f32_16x16x32_bf16 a[36:39], a[228:231], v[200:203], a[36:39]
    v_exp_f32 v164, v164
    v_mfma_f32_16x16x32_bf16 a[40:43], a[232:235], v[200:203], a[40:43]
    v_add_f32 v140, v140, v162
    v_add_f32 v141, v141, v163
    v_mfma_f32_16x16x32_bf16 a[44:47], a[236:239], v[200:203], a[44:47]
    v_exp_f32 v165, v165
    v_mfma_f32_16x16x32_bf16 a[48:51], a[240:243], v[200:203], a[48:51]
    v_cvt_pk_bf16_f32 v192, v164, v165
    v_add_f32 v141, v141, v161
    v_mfma_f32_16x16x32_bf16 a[52:55], a[244:247], v[200:203], a[52:55]
    v_exp_f32 v166, v166
    v_mfma_f32_16x16x32_bf16 a[56:59], a[248:251], v[200:203], a[56:59]
    v_mfma_f32_16x16x32_bf16 a[60:63], a[252:255], v[200:203], a[60:63]
    v_exp_f32 v167, v167
    v_mfma_f32_16x16x32_bf16 v[136:139], v[228:231], v[200:203], v[136:139]
    v_cvt_pk_bf16_f32 v193, v166, v167
    v_mfma_f32_16x16x32_bf16 v[172:175], a[192:195], v[76:79], v[124:127]
    v_exp_f32 v168, v168
    v_mfma_f32_16x16x32_bf16 v[172:175], a[196:199], v[80:83], v[172:175]
    buffer_load_dwordx4 v6, s[12:15], s51 offen offset:1024 nt lds
    v_mfma_f32_16x16x32_bf16 v[172:175], a[200:203], v[84:87], v[172:175]
    v_exp_f32 v169, v169
    v_mfma_f32_16x16x32_bf16 v[172:175], a[204:207], v[88:91], v[172:175]
    v_cvt_pk_bf16_f32 v194, v168, v169
    v_mfma_f32_16x16x32_bf16 v[176:179], a[208:211], v[76:79], v[124:127]
    v_exp_f32 v170, v170
    v_mfma_f32_16x16x32_bf16 v[176:179], a[212:215], v[80:83], v[176:179]
    v_mfma_f32_16x16x32_bf16 v[176:179], a[216:219], v[84:87], v[176:179]
    v_exp_f32 v171, v171
    v_mfma_f32_16x16x32_bf16 v[176:179], a[220:223], v[88:91], v[176:179]
    v_cvt_pk_bf16_f32 v195, v170, v171
    v_mfma_f32_16x16x32_bf16 v[180:183], a[192:195], v[92:95], v[128:131]
    ds_read_b128 a[192:195], v206 offset:0
    v_mfma_f32_16x16x32_bf16 v[180:183], a[196:199], v[96:99], v[180:183]
    v_exp_f32 v172, v172
    v_mfma_f32_16x16x32_bf16 v[180:183], a[200:203], v[100:103], v[180:183]
    ds_read_b128 a[200:203], v206 offset:1024
    v_add_f32 v148, v148, v172
    v_mfma_f32_16x16x32_bf16 v[180:183], a[204:207], v[104:107], v[180:183]
    v_exp_f32 v173, v173
    v_mfma_f32_16x16x32_bf16 v[184:187], a[208:211], v[92:95], v[128:131]
    ds_read_b128 a[196:199], v207 offset:0
    v_cvt_pk_bf16_f32 v196, v172, v173
    v_mfma_f32_16x16x32_bf16 v[184:187], a[212:215], v[96:99], v[184:187]
    v_exp_f32 v174, v174
    v_mfma_f32_16x16x32_bf16 v[184:187], a[216:219], v[100:103], v[184:187]
    ds_read_b128 a[208:211], v206 offset:4096
    ds_read_b128 a[212:215], v207 offset:4096
    v_mfma_f32_16x16x32_bf16 v[184:187], a[220:223], v[104:107], v[184:187]
    v_exp_f32 v175, v175
    v_mfma_f32_16x16x32_bf16 a[64:67], a[224:227], v[188:191], a[64:67]
    ds_read_b128 a[204:207], v207 offset:1024
    v_cvt_pk_bf16_f32 v197, v174, v175
    v_mfma_f32_16x16x32_bf16 a[68:71], a[228:231], v[188:191], a[68:71]
    v_exp_f32 v176, v176
    v_mfma_f32_16x16x32_bf16 a[72:75], a[232:235], v[188:191], a[72:75]
    ds_read_b128 a[220:223], v207 offset:5120
    v_add_f32 v149, v149, v173
    v_mfma_f32_16x16x32_bf16 a[76:79], a[236:239], v[188:191], a[76:79]
    v_exp_f32 v177, v177
    v_mfma_f32_16x16x32_bf16 a[80:83], a[240:243], v[188:191], a[80:83]
    ds_read_b128 a[216:219], v206 offset:5120
    v_cvt_pk_bf16_f32 v198, v176, v177
    v_mfma_f32_16x16x32_bf16 a[84:87], a[244:247], v[188:191], a[84:87]
    v_exp_f32 v178, v178
    v_mfma_f32_16x16x32_bf16 a[88:91], a[248:251], v[188:191], a[88:91]
    buffer_load_dwordx4 v7, s[12:15], s51 offen offset:2048 nt lds
    v_mfma_f32_16x16x32_bf16 a[92:95], a[252:255], v[188:191], a[92:95]
    v_exp_f32 v179, v179
    v_mfma_f32_16x16x32_bf16 a[96:99], a[224:227], v[192:195], a[96:99]
    v_cvt_pk_bf16_f32 v199, v178, v179
    v_add_f32 v148, v148, v174
    v_mfma_f32_16x16x32_bf16 a[100:103], a[228:231], v[192:195], a[100:103]
    v_exp_f32 v180, v180
    v_mfma_f32_16x16x32_bf16 a[104:107], a[232:235], v[192:195], a[104:107]
    v_add_f32 v148, v148, v176
    v_add_f32 v149, v149, v177
    v_mfma_f32_16x16x32_bf16 a[108:111], a[236:239], v[192:195], a[108:111]
    v_exp_f32 v181, v181
    v_mfma_f32_16x16x32_bf16 a[112:115], a[240:243], v[192:195], a[112:115]
    v_cvt_pk_bf16_f32 v200, v180, v181
    v_add_f32 v149, v149, v175
    v_mfma_f32_16x16x32_bf16 a[116:119], a[244:247], v[192:195], a[116:119]
    v_exp_f32 v182, v182
    v_mfma_f32_16x16x32_bf16 a[120:123], a[248:251], v[192:195], a[120:123]
    v_add_f32 v149, v149, v179
    v_mfma_f32_16x16x32_bf16 a[124:127], a[252:255], v[192:195], a[124:127]
    v_exp_f32 v183, v183
    v_mfma_f32_16x16x32_bf16 v[144:147], v[228:231], v[192:195], v[144:147]
    s_waitcnt lgkmcnt(0)
    v_cvt_pk_bf16_f32 v201, v182, v183
    v_add_f32 v148, v148, v178
    v_mfma_f32_16x16x32_bf16 v[156:159], a[192:195], v[12:15], v[108:111]
    v_exp_f32 v184, v184
    v_mfma_f32_16x16x32_bf16 v[156:159], a[196:199], v[16:19], v[156:159]
    buffer_load_dwordx4 v8, s[12:15], s51 offen offset:3072 nt lds
    v_mfma_f32_16x16x32_bf16 v[156:159], a[200:203], v[20:23], v[156:159]
    v_exp_f32 v185, v185
    v_mfma_f32_16x16x32_bf16 v[156:159], a[204:207], v[24:27], v[156:159]
    v_cvt_pk_bf16_f32 v202, v184, v185
    v_mfma_f32_16x16x32_bf16 v[160:163], a[208:211], v[12:15], v[108:111]
    v_exp_f32 v186, v186
    v_mfma_f32_16x16x32_bf16 v[160:163], a[212:215], v[16:19], v[160:163]
    v_mfma_f32_16x16x32_bf16 v[160:163], a[216:219], v[20:23], v[160:163]
    v_exp_f32 v187, v187
    v_mfma_f32_16x16x32_bf16 v[160:163], a[220:223], v[24:27], v[160:163]
    v_cvt_pk_bf16_f32 v203, v186, v187
    v_mfma_f32_16x16x32_bf16 v[164:167], a[192:195], v[28:31], v[112:115]
    v_mfma_f32_16x16x32_bf16 v[164:167], a[196:199], v[32:35], v[164:167]
    v_exp_f32 v156, v156
    v_mfma_f32_16x16x32_bf16 v[164:167], a[200:203], v[36:39], v[164:167]
    v_mfma_f32_16x16x32_bf16 v[164:167], a[204:207], v[40:43], v[164:167]
    v_exp_f32 v157, v157
    v_mfma_f32_16x16x32_bf16 v[168:171], a[208:211], v[28:31], v[112:115]
    v_cvt_pk_bf16_f32 v188, v156, v157
    v_add_f32 v132, v132, v156
    v_mfma_f32_16x16x32_bf16 v[168:171], a[212:215], v[32:35], v[168:171]
    v_exp_f32 v158, v158
    v_mfma_f32_16x16x32_bf16 v[168:171], a[216:219], v[36:39], v[168:171]
    v_add_f32 v132, v132, v158
    v_mfma_f32_16x16x32_bf16 v[168:171], a[220:223], v[40:43], v[168:171]
    v_exp_f32 v159, v159
    v_mfma_f32_16x16x32_bf16 a[128:131], a[224:227], v[196:199], a[128:131]
    v_cvt_pk_bf16_f32 v189, v158, v159
    v_add_f32 v133, v133, v157
    v_mfma_f32_16x16x32_bf16 a[132:135], a[228:231], v[196:199], a[132:135]
    s_add_u32 s48, s48, s52
    s_add_u32 s49, s49, s52
    s_and_b32 s48, s48, s32
    s_and_b32 s49, s49, s32
    s_mov_b32 m0, s68
    v_exp_f32 v160, v160
    v_mfma_f32_16x16x32_bf16 a[136:139], a[232:235], v[196:199], a[136:139]
    buffer_load_dwordx4 v1, s[8:11], s48 offen nt lds
    v_mfma_f32_16x16x32_bf16 a[140:143], a[236:239], v[196:199], a[140:143]
    v_exp_f32 v161, v161
    v_mfma_f32_16x16x32_bf16 a[144:147], a[240:243], v[196:199], a[144:147]
    v_cvt_pk_bf16_f32 v190, v160, v161
    v_add_f32 v133, v133, v159
    v_mfma_f32_16x16x32_bf16 a[148:151], a[244:247], v[196:199], a[148:151]
    v_exp_f32 v162, v162
    v_mfma_f32_16x16x32_bf16 a[152:155], a[248:251], v[196:199], a[152:155]
    v_add_f32 v132, v132, v160
    v_add_f32 v133, v133, v161
    v_mfma_f32_16x16x32_bf16 a[156:159], a[252:255], v[196:199], a[156:159]
    v_exp_f32 v163, v163
    v_mfma_f32_16x16x32_bf16 a[160:163], a[224:227], v[200:203], a[160:163]
    ds_read_b64_tr_b16 a[224:225], v216 offset:32768
    v_cvt_pk_bf16_f32 v191, v162, v163
    v_mfma_f32_16x16x32_bf16 a[164:167], a[228:231], v[200:203], a[164:167]
    v_exp_f32 v164, v164
    v_mfma_f32_16x16x32_bf16 a[168:171], a[232:235], v[200:203], a[168:171]
    ds_read_b64_tr_b16 a[228:229], v217 offset:32768
    ds_read_b64_tr_b16 a[230:231], v217 offset:36864
    v_mfma_f32_16x16x32_bf16 a[172:175], a[236:239], v[200:203], a[172:175]
    v_exp_f32 v165, v165
    v_mfma_f32_16x16x32_bf16 a[176:179], a[240:243], v[200:203], a[176:179]
    ds_read_b64_tr_b16 a[226:227], v216 offset:36864
    v_cvt_pk_bf16_f32 v192, v164, v165
    v_mfma_f32_16x16x32_bf16 a[180:183], a[244:247], v[200:203], a[180:183]
    v_exp_f32 v166, v166
    v_mfma_f32_16x16x32_bf16 a[184:187], a[248:251], v[200:203], a[184:187]
    ds_read_b64_tr_b16 a[234:235], v218 offset:36864
    ds_read_b64_tr_b16 a[236:237], v219 offset:32768
    v_mfma_f32_16x16x32_bf16 a[188:191], a[252:255], v[200:203], a[188:191]
    v_exp_f32 v167, v167
    v_mfma_f32_16x16x32_bf16 v[152:155], v[228:231], v[200:203], v[152:155]
    ds_read_b64_tr_b16 a[232:233], v218 offset:32768
    v_cvt_pk_bf16_f32 v193, v166, v167
    v_mfma_f32_16x16x32_bf16 v[172:175], a[192:195], v[44:47], v[116:119]
    v_exp_f32 v168, v168
    v_mfma_f32_16x16x32_bf16 v[172:175], a[196:199], v[48:51], v[172:175]
    ds_read_b64_tr_b16 a[240:241], v216 offset:33792
    ds_read_b64_tr_b16 a[242:243], v216 offset:37888
    v_mfma_f32_16x16x32_bf16 v[172:175], a[200:203], v[52:55], v[172:175]
    v_exp_f32 v169, v169
    v_mfma_f32_16x16x32_bf16 v[172:175], a[204:207], v[56:59], v[172:175]
    ds_read_b64_tr_b16 a[238:239], v219 offset:36864
    v_cvt_pk_bf16_f32 v194, v168, v169
    v_mfma_f32_16x16x32_bf16 v[176:179], a[208:211], v[44:47], v[116:119]
    v_exp_f32 v170, v170
    v_mfma_f32_16x16x32_bf16 v[176:179], a[212:215], v[48:51], v[176:179]
    ds_read_b64_tr_b16 a[246:247], v217 offset:37888
    ds_read_b64_tr_b16 a[248:249], v218 offset:33792
    v_mfma_f32_16x16x32_bf16 v[176:179], a[216:219], v[52:55], v[176:179]
    v_exp_f32 v171, v171
    v_mfma_f32_16x16x32_bf16 v[176:179], a[220:223], v[56:59], v[176:179]
    ds_read_b64_tr_b16 a[244:245], v217 offset:33792
    v_cvt_pk_bf16_f32 v195, v170, v171
    v_mfma_f32_16x16x32_bf16 v[180:183], a[192:195], v[60:63], v[120:123]
    ds_read_b64_tr_b16 a[250:251], v218 offset:37888
    ds_read_b64_tr_b16 a[252:253], v219 offset:33792
    v_mfma_f32_16x16x32_bf16 v[180:183], a[196:199], v[64:67], v[180:183]
    v_exp_f32 v172, v172
    v_mfma_f32_16x16x32_bf16 v[180:183], a[200:203], v[68:71], v[180:183]
    ds_read_b128 a[192:195], v208 offset:0
    ds_read_b128 a[196:199], v209 offset:0
    v_mfma_f32_16x16x32_bf16 v[180:183], a[204:207], v[72:75], v[180:183]
    v_exp_f32 v173, v173
    v_mfma_f32_16x16x32_bf16 v[184:187], a[208:211], v[60:63], v[120:123]
    ds_read_b64_tr_b16 a[254:255], v219 offset:37888
    v_cvt_pk_bf16_f32 v196, v172, v173
    v_mfma_f32_16x16x32_bf16 v[184:187], a[212:215], v[64:67], v[184:187]
    v_exp_f32 v174, v174
    v_mfma_f32_16x16x32_bf16 v[184:187], a[216:219], v[68:71], v[184:187]
    ds_read_b128 a[204:207], v209 offset:1024
    ds_read_b128 a[208:211], v208 offset:4096
    v_mfma_f32_16x16x32_bf16 v[184:187], a[220:223], v[72:75], v[184:187]
    s_waitcnt lgkmcnt(5)
    v_exp_f32 v175, v175
    v_mfma_f32_16x16x32_bf16 a[0:3], a[224:227], v[188:191], a[0:3]
    ds_read_b128 a[200:203], v208 offset:1024
    v_cvt_pk_bf16_f32 v197, v174, v175
    v_mfma_f32_16x16x32_bf16 a[4:7], a[228:231], v[188:191], a[4:7]
    v_exp_f32 v176, v176
    v_mfma_f32_16x16x32_bf16 a[8:11], a[232:235], v[188:191], a[8:11]
    ds_read_b128 a[216:219], v208 offset:5120
    ds_read_b128 a[220:223], v209 offset:5120
    v_mfma_f32_16x16x32_bf16 a[12:15], a[236:239], v[188:191], a[12:15]
    v_exp_f32 v177, v177
    v_mfma_f32_16x16x32_bf16 a[16:19], a[240:243], v[188:191], a[16:19]
    ds_read_b128 a[212:215], v209 offset:4096
    v_cvt_pk_bf16_f32 v198, v176, v177
    v_mfma_f32_16x16x32_bf16 a[20:23], a[244:247], v[188:191], a[20:23]
    v_exp_f32 v178, v178
    v_mfma_f32_16x16x32_bf16 a[24:27], a[248:251], v[188:191], a[24:27]
    s_waitcnt lgkmcnt(3)
    buffer_load_dwordx4 v2, s[8:11], s48 offen offset:1024 nt lds
    v_mfma_f32_16x16x32_bf16 a[28:31], a[252:255], v[188:191], a[28:31]
    v_exp_f32 v179, v179
    v_mfma_f32_16x16x32_bf16 a[32:35], a[224:227], v[192:195], a[32:35]
    v_cvt_pk_bf16_f32 v199, v178, v179
    v_add_f32 v132, v132, v162
    v_mfma_f32_16x16x32_bf16 a[36:39], a[228:231], v[192:195], a[36:39]
    v_exp_f32 v180, v180
    v_mfma_f32_16x16x32_bf16 a[40:43], a[232:235], v[192:195], a[40:43]
    buffer_load_dwordx4 v3, s[8:11], s48 offen offset:2048 nt lds
    v_mfma_f32_16x16x32_bf16 a[44:47], a[236:239], v[192:195], a[44:47]
    v_exp_f32 v181, v181
    v_mfma_f32_16x16x32_bf16 a[48:51], a[240:243], v[192:195], a[48:51]
    v_cvt_pk_bf16_f32 v200, v180, v181
    v_add_f32 v133, v133, v163
    v_mfma_f32_16x16x32_bf16 a[52:55], a[244:247], v[192:195], a[52:55]
    v_exp_f32 v182, v182
    v_mfma_f32_16x16x32_bf16 a[56:59], a[248:251], v[192:195], a[56:59]
    v_add_f32 v141, v141, v173
    v_add_f32 v140, v140, v174
    v_mfma_f32_16x16x32_bf16 a[60:63], a[252:255], v[192:195], a[60:63]
    v_exp_f32 v183, v183
    v_mfma_f32_16x16x32_bf16 v[136:139], v[228:231], v[192:195], v[136:139]
    v_cvt_pk_bf16_f32 v201, v182, v183
    v_add_f32 v140, v140, v172
    v_mfma_f32_16x16x32_bf16 v[156:159], a[192:195], v[12:15], v[108:111]
    v_exp_f32 v184, v184
    v_mfma_f32_16x16x32_bf16 v[156:159], a[196:199], v[16:19], v[156:159]
    buffer_load_dwordx4 v4, s[8:11], s48 offen offset:3072 nt lds
    v_mfma_f32_16x16x32_bf16 v[156:159], a[200:203], v[20:23], v[156:159]
    v_exp_f32 v185, v185
    v_mfma_f32_16x16x32_bf16 v[156:159], a[204:207], v[24:27], v[156:159]
    v_cvt_pk_bf16_f32 v202, v184, v185
    v_add_f32 v141, v141, v175
    v_mfma_f32_16x16x32_bf16 v[160:163], a[208:211], v[12:15], v[108:111]
    s_waitcnt lgkmcnt(0)
    v_exp_f32 v186, v186
    v_mfma_f32_16x16x32_bf16 v[160:163], a[212:215], v[16:19], v[160:163]
    v_add_f32 v141, v141, v177
    v_add_f32 v140, v140, v178
    v_mfma_f32_16x16x32_bf16 v[160:163], a[216:219], v[20:23], v[160:163]
    v_exp_f32 v187, v187
    v_mfma_f32_16x16x32_bf16 v[160:163], a[220:223], v[24:27], v[160:163]
    v_cvt_pk_bf16_f32 v203, v186, v187
    v_add_f32 v140, v140, v176
    v_mfma_f32_16x16x32_bf16 v[164:167], a[192:195], v[28:31], v[112:115]
    v_add_f32 v141, v141, v179
    v_mfma_f32_16x16x32_bf16 v[164:167], a[196:199], v[32:35], v[164:167]
    v_exp_f32 v156, v156
    v_mfma_f32_16x16x32_bf16 v[164:167], a[200:203], v[36:39], v[164:167]
    v_mfma_f32_16x16x32_bf16 v[164:167], a[204:207], v[40:43], v[164:167]
    v_exp_f32 v157, v157
    v_mfma_f32_16x16x32_bf16 v[168:171], a[208:211], v[28:31], v[112:115]
    v_cvt_pk_bf16_f32 v188, v156, v157
    v_add_f32 v132, v132, v156
    v_mfma_f32_16x16x32_bf16 v[168:171], a[212:215], v[32:35], v[168:171]
    v_exp_f32 v158, v158
    v_mfma_f32_16x16x32_bf16 v[168:171], a[216:219], v[36:39], v[168:171]
    v_add_f32 v132, v132, v158
    v_mfma_f32_16x16x32_bf16 v[168:171], a[220:223], v[40:43], v[168:171]
    v_exp_f32 v159, v159
    v_mfma_f32_16x16x32_bf16 a[64:67], a[224:227], v[196:199], a[64:67]
    v_cvt_pk_bf16_f32 v189, v158, v159
    v_add_f32 v133, v133, v157
    v_mfma_f32_16x16x32_bf16 a[68:71], a[228:231], v[196:199], a[68:71]
    s_add_u32 m0, s68, 4096
    v_exp_f32 v160, v160
    v_mfma_f32_16x16x32_bf16 a[72:75], a[232:235], v[196:199], a[72:75]
    buffer_load_dwordx4 v1, s[8:11], s49 offen nt lds
    v_mfma_f32_16x16x32_bf16 a[76:79], a[236:239], v[196:199], a[76:79]
    v_exp_f32 v161, v161
    v_mfma_f32_16x16x32_bf16 a[80:83], a[240:243], v[196:199], a[80:83]
    v_cvt_pk_bf16_f32 v190, v160, v161
    v_add_f32 v133, v133, v159
    v_mfma_f32_16x16x32_bf16 a[84:87], a[244:247], v[196:199], a[84:87]
    v_exp_f32 v162, v162
    v_mfma_f32_16x16x32_bf16 a[88:91], a[248:251], v[196:199], a[88:91]
    v_add_f32 v132, v132, v160
    v_add_f32 v133, v133, v161
    v_mfma_f32_16x16x32_bf16 a[92:95], a[252:255], v[196:199], a[92:95]
    v_exp_f32 v163, v163
    v_mfma_f32_16x16x32_bf16 a[96:99], a[224:227], v[200:203], a[96:99]
    ds_read_b64_tr_b16 a[224:225], v220 offset:32768
    v_cvt_pk_bf16_f32 v191, v162, v163
    v_mfma_f32_16x16x32_bf16 a[100:103], a[228:231], v[200:203], a[100:103]
    v_exp_f32 v164, v164
    v_mfma_f32_16x16x32_bf16 a[104:107], a[232:235], v[200:203], a[104:107]
    ds_read_b64_tr_b16 a[228:229], v221 offset:32768
    ds_read_b64_tr_b16 a[230:231], v221 offset:36864
    v_mfma_f32_16x16x32_bf16 a[108:111], a[236:239], v[200:203], a[108:111]
    v_exp_f32 v165, v165
    v_mfma_f32_16x16x32_bf16 a[112:115], a[240:243], v[200:203], a[112:115]
    ds_read_b64_tr_b16 a[226:227], v220 offset:36864
    v_cvt_pk_bf16_f32 v192, v164, v165
    v_mfma_f32_16x16x32_bf16 a[116:119], a[244:247], v[200:203], a[116:119]
    v_exp_f32 v166, v166
    v_mfma_f32_16x16x32_bf16 a[120:123], a[248:251], v[200:203], a[120:123]
    ds_read_b64_tr_b16 a[234:235], v222 offset:36864
    ds_read_b64_tr_b16 a[236:237], v223 offset:32768
    v_mfma_f32_16x16x32_bf16 a[124:127], a[252:255], v[200:203], a[124:127]
    v_exp_f32 v167, v167
    v_mfma_f32_16x16x32_bf16 v[144:147], v[228:231], v[200:203], v[144:147]
    ds_read_b64_tr_b16 a[232:233], v222 offset:32768
    v_cvt_pk_bf16_f32 v193, v166, v167
    v_mfma_f32_16x16x32_bf16 v[172:175], a[192:195], v[44:47], v[116:119]
    v_exp_f32 v168, v168
    v_mfma_f32_16x16x32_bf16 v[172:175], a[196:199], v[48:51], v[172:175]
    ds_read_b64_tr_b16 a[240:241], v220 offset:33792
    ds_read_b64_tr_b16 a[242:243], v220 offset:37888
    v_mfma_f32_16x16x32_bf16 v[172:175], a[200:203], v[52:55], v[172:175]
    v_exp_f32 v169, v169
    v_mfma_f32_16x16x32_bf16 v[172:175], a[204:207], v[56:59], v[172:175]
    ds_read_b64_tr_b16 a[238:239], v223 offset:36864
    v_cvt_pk_bf16_f32 v194, v168, v169
    v_mfma_f32_16x16x32_bf16 v[176:179], a[208:211], v[44:47], v[116:119]
    v_exp_f32 v170, v170
    v_mfma_f32_16x16x32_bf16 v[176:179], a[212:215], v[48:51], v[176:179]
    ds_read_b64_tr_b16 a[246:247], v221 offset:37888
    ds_read_b64_tr_b16 a[248:249], v222 offset:33792
    v_mfma_f32_16x16x32_bf16 v[176:179], a[216:219], v[52:55], v[176:179]
    v_exp_f32 v171, v171
    v_mfma_f32_16x16x32_bf16 v[176:179], a[220:223], v[56:59], v[176:179]
    ds_read_b64_tr_b16 a[244:245], v221 offset:33792
    v_cvt_pk_bf16_f32 v195, v170, v171
    v_mfma_f32_16x16x32_bf16 v[180:183], a[192:195], v[60:63], v[120:123]
    ds_read_b64_tr_b16 a[250:251], v222 offset:37888
    ds_read_b64_tr_b16 a[252:253], v223 offset:33792
    v_mfma_f32_16x16x32_bf16 v[180:183], a[196:199], v[64:67], v[180:183]
    v_exp_f32 v172, v172
    v_mfma_f32_16x16x32_bf16 v[180:183], a[200:203], v[68:71], v[180:183]
    ds_read_b128 a[192:195], v210 offset:0
    ds_read_b128 a[196:199], v211 offset:0
    v_mfma_f32_16x16x32_bf16 v[180:183], a[204:207], v[72:75], v[180:183]
    v_exp_f32 v173, v173
    v_mfma_f32_16x16x32_bf16 v[184:187], a[208:211], v[60:63], v[120:123]
    ds_read_b64_tr_b16 a[254:255], v223 offset:37888
    v_cvt_pk_bf16_f32 v196, v172, v173
    v_mfma_f32_16x16x32_bf16 v[184:187], a[212:215], v[64:67], v[184:187]
    v_exp_f32 v174, v174
    v_mfma_f32_16x16x32_bf16 v[184:187], a[216:219], v[68:71], v[184:187]
    ds_read_b128 a[204:207], v211 offset:1024
    ds_read_b128 a[208:211], v210 offset:4096
    v_mfma_f32_16x16x32_bf16 v[184:187], a[220:223], v[72:75], v[184:187]
    s_waitcnt lgkmcnt(5)
    v_exp_f32 v175, v175
    v_mfma_f32_16x16x32_bf16 a[0:3], a[224:227], v[188:191], a[0:3]
    ds_read_b128 a[200:203], v210 offset:1024
    v_cvt_pk_bf16_f32 v197, v174, v175
    v_mfma_f32_16x16x32_bf16 a[4:7], a[228:231], v[188:191], a[4:7]
    v_exp_f32 v176, v176
    v_mfma_f32_16x16x32_bf16 a[8:11], a[232:235], v[188:191], a[8:11]
    ds_read_b128 a[216:219], v210 offset:5120
    ds_read_b128 a[220:223], v211 offset:5120
    v_mfma_f32_16x16x32_bf16 a[12:15], a[236:239], v[188:191], a[12:15]
    v_exp_f32 v177, v177
    v_mfma_f32_16x16x32_bf16 a[16:19], a[240:243], v[188:191], a[16:19]
    ds_read_b128 a[212:215], v211 offset:4096
    v_cvt_pk_bf16_f32 v198, v176, v177
    v_mfma_f32_16x16x32_bf16 a[20:23], a[244:247], v[188:191], a[20:23]
    v_exp_f32 v178, v178
    v_mfma_f32_16x16x32_bf16 a[24:27], a[248:251], v[188:191], a[24:27]
    s_waitcnt lgkmcnt(3)
    buffer_load_dwordx4 v2, s[8:11], s49 offen offset:1024 nt lds
    v_mfma_f32_16x16x32_bf16 a[28:31], a[252:255], v[188:191], a[28:31]
    v_exp_f32 v179, v179
    v_mfma_f32_16x16x32_bf16 a[32:35], a[224:227], v[192:195], a[32:35]
    v_cvt_pk_bf16_f32 v199, v178, v179
    v_add_f32 v132, v132, v162
    v_mfma_f32_16x16x32_bf16 a[36:39], a[228:231], v[192:195], a[36:39]
    v_exp_f32 v180, v180
    v_mfma_f32_16x16x32_bf16 a[40:43], a[232:235], v[192:195], a[40:43]
    buffer_load_dwordx4 v3, s[8:11], s49 offen offset:2048 nt lds
    v_mfma_f32_16x16x32_bf16 a[44:47], a[236:239], v[192:195], a[44:47]
    v_exp_f32 v181, v181
    v_mfma_f32_16x16x32_bf16 a[48:51], a[240:243], v[192:195], a[48:51]
    v_cvt_pk_bf16_f32 v200, v180, v181
    v_add_f32 v133, v133, v163
    v_mfma_f32_16x16x32_bf16 a[52:55], a[244:247], v[192:195], a[52:55]
    v_exp_f32 v182, v182
    v_mfma_f32_16x16x32_bf16 a[56:59], a[248:251], v[192:195], a[56:59]
    v_add_f32 v141, v141, v173
    v_add_f32 v140, v140, v174
    v_mfma_f32_16x16x32_bf16 a[60:63], a[252:255], v[192:195], a[60:63]
    v_exp_f32 v183, v183
    v_mfma_f32_16x16x32_bf16 v[136:139], v[228:231], v[192:195], v[136:139]
    v_cvt_pk_bf16_f32 v201, v182, v183
    v_add_f32 v140, v140, v172
    v_mfma_f32_16x16x32_bf16 v[156:159], a[192:195], v[12:15], v[108:111]
    v_exp_f32 v184, v184
    v_mfma_f32_16x16x32_bf16 v[156:159], a[196:199], v[16:19], v[156:159]
    buffer_load_dwordx4 v4, s[8:11], s49 offen offset:3072 nt lds
    v_mfma_f32_16x16x32_bf16 v[156:159], a[200:203], v[20:23], v[156:159]
    v_exp_f32 v185, v185
    v_mfma_f32_16x16x32_bf16 v[156:159], a[204:207], v[24:27], v[156:159]
    v_cvt_pk_bf16_f32 v202, v184, v185
    v_add_f32 v141, v141, v175
    v_mfma_f32_16x16x32_bf16 v[160:163], a[208:211], v[12:15], v[108:111]
    s_waitcnt lgkmcnt(0)
    v_exp_f32 v186, v186
    v_mfma_f32_16x16x32_bf16 v[160:163], a[212:215], v[16:19], v[160:163]
    v_add_f32 v141, v141, v177
    v_add_f32 v140, v140, v178
    v_mfma_f32_16x16x32_bf16 v[160:163], a[216:219], v[20:23], v[160:163]
    v_exp_f32 v187, v187
    v_mfma_f32_16x16x32_bf16 v[160:163], a[220:223], v[24:27], v[160:163]
    v_cvt_pk_bf16_f32 v203, v186, v187
    v_add_f32 v140, v140, v176
    v_mfma_f32_16x16x32_bf16 v[164:167], a[192:195], v[28:31], v[112:115]
    v_add_f32 v141, v141, v179
    v_mfma_f32_16x16x32_bf16 v[164:167], a[196:199], v[32:35], v[164:167]
    s_mov_b32 s100, s67
    s_cmp_eq_u32 s67, s86
    s_cselect_b32 s69, s66, s65
    v_exp_f32 v156, v156
    v_mfma_f32_16x16x32_bf16 v[164:167], a[200:203], v[36:39], v[164:167]
    s_add_u32 s67, s67, s69
    v_add_f32 v132, v132, v156
    v_mfma_f32_16x16x32_bf16 v[164:167], a[204:207], v[40:43], v[164:167]
    v_exp_f32 v157, v157
    v_mfma_f32_16x16x32_bf16 v[168:171], a[208:211], v[28:31], v[112:115]
    v_cvt_pk_bf16_f32 v188, v156, v157
    v_add_u32 v204, s69, v204
    v_mfma_f32_16x16x32_bf16 v[168:171], a[212:215], v[32:35], v[168:171]
    v_exp_f32 v158, v158
    v_mfma_f32_16x16x32_bf16 v[168:171], a[216:219], v[36:39], v[168:171]
    v_add_u32 v206, s69, v206
    v_add_u32 v207, s69, v207
    v_mfma_f32_16x16x32_bf16 v[168:171], a[220:223], v[40:43], v[168:171]
    v_exp_f32 v159, v159
    v_mfma_f32_16x16x32_bf16 a[64:67], a[224:227], v[196:199], a[64:67]
    v_cvt_pk_bf16_f32 v189, v158, v159
    v_add_u32 v205, s69, v205
    v_mfma_f32_16x16x32_bf16 a[68:71], a[228:231], v[196:199], a[68:71]
    v_exp_f32 v160, v160
    v_mfma_f32_16x16x32_bf16 a[72:75], a[232:235], v[196:199], a[72:75]
    v_add_u32 v209, s69, v209
    v_add_u32 v210, s69, v210
    v_mfma_f32_16x16x32_bf16 a[76:79], a[236:239], v[196:199], a[76:79]
    v_exp_f32 v161, v161
    v_mfma_f32_16x16x32_bf16 a[80:83], a[240:243], v[196:199], a[80:83]
    v_cvt_pk_bf16_f32 v190, v160, v161
    v_add_u32 v208, s69, v208
    v_mfma_f32_16x16x32_bf16 a[84:87], a[244:247], v[196:199], a[84:87]
    v_exp_f32 v162, v162
    v_mfma_f32_16x16x32_bf16 a[88:91], a[248:251], v[196:199], a[88:91]
    v_add_u32 v211, s69, v211
    v_add_f32 v133, v133, v157
    v_mfma_f32_16x16x32_bf16 a[92:95], a[252:255], v[196:199], a[92:95]
    v_exp_f32 v163, v163
    v_mfma_f32_16x16x32_bf16 a[96:99], a[224:227], v[200:203], a[96:99]
    ds_read_b64_tr_b16 a[224:225], v224 offset:32768
    v_cvt_pk_bf16_f32 v191, v162, v163
    v_mfma_f32_16x16x32_bf16 a[100:103], a[228:231], v[200:203], a[100:103]
    v_exp_f32 v164, v164
    v_mfma_f32_16x16x32_bf16 a[104:107], a[232:235], v[200:203], a[104:107]
    ds_read_b64_tr_b16 a[228:229], v225 offset:32768
    ds_read_b64_tr_b16 a[230:231], v225 offset:36864
    v_mfma_f32_16x16x32_bf16 a[108:111], a[236:239], v[200:203], a[108:111]
    v_exp_f32 v165, v165
    v_mfma_f32_16x16x32_bf16 a[112:115], a[240:243], v[200:203], a[112:115]
    ds_read_b64_tr_b16 a[226:227], v224 offset:36864
    v_cvt_pk_bf16_f32 v192, v164, v165
    v_mfma_f32_16x16x32_bf16 a[116:119], a[244:247], v[200:203], a[116:119]
    v_exp_f32 v166, v166
    v_mfma_f32_16x16x32_bf16 a[120:123], a[248:251], v[200:203], a[120:123]
    ds_read_b64_tr_b16 a[234:235], v226 offset:36864
    ds_read_b64_tr_b16 a[236:237], v227 offset:32768
    v_mfma_f32_16x16x32_bf16 a[124:127], a[252:255], v[200:203], a[124:127]
    v_exp_f32 v167, v167
    v_mfma_f32_16x16x32_bf16 v[144:147], v[228:231], v[200:203], v[144:147]
    ds_read_b64_tr_b16 a[232:233], v226 offset:32768
    v_cvt_pk_bf16_f32 v193, v166, v167
    v_mfma_f32_16x16x32_bf16 v[172:175], a[192:195], v[44:47], v[116:119]
    v_exp_f32 v168, v168
    v_mfma_f32_16x16x32_bf16 v[172:175], a[196:199], v[48:51], v[172:175]
    ds_read_b64_tr_b16 a[240:241], v224 offset:33792
    ds_read_b64_tr_b16 a[242:243], v224 offset:37888
    v_mfma_f32_16x16x32_bf16 v[172:175], a[200:203], v[52:55], v[172:175]
    v_exp_f32 v169, v169
    v_mfma_f32_16x16x32_bf16 v[172:175], a[204:207], v[56:59], v[172:175]
    ds_read_b64_tr_b16 a[238:239], v227 offset:36864
    v_cvt_pk_bf16_f32 v194, v168, v169
    v_mfma_f32_16x16x32_bf16 v[176:179], a[208:211], v[44:47], v[116:119]
    v_exp_f32 v170, v170
    v_mfma_f32_16x16x32_bf16 v[176:179], a[212:215], v[48:51], v[176:179]
    ds_read_b64_tr_b16 a[246:247], v225 offset:37888
    ds_read_b64_tr_b16 a[248:249], v226 offset:33792
    v_mfma_f32_16x16x32_bf16 v[176:179], a[216:219], v[52:55], v[176:179]
    v_exp_f32 v171, v171
    v_mfma_f32_16x16x32_bf16 v[176:179], a[220:223], v[56:59], v[176:179]
    ds_read_b64_tr_b16 a[244:245], v225 offset:33792
    v_cvt_pk_bf16_f32 v195, v170, v171
    v_mfma_f32_16x16x32_bf16 v[180:183], a[192:195], v[60:63], v[120:123]
    ds_read_b64_tr_b16 a[250:251], v226 offset:37888
    ds_read_b64_tr_b16 a[252:253], v227 offset:33792
    v_mfma_f32_16x16x32_bf16 v[180:183], a[196:199], v[64:67], v[180:183]
    v_exp_f32 v172, v172
    v_mfma_f32_16x16x32_bf16 v[180:183], a[200:203], v[68:71], v[180:183]
    ds_read_b64_tr_b16 a[254:255], v227 offset:37888
    v_add_f32 v132, v132, v158
    v_mfma_f32_16x16x32_bf16 v[180:183], a[204:207], v[72:75], v[180:183]
    v_exp_f32 v173, v173
    v_mfma_f32_16x16x32_bf16 v[184:187], a[208:211], v[60:63], v[120:123]
    v_cvt_pk_bf16_f32 v196, v172, v173
    v_add_f32 v133, v133, v159
    v_mfma_f32_16x16x32_bf16 v[184:187], a[212:215], v[64:67], v[184:187]
    v_exp_f32 v174, v174
    v_mfma_f32_16x16x32_bf16 v[184:187], a[216:219], v[68:71], v[184:187]
    v_add_f32 v132, v132, v160
    v_add_f32 v133, v133, v161
    v_mfma_f32_16x16x32_bf16 v[184:187], a[220:223], v[72:75], v[184:187]
    s_waitcnt lgkmcnt(1)
    v_exp_f32 v175, v175
    v_mfma_f32_16x16x32_bf16 a[0:3], a[224:227], v[188:191], a[0:3]
    s_waitcnt vmcnt(8) lgkmcnt(0)
    s_barrier
    ds_read_b128 a[192:195], v204 offset:0
    v_cvt_pk_bf16_f32 v197, v174, v175
    v_mfma_f32_16x16x32_bf16 a[4:7], a[228:231], v[188:191], a[4:7]
    s_mov_b32 s68, s100
    v_exp_f32 v176, v176
    v_mfma_f32_16x16x32_bf16 a[8:11], a[232:235], v[188:191], a[8:11]
    ds_read_b128 a[200:203], v204 offset:1024
    ds_read_b128 a[204:207], v205 offset:1024
    v_mfma_f32_16x16x32_bf16 a[12:15], a[236:239], v[188:191], a[12:15]
    v_exp_f32 v177, v177
    v_mfma_f32_16x16x32_bf16 a[16:19], a[240:243], v[188:191], a[16:19]
    ds_read_b128 a[196:199], v205 offset:0
    v_cvt_pk_bf16_f32 v198, v176, v177
    v_mfma_f32_16x16x32_bf16 a[20:23], a[244:247], v[188:191], a[20:23]
    v_exp_f32 v178, v178
    v_mfma_f32_16x16x32_bf16 a[24:27], a[248:251], v[188:191], a[24:27]
    ds_read_b128 a[212:215], v205 offset:4096
    ds_read_b128 a[216:219], v204 offset:5120
    v_mfma_f32_16x16x32_bf16 a[28:31], a[252:255], v[188:191], a[28:31]
    v_exp_f32 v179, v179
    v_mfma_f32_16x16x32_bf16 a[32:35], a[224:227], v[192:195], a[32:35]
    ds_read_b128 a[208:211], v204 offset:4096
    v_cvt_pk_bf16_f32 v199, v178, v179
    v_mfma_f32_16x16x32_bf16 a[36:39], a[228:231], v[192:195], a[36:39]
    v_exp_f32 v180, v180
    v_mfma_f32_16x16x32_bf16 a[40:43], a[232:235], v[192:195], a[40:43]
    v_add_f32 v132, v132, v162
    v_add_f32 v133, v133, v163
    v_mfma_f32_16x16x32_bf16 a[44:47], a[236:239], v[192:195], a[44:47]
    v_exp_f32 v181, v181
    v_mfma_f32_16x16x32_bf16 a[48:51], a[240:243], v[192:195], a[48:51]
    ds_read_b128 a[220:223], v205 offset:5120
    v_cvt_pk_bf16_f32 v200, v180, v181
    v_mfma_f32_16x16x32_bf16 a[52:55], a[244:247], v[192:195], a[52:55]
    v_exp_f32 v182, v182
    v_mfma_f32_16x16x32_bf16 a[56:59], a[248:251], v[192:195], a[56:59]
    v_add_f32 v141, v141, v173
    v_add_f32 v140, v140, v174
    v_mfma_f32_16x16x32_bf16 a[60:63], a[252:255], v[192:195], a[60:63]
    v_exp_f32 v183, v183
    v_mfma_f32_16x16x32_bf16 v[136:139], v[228:231], v[192:195], v[136:139]
    s_waitcnt lgkmcnt(1)
    v_cvt_pk_bf16_f32 v201, v182, v183
    v_add_f32 v140, v140, v172
    v_mfma_f32_16x16x32_bf16 v[156:159], a[192:195], v[12:15], v[108:111]
    s_add_u32 s50, s50, s53
    s_add_u32 s51, s51, s53
    s_and_b32 s50, s50, s33
    s_and_b32 s51, s51, s33
    s_mov_b32 m0, s56
    v_exp_f32 v184, v184
    v_mfma_f32_16x16x32_bf16 v[156:159], a[196:199], v[16:19], v[156:159]
    buffer_load_dwordx4 v5, s[12:15], s50 offen nt lds
    v_mfma_f32_16x16x32_bf16 v[156:159], a[200:203], v[20:23], v[156:159]
    v_exp_f32 v185, v185
    v_mfma_f32_16x16x32_bf16 v[156:159], a[204:207], v[24:27], v[156:159]
    v_cvt_pk_bf16_f32 v202, v184, v185
    v_add_f32 v141, v141, v175
    v_mfma_f32_16x16x32_bf16 v[160:163], a[208:211], v[12:15], v[108:111]
    v_exp_f32 v186, v186
    v_mfma_f32_16x16x32_bf16 v[160:163], a[212:215], v[16:19], v[160:163]
    v_add_f32 v141, v141, v177
    v_add_f32 v140, v140, v178
    v_mfma_f32_16x16x32_bf16 v[160:163], a[216:219], v[20:23], v[160:163]
    s_waitcnt lgkmcnt(0)
    v_exp_f32 v187, v187
    v_mfma_f32_16x16x32_bf16 v[160:163], a[220:223], v[24:27], v[160:163]
    v_cvt_pk_bf16_f32 v203, v186, v187
    v_add_f32 v140, v140, v176
    v_mfma_f32_16x16x32_bf16 v[164:167], a[192:195], v[28:31], v[112:115]
    v_add_f32 v141, v141, v179
    v_mfma_f32_16x16x32_bf16 v[164:167], a[196:199], v[32:35], v[164:167]
    v_exp_f32 v156, v156
    v_mfma_f32_16x16x32_bf16 v[164:167], a[200:203], v[36:39], v[164:167]
    v_mfma_f32_16x16x32_bf16 v[164:167], a[204:207], v[40:43], v[164:167]
    v_exp_f32 v157, v157
    v_mfma_f32_16x16x32_bf16 v[168:171], a[208:211], v[28:31], v[112:115]
    v_cvt_pk_bf16_f32 v188, v156, v157
    v_add_f32 v132, v132, v156
    v_mfma_f32_16x16x32_bf16 v[168:171], a[212:215], v[32:35], v[168:171]
    v_exp_f32 v158, v158
    v_mfma_f32_16x16x32_bf16 v[168:171], a[216:219], v[36:39], v[168:171]
    v_add_f32 v132, v132, v158
    v_mfma_f32_16x16x32_bf16 v[168:171], a[220:223], v[40:43], v[168:171]
    v_exp_f32 v159, v159
    v_mfma_f32_16x16x32_bf16 a[64:67], a[224:227], v[196:199], a[64:67]
    v_cvt_pk_bf16_f32 v189, v158, v159
    v_add_f32 v133, v133, v157
    v_mfma_f32_16x16x32_bf16 a[68:71], a[228:231], v[196:199], a[68:71]
    v_exp_f32 v160, v160
    v_mfma_f32_16x16x32_bf16 a[72:75], a[232:235], v[196:199], a[72:75]
    buffer_load_dwordx4 v6, s[12:15], s50 offen offset:1024 nt lds
    v_mfma_f32_16x16x32_bf16 a[76:79], a[236:239], v[196:199], a[76:79]
    v_exp_f32 v161, v161
    v_mfma_f32_16x16x32_bf16 a[80:83], a[240:243], v[196:199], a[80:83]
    v_cvt_pk_bf16_f32 v190, v160, v161
    v_add_f32 v133, v133, v159
    v_mfma_f32_16x16x32_bf16 a[84:87], a[244:247], v[196:199], a[84:87]
    v_exp_f32 v162, v162
    v_mfma_f32_16x16x32_bf16 a[88:91], a[248:251], v[196:199], a[88:91]
    v_add_f32 v132, v132, v160
    v_add_f32 v133, v133, v161
    v_mfma_f32_16x16x32_bf16 a[92:95], a[252:255], v[196:199], a[92:95]
    v_exp_f32 v163, v163
    v_mfma_f32_16x16x32_bf16 a[96:99], a[224:227], v[200:203], a[96:99]
    ds_read_b64_tr_b16 a[224:225], v212 offset:0
    v_cvt_pk_bf16_f32 v191, v162, v163
    v_mfma_f32_16x16x32_bf16 a[100:103], a[228:231], v[200:203], a[100:103]
    v_exp_f32 v164, v164
    v_mfma_f32_16x16x32_bf16 a[104:107], a[232:235], v[200:203], a[104:107]
    ds_read_b64_tr_b16 a[228:229], v213 offset:0
    ds_read_b64_tr_b16 a[230:231], v213 offset:4096
    v_mfma_f32_16x16x32_bf16 a[108:111], a[236:239], v[200:203], a[108:111]
    v_exp_f32 v165, v165
    v_mfma_f32_16x16x32_bf16 a[112:115], a[240:243], v[200:203], a[112:115]
    ds_read_b64_tr_b16 a[226:227], v212 offset:4096
    v_cvt_pk_bf16_f32 v192, v164, v165
    v_mfma_f32_16x16x32_bf16 a[116:119], a[244:247], v[200:203], a[116:119]
    v_exp_f32 v166, v166
    v_mfma_f32_16x16x32_bf16 a[120:123], a[248:251], v[200:203], a[120:123]
    ds_read_b64_tr_b16 a[234:235], v214 offset:4096
    ds_read_b64_tr_b16 a[236:237], v215 offset:0
    v_mfma_f32_16x16x32_bf16 a[124:127], a[252:255], v[200:203], a[124:127]
    v_exp_f32 v167, v167
    v_mfma_f32_16x16x32_bf16 v[144:147], v[228:231], v[200:203], v[144:147]
    s_sub_u32 s58, s58, 1
    s_cmp_lg_u32 s58, 0
    ds_read_b64_tr_b16 a[232:233], v214 offset:0
    v_cvt_pk_bf16_f32 v193, v166, v167
    s_cbranch_scc1 L_loop
L_last:
    v_mfma_f32_16x16x32_bf16 v[172:175], a[192:195], v[44:47], v[116:119]
    v_exp_f32 v168, v168
    v_mfma_f32_16x16x32_bf16 v[172:175], a[196:199], v[48:51], v[172:175]
    ds_read_b64_tr_b16 a[240:241], v212 offset:1024
    ds_read_b64_tr_b16 a[242:243], v212 offset:5120
    buffer_load_dwordx4 v7, s[12:15], s50 offen offset:2048 nt lds
    v_mfma_f32_16x16x32_bf16 v[172:175], a[200:203], v[52:55], v[172:175]
    s_lshl_b32 s7, s3, 19
    s_lshl_b32 s6, s90, 21
    s_or_b32 s7, s7, s6
    s_mov_b32 s28, s40
    s_mov_b32 s29, s41
    s_mov_b32 s30, 4194304
    s_mov_b32 s31, 0x20000
    s_lshr_b32 s101, s2, 3
    s_lshl_b32 s101, s101, 13
    s_add_u32 s101, s101, s7
    s_and_b32 s60, s2, 4
    s_lshl_b32 s60, s60, 16
    v_exp_f32 v169, v169
    v_mfma_f32_16x16x32_bf16 v[172:175], a[204:207], v[56:59], v[172:175]
    ds_read_b64_tr_b16 a[238:239], v215 offset:4096
    v_cvt_pk_bf16_f32 v194, v168, v169
    v_mfma_f32_16x16x32_bf16 v[176:179], a[208:211], v[44:47], v[116:119]
    v_exp_f32 v170, v170
    v_mfma_f32_16x16x32_bf16 v[176:179], a[212:215], v[48:51], v[176:179]
    ds_read_b64_tr_b16 a[246:247], v213 offset:5120
    ds_read_b64_tr_b16 a[248:249], v214 offset:1024
    v_mfma_f32_16x16x32_bf16 v[176:179], a[216:219], v[52:55], v[176:179]
    v_exp_f32 v171, v171
    v_mfma_f32_16x16x32_bf16 v[176:179], a[220:223], v[56:59], v[176:179]
    ds_read_b64_tr_b16 a[244:245], v213 offset:1024
    buffer_load_dwordx4 v8, s[12:15], s50 offen offset:3072 nt lds
    v_cvt_pk_bf16_f32 v195, v170, v171
    v_mfma_f32_16x16x32_bf16 v[180:183], a[192:195], v[60:63], v[120:123]
    ds_read_b64_tr_b16 a[250:251], v214 offset:5120
    ds_read_b64_tr_b16 a[252:253], v215 offset:1024
    v_mfma_f32_16x16x32_bf16 v[180:183], a[196:199], v[64:67], v[180:183]
    v_exp_f32 v172, v172
    v_mfma_f32_16x16x32_bf16 v[180:183], a[200:203], v[68:71], v[180:183]
    v_lshlrev_b32 v243, 7, v0
    v_mfma_f32_16x16x32_bf16 v[180:183], a[204:207], v[72:75], v[180:183]
    s_mov_b32 m0, s57
    s_getpc_b64 s[48:49]
L_pc1:
    s_add_u32 s48, s48, 0
    s_addc_u32 s49, s49, 0
    s_lshr_b32 s64, s2, 3
    s_lshl_b32 s64, s64, 2
    s_add_u32 s64, s64, s3
    s_lshl_b32 s64, s64, 6
    v_exp_f32 v173, v173
    v_mfma_f32_16x16x32_bf16 v[184:187], a[208:211], v[60:63], v[120:123]
    ds_read_b64_tr_b16 a[254:255], v215 offset:5120
    buffer_load_dwordx4 v5, s[12:15], s51 offen nt lds
    v_cvt_pk_bf16_f32 v196, v172, v173
    v_mfma_f32_16x16x32_bf16 v[184:187], a[212:215], v[64:67], v[184:187]
    v_exp_f32 v174, v174
    v_mfma_f32_16x16x32_bf16 v[184:187], a[216:219], v[68:71], v[184:187]
    v_min_u32 v11, 2, v0
    v_mfma_f32_16x16x32_bf16 v[184:187], a[220:223], v[72:75], v[184:187]
    s_waitcnt lgkmcnt(1)
    v_exp_f32 v175, v175
    v_lshlrev_b32 v11, 13, v11
    v_mfma_f32_16x16x32_bf16 a[0:3], a[224:227], v[188:191], a[0:3]
    v_cvt_pk_bf16_f32 v197, v174, v175
    v_add_f32 v140, v140, v172
    v_add_u32 v11, s64, v11
    v_mfma_f32_16x16x32_bf16 a[4:7], a[228:231], v[188:191], a[4:7]
    s_and_b32 s63, s88, 0
    s_lshl_b32 s63, s63, 15
    s_or_b32 s63, s63, s7
    s_and_b32 s7, s2, 6
    s_lshl_b32 s7, s7, 16
    s_xor_b32 s63, s63, s7
    v_exp_f32 v176, v176
    v_lshrrev_b32 v232, 3, v0
    v_mfma_f32_16x16x32_bf16 a[8:11], a[232:235], v[188:191], a[8:11]
    buffer_load_dwordx4 v6, s[12:15], s51 offen offset:1024 nt lds
    v_add_f32 v140, v140, v174
    v_add_f32 v141, v141, v175
    v_mfma_f32_16x16x32_bf16 a[12:15], a[236:239], v[188:191], a[12:15]
    v_exp_f32 v177, v177
    v_and_b32 v233, 7, v0
    v_mfma_f32_16x16x32_bf16 a[16:19], a[240:243], v[188:191], a[16:19]
    v_cvt_pk_bf16_f32 v198, v176, v177
    v_add_f32 v141, v141, v173
    v_mfma_f32_16x16x32_bf16 a[20:23], a[244:247], v[188:191], a[20:23]
    v_exp_f32 v178, v178
    v_mfma_f32_16x16x32_bf16 a[24:27], a[248:251], v[188:191], a[24:27]
    s_waitcnt lgkmcnt(0)
    v_add_f32 v141, v141, v177
    v_add_f32 v140, v140, v178
    v_mfma_f32_16x16x32_bf16 a[28:31], a[252:255], v[188:191], a[28:31]
    v_exp_f32 v179, v179
    v_mfma_f32_16x16x32_bf16 a[32:35], a[224:227], v[192:195], a[32:35]
    buffer_load_dwordx4 v7, s[12:15], s51 offen offset:2048 nt lds
    v_cvt_pk_bf16_f32 v199, v178, v179
    v_add_f32 v140, v140, v176
    v_mfma_f32_16x16x32_bf16 a[36:39], a[228:231], v[192:195], a[36:39]
    v_exp_f32 v180, v180
    v_mfma_f32_16x16x32_bf16 a[40:43], a[232:235], v[192:195], a[40:43]
    v_add_f32 v132, v132, v162
    v_add_f32 v133, v133, v163
    v_mfma_f32_16x16x32_bf16 a[44:47], a[236:239], v[192:195], a[44:47]
    v_exp_f32 v181, v181
    v_mfma_f32_16x16x32_bf16 a[48:51], a[240:243], v[192:195], a[48:51]
    v_cvt_pk_bf16_f32 v200, v180, v181
    v_add_f32 v141, v141, v179
    v_mfma_f32_16x16x32_bf16 a[52:55], a[244:247], v[192:195], a[52:55]
    v_exp_f32 v182, v182
    v_mfma_f32_16x16x32_bf16 a[56:59], a[248:251], v[192:195], a[56:59]
    buffer_load_dwordx4 v8, s[12:15], s51 offen offset:3072 nt lds
    v_mfma_f32_16x16x32_bf16 a[60:63], a[252:255], v[192:195], a[60:63]
    v_exp_f32 v183, v183
    v_mfma_f32_16x16x32_bf16 v[136:139], v[228:231], v[192:195], v[136:139]
    v_cvt_pk_bf16_f32 v201, v182, v183
    v_bfe_u32 v234, v232, 1, 2
    v_mfma_f32_16x16x32_bf16 v[156:159], a[192:195], v[76:79], v[124:127]
    v_exp_f32 v184, v184
    v_mfma_f32_16x16x32_bf16 v[156:159], a[196:199], v[80:83], v[156:159]
    v_lshlrev_b32 v234, 1, v234
    v_mfma_f32_16x16x32_bf16 v[156:159], a[200:203], v[84:87], v[156:159]
    v_exp_f32 v185, v185
    v_mfma_f32_16x16x32_bf16 v[156:159], a[204:207], v[88:91], v[156:159]
    v_cvt_pk_bf16_f32 v202, v184, v185
    v_xor_b32 v234, v234, v233
    v_mfma_f32_16x16x32_bf16 v[160:163], a[208:211], v[76:79], v[124:127]
    v_exp_f32 v186, v186
    v_mfma_f32_16x16x32_bf16 v[160:163], a[212:215], v[80:83], v[160:163]
    global_load_dword v9, v11, s[48:49]
    v_mfma_f32_16x16x32_bf16 v[160:163], a[216:219], v[84:87], v[160:163]
    v_exp_f32 v187, v187
    v_mfma_f32_16x16x32_bf16 v[160:163], a[220:223], v[88:91], v[160:163]
    v_cvt_pk_bf16_f32 v203, v186, v187
    v_lshlrev_b32 v235, 10, v232
    v_mfma_f32_16x16x32_bf16 v[164:167], a[192:195], v[92:95], v[128:131]
    ds_read_b128 a[192:195], v206 offset:0
    v_lshl_add_u32 v1, v234, 4, v235
    v_mfma_f32_16x16x32_bf16 v[164:167], a[196:199], v[96:99], v[164:167]
    v_exp_f32 v156, v156
    v_add_u32 v2, 7168, v1
    v_mfma_f32_16x16x32_bf16 v[164:167], a[200:203], v[100:103], v[164:167]
    ds_read_b128 a[200:203], v206 offset:1024
    v_add_f32 v148, v148, v156
    v_mfma_f32_16x16x32_bf16 v[164:167], a[204:207], v[104:107], v[164:167]
    v_exp_f32 v157, v157
    v_mfma_f32_16x16x32_bf16 v[168:171], a[208:211], v[92:95], v[128:131]
    ds_read_b128 a[196:199], v207 offset:0
    v_cvt_pk_bf16_f32 v188, v156, v157
    v_mfma_f32_16x16x32_bf16 v[168:171], a[212:215], v[96:99], v[168:171]
    v_exp_f32 v158, v158
    v_mfma_f32_16x16x32_bf16 v[168:171], a[216:219], v[100:103], v[168:171]
    ds_read_b128 a[208:211], v206 offset:4096
    ds_read_b128 a[212:215], v207 offset:4096
    v_mfma_f32_16x16x32_bf16 v[168:171], a[220:223], v[104:107], v[168:171]
    v_exp_f32 v159, v159
    v_mfma_f32_16x16x32_bf16 a[64:67], a[224:227], v[196:199], a[64:67]
    ds_read_b128 a[204:207], v207 offset:1024
    v_cvt_pk_bf16_f32 v189, v158, v159
    v_mfma_f32_16x16x32_bf16 a[68:71], a[228:231], v[196:199], a[68:71]
    v_exp_f32 v160, v160
    v_mfma_f32_16x16x32_bf16 a[72:75], a[232:235], v[196:199], a[72:75]
    ds_read_b128 a[220:223], v207 offset:5120
    v_add_f32 v149, v149, v157
    v_mfma_f32_16x16x32_bf16 a[76:79], a[236:239], v[196:199], a[76:79]
    v_exp_f32 v161, v161
    v_mfma_f32_16x16x32_bf16 a[80:83], a[240:243], v[196:199], a[80:83]
    ds_read_b128 a[216:219], v206 offset:5120
    v_cvt_pk_bf16_f32 v190, v160, v161
    v_mfma_f32_16x16x32_bf16 a[84:87], a[244:247], v[196:199], a[84:87]
    v_exp_f32 v162, v162
    v_mfma_f32_16x16x32_bf16 a[88:91], a[248:251], v[196:199], a[88:91]
    v_add_u32 v3, 14336, v1
    v_mfma_f32_16x16x32_bf16 a[92:95], a[252:255], v[196:199], a[92:95]
    v_exp_f32 v163, v163
    v_mfma_f32_16x16x32_bf16 a[96:99], a[224:227], v[200:203], a[96:99]
    v_cvt_pk_bf16_f32 v191, v162, v163
    v_add_f32 v148, v148, v158
    v_mfma_f32_16x16x32_bf16 a[100:103], a[228:231], v[200:203], a[100:103]
    v_exp_f32 v164, v164
    v_mfma_f32_16x16x32_bf16 a[104:107], a[232:235], v[200:203], a[104:107]
    v_add_u32 v4, 21504, v1
    v_mfma_f32_16x16x32_bf16 a[108:111], a[236:239], v[200:203], a[108:111]
    s_lshl_b32 s6, s88, 7
    s_add_u32 s8, s40, s6
    s_addc_u32 s9, s41, 0
    s_sub_u32 s10, 4194304, s6
    s_mov_b32 s11, 0x20000
    s_or_b32 s99, s3, s59
    s_cbranch_scc1 L_nocnt
    v_mov_b32 v238, 0
    v_mov_b32 v239, 1
    s_mov_b64 exec, 1
    global_atomic_add v238, v239, s[44:45]
    s_mov_b64 exec, -1
    s_nop 3
L_nocnt:
    v_exp_f32 v165, v165
    v_mfma_f32_16x16x32_bf16 a[112:115], a[240:243], v[200:203], a[112:115]
    v_cvt_pk_bf16_f32 v192, v164, v165
    v_add_f32 v149, v149, v159
    v_mfma_f32_16x16x32_bf16 a[116:119], a[244:247], v[200:203], a[116:119]
    v_exp_f32 v166, v166
    v_mfma_f32_16x16x32_bf16 a[120:123], a[248:251], v[200:203], a[120:123]
    v_add_f32 v149, v149, v161
    v_add_f32 v148, v148, v162
    v_mfma_f32_16x16x32_bf16 a[124:127], a[252:255], v[200:203], a[124:127]
    v_exp_f32 v167, v167
    v_mfma_f32_16x16x32_bf16 v[144:147], v[228:231], v[200:203], v[144:147]
    s_waitcnt lgkmcnt(0)
    v_cvt_pk_bf16_f32 v193, v166, v167
    v_add_f32 v148, v148, v160
    v_mfma_f32_16x16x32_bf16 v[172:175], a[192:195], v[12:15], v[108:111]
    v_exp_f32 v168, v168
    v_mfma_f32_16x16x32_bf16 v[172:175], a[196:199], v[16:19], v[172:175]
    v_lshrrev_b32 v232, 4, v0
    v_mfma_f32_16x16x32_bf16 v[172:175], a[200:203], v[20:23], v[172:175]
    v_exp_f32 v169, v169
    v_mfma_f32_16x16x32_bf16 v[172:175], a[204:207], v[24:27], v[172:175]
    v_cvt_pk_bf16_f32 v194, v168, v169
    v_add_f32 v149, v149, v163
    v_mfma_f32_16x16x32_bf16 v[176:179], a[208:211], v[12:15], v[108:111]
    v_exp_f32 v170, v170
    v_mfma_f32_16x16x32_bf16 v[176:179], a[212:215], v[16:19], v[176:179]
    v_bfe_u32 v233, v0, 2, 2
    v_mfma_f32_16x16x32_bf16 v[176:179], a[216:219], v[20:23], v[176:179]
    v_exp_f32 v171, v171
    v_mfma_f32_16x16x32_bf16 v[176:179], a[220:223], v[24:27], v[176:179]
    v_cvt_pk_bf16_f32 v195, v170, v171
    v_and_b32 v234, 3, v0
    v_mfma_f32_16x16x32_bf16 v[180:183], a[192:195], v[28:31], v[112:115]
    v_and_b32 v235, 1, v232
    v_mfma_f32_16x16x32_bf16 v[180:183], a[196:199], v[32:35], v[180:183]
    v_exp_f32 v172, v172
    v_mfma_f32_16x16x32_bf16 v[180:183], a[200:203], v[36:39], v[180:183]
    v_lshl_add_u32 v235, v235, 2, v233
    v_mfma_f32_16x16x32_bf16 v[180:183], a[204:207], v[40:43], v[180:183]
    v_exp_f32 v173, v173
    v_mfma_f32_16x16x32_bf16 v[184:187], a[208:211], v[28:31], v[112:115]
    v_cvt_pk_bf16_f32 v196, v172, v173
    v_add_f32 v132, v132, v172
    v_mfma_f32_16x16x32_bf16 v[184:187], a[212:215], v[32:35], v[184:187]
    v_exp_f32 v174, v174
    v_mfma_f32_16x16x32_bf16 v[184:187], a[216:219], v[36:39], v[184:187]
    v_add_f32 v132, v132, v174
    v_lshrrev_b32 v236, 1, v235
    v_mfma_f32_16x16x32_bf16 v[184:187], a[220:223], v[40:43], v[184:187]
    v_exp_f32 v175, v175
    v_mfma_f32_16x16x32_bf16 a[128:131], a[224:227], v[188:191], a[128:131]
    v_cvt_pk_bf16_f32 v197, v174, v175
    v_add_f32 v133, v133, v173
    v_mfma_f32_16x16x32_bf16 a[132:135], a[228:231], v[188:191], a[132:135]
    v_exp_f32 v176, v176
    v_mfma_f32_16x16x32_bf16 a[136:139], a[232:235], v[188:191], a[136:139]
    v_add_f32 v132, v132, v176
    v_lshlrev_b32 v236, 5, v236
    v_mfma_f32_16x16x32_bf16 a[140:143], a[236:239], v[188:191], a[140:143]
    v_exp_f32 v177, v177
    v_lshl_add_u32 v236, v235, 7, v236
    v_mfma_f32_16x16x32_bf16 a[144:147], a[240:243], v[188:191], a[144:147]
    v_cvt_pk_bf16_f32 v198, v176, v177
    v_add_f32 v133, v133, v175
    v_lshrrev_b32 v235, 1, v232
    v_mfma_f32_16x16x32_bf16 a[148:151], a[244:247], v[188:191], a[148:151]
    v_exp_f32 v178, v178
    v_lshl_add_u32 v236, v235, 10, v236
    v_mfma_f32_16x16x32_bf16 a[152:155], a[248:251], v[188:191], a[152:155]
    v_add_f32 v133, v133, v177
    v_add_f32 v132, v132, v178
    v_lshl_add_u32 v236, v234, 3, v236
    v_mfma_f32_16x16x32_bf16 a[156:159], a[252:255], v[188:191], a[156:159]
    v_exp_f32 v179, v179
    v_add_u32 v244, s91, v236
    v_mfma_f32_16x16x32_bf16 a[160:163], a[224:227], v[192:195], a[160:163]
    s_lshl_b32 s7, s3, 5
    ds_read_b64_tr_b16 a[224:225], v216 offset:0
    v_cvt_pk_bf16_f32 v199, v178, v179
    v_xor_b32 v244, s7, v244
    v_mfma_f32_16x16x32_bf16 a[164:167], a[228:231], v[192:195], a[164:167]
    v_exp_f32 v180, v180
    v_xor_b32 v245, 32, v244
    v_mfma_f32_16x16x32_bf16 a[168:171], a[232:235], v[192:195], a[168:171]
    ds_read_b64_tr_b16 a[228:229], v217 offset:0
    ds_read_b64_tr_b16 a[230:231], v217 offset:4096
    v_xor_b32 v246, 64, v244
    v_mfma_f32_16x16x32_bf16 a[172:175], a[236:239], v[192:195], a[172:175]
    v_exp_f32 v181, v181
    v_xor_b32 v247, 96, v244
    v_mfma_f32_16x16x32_bf16 a[176:179], a[240:243], v[192:195], a[176:179]
    ds_read_b64_tr_b16 a[226:227], v216 offset:4096
    v_cvt_pk_bf16_f32 v200, v180, v181
    v_add_u32 v248, 65536, v244
    v_mfma_f32_16x16x32_bf16 a[180:183], a[244:247], v[192:195], a[180:183]
    v_exp_f32 v182, v182
    v_add_u32 v249, 65536, v245
    v_mfma_f32_16x16x32_bf16 a[184:187], a[248:251], v[192:195], a[184:187]
    ds_read_b64_tr_b16 a[234:235], v218 offset:4096
    ds_read_b64_tr_b16 a[236:237], v219 offset:0
    v_add_u32 v250, 65536, v246
    v_mfma_f32_16x16x32_bf16 a[188:191], a[252:255], v[192:195], a[188:191]
    v_exp_f32 v183, v183
    v_add_u32 v251, 65536, v247
    v_mfma_f32_16x16x32_bf16 v[152:155], v[228:231], v[192:195], v[152:155]
    ds_read_b64_tr_b16 a[232:233], v218 offset:0
    v_cvt_pk_bf16_f32 v201, v182, v183
    v_add_u32 v252, 131072, v244
    v_mfma_f32_16x16x32_bf16 v[156:159], a[192:195], v[44:47], v[116:119]
    v_exp_f32 v184, v184
    v_add_u32 v253, 131072, v245
    v_mfma_f32_16x16x32_bf16 v[156:159], a[196:199], v[48:51], v[156:159]
    ds_read_b64_tr_b16 a[240:241], v216 offset:1024
    ds_read_b64_tr_b16 a[242:243], v216 offset:5120
    v_add_u32 v254, 131072, v246
    v_mfma_f32_16x16x32_bf16 v[156:159], a[200:203], v[52:55], v[156:159]
    v_exp_f32 v185, v185
    v_add_u32 v255, 131072, v247
    v_mfma_f32_16x16x32_bf16 v[156:159], a[204:207], v[56:59], v[156:159]
    ds_read_b64_tr_b16 a[238:239], v219 offset:4096
    v_cvt_pk_bf16_f32 v202, v184, v185
    v_lshlrev_b32 v10, 4, v0
    v_mfma_f32_16x16x32_bf16 v[160:163], a[208:211], v[44:47], v[116:119]
    s_add_u32 s12, s46, 20971520
    s_addc_u32 s13, s47, 0
    s_mov_b32 s14, 5242880
    s_mov_b32 s15, 0x20000
    s_mul_i32 s51, s2, 20480
    s_mul_i32 s6, s3, 5120
    s_add_u32 s51, s51, s6
    s_xor_b32 s50, s2, 1
    s_mul_i32 s50, s50, 20480
    s_add_u32 s50, s50, s6
    s_add_u32 s6, s51, 4096
    v_exp_f32 v186, v186
    v_mov_b32 v236, -1
    v_mfma_f32_16x16x32_bf16 v[160:163], a[212:215], v[48:51], v[160:163]
    ds_read_b64_tr_b16 a[246:247], v217 offset:5120
    ds_read_b64_tr_b16 a[248:249], v218 offset:1024
    v_mov_b32 v237, -1
    v_mfma_f32_16x16x32_bf16 v[160:163], a[216:219], v[52:55], v[160:163]
    v_exp_f32 v187, v187
    v_mov_b32 v238, -1
    v_mfma_f32_16x16x32_bf16 v[160:163], a[220:223], v[56:59], v[160:163]
    ds_read_b64_tr_b16 a[244:245], v217 offset:1024
    v_cvt_pk_bf16_f32 v203, v186, v187
    v_mov_b32 v239, -1
    v_mfma_f32_16x16x32_bf16 v[164:167], a[192:195], v[60:63], v[120:123]
    ds_read_b64_tr_b16 a[250:251], v218 offset:5120
    ds_read_b64_tr_b16 a[252:253], v219 offset:1024
    v_mfma_f32_16x16x32_bf16 v[164:167], a[196:199], v[64:67], v[164:167]
    v_exp_f32 v156, v156
    v_mfma_f32_16x16x32_bf16 v[164:167], a[200:203], v[68:71], v[164:167]
    ds_read_b128 a[192:195], v208 offset:0
    ds_read_b128 a[196:199], v209 offset:0
    buffer_store_dwordx4 v[236:239], v10, s[12:15], s51 offen offset:0 sc1
    v_mfma_f32_16x16x32_bf16 v[164:167], a[204:207], v[72:75], v[164:167]
    v_exp_f32 v157, v157
    v_mfma_f32_16x16x32_bf16 v[168:171], a[208:211], v[60:63], v[120:123]
    ds_read_b64_tr_b16 a[254:255], v219 offset:5120
    buffer_store_dwordx4 v[236:239], v10, s[12:15], s51 offen offset:1024 sc1
    v_cvt_pk_bf16_f32 v188, v156, v157
    v_mfma_f32_16x16x32_bf16 v[168:171], a[212:215], v[64:67], v[168:171]
    v_exp_f32 v158, v158
    v_mfma_f32_16x16x32_bf16 v[168:171], a[216:219], v[68:71], v[168:171]
    ds_read_b128 a[204:207], v209 offset:1024
    ds_read_b128 a[208:211], v208 offset:4096
    buffer_store_dwordx4 v[236:239], v10, s[12:15], s51 offen offset:2048 sc1
    v_mfma_f32_16x16x32_bf16 v[168:171], a[220:223], v[72:75], v[168:171]
    s_waitcnt lgkmcnt(5)
    v_exp_f32 v159, v159
    v_mfma_f32_16x16x32_bf16 a[0:3], a[224:227], v[196:199], a[0:3]
    ds_read_b128 a[200:203], v208 offset:1024
    buffer_store_dwordx4 v[236:239], v10, s[12:15], s51 offen offset:3072 sc1
    v_cvt_pk_bf16_f32 v189, v158, v159
    v_mfma_f32_16x16x32_bf16 a[4:7], a[228:231], v[196:199], a[4:7]
    v_exp_f32 v160, v160
    v_mfma_f32_16x16x32_bf16 a[8:11], a[232:235], v[196:199], a[8:11]
    ds_read_b128 a[216:219], v208 offset:5120
    ds_read_b128 a[220:223], v209 offset:5120
    buffer_store_dwordx4 v[236:239], v10, s[12:15], s6 offen offset:0 sc1
    v_mfma_f32_16x16x32_bf16 a[12:15], a[236:239], v[196:199], a[12:15]
    v_exp_f32 v161, v161
    v_mfma_f32_16x16x32_bf16 a[16:19], a[240:243], v[196:199], a[16:19]
    ds_read_b128 a[212:215], v209 offset:4096
    v_cvt_pk_bf16_f32 v190, v160, v161
    v_mfma_f32_16x16x32_bf16 a[20:23], a[244:247], v[196:199], a[20:23]
    v_exp_f32 v162, v162
    v_mfma_f32_16x16x32_bf16 a[24:27], a[248:251], v[196:199], a[24:27]
    s_waitcnt lgkmcnt(3)
    v_add_f32 v140, v140, v156
    v_add_f32 v141, v141, v157
    v_mfma_f32_16x16x32_bf16 a[28:31], a[252:255], v[196:199], a[28:31]
    v_exp_f32 v163, v163
    v_mfma_f32_16x16x32_bf16 a[32:35], a[224:227], v[200:203], a[32:35]
    v_cvt_pk_bf16_f32 v191, v162, v163
    v_add_f32 v133, v133, v179
    v_mfma_f32_16x16x32_bf16 a[36:39], a[228:231], v[200:203], a[36:39]
    v_exp_f32 v164, v164
    v_mfma_f32_16x16x32_bf16 a[40:43], a[232:235], v[200:203], a[40:43]
    v_add_f32 v141, v141, v159
    v_add_f32 v140, v140, v160
    v_mfma_f32_16x16x32_bf16 a[44:47], a[236:239], v[200:203], a[44:47]
    v_exp_f32 v165, v165
    v_mfma_f32_16x16x32_bf16 a[48:51], a[240:243], v[200:203], a[48:51]
    v_cvt_pk_bf16_f32 v192, v164, v165
    v_add_f32 v140, v140, v158
    v_mfma_f32_16x16x32_bf16 a[52:55], a[244:247], v[200:203], a[52:55]
    v_exp_f32 v166, v166
    v_mfma_f32_16x16x32_bf16 a[56:59], a[248:251], v[200:203], a[56:59]
    v_add_f32 v140, v140, v162
    v_add_f32 v141, v141, v163
    v_mfma_f32_16x16x32_bf16 a[60:63], a[252:255], v[200:203], a[60:63]
    v_exp_f32 v167, v167
    v_mfma_f32_16x16x32_bf16 v[136:139], v[228:231], v[200:203], v[136:139]
    v_cvt_pk_bf16_f32 v193, v166, v167
    v_add_f32 v141, v141, v161
    v_mfma_f32_16x16x32_bf16 v[172:175], a[192:195], v[12:15], v[108:111]
    v_exp_f32 v168, v168
    v_mfma_f32_16x16x32_bf16 v[172:175], a[196:199], v[16:19], v[172:175]
    v_mfma_f32_16x16x32_bf16 v[172:175], a[200:203], v[20:23], v[172:175]
    v_exp_f32 v169, v169
    v_mfma_f32_16x16x32_bf16 v[172:175], a[204:207], v[24:27], v[172:175]
    v_cvt_pk_bf16_f32 v194, v168, v169
    v_mfma_f32_16x16x32_bf16 v[176:179], a[208:211], v[12:15], v[108:111]
    s_waitcnt lgkmcnt(0)
    v_exp_f32 v170, v170
    v_mfma_f32_16x16x32_bf16 v[176:179], a[212:215], v[16:19], v[176:179]
    v_mfma_f32_16x16x32_bf16 v[176:179], a[216:219], v[20:23], v[176:179]
    v_exp_f32 v171, v171
    v_mfma_f32_16x16x32_bf16 v[176:179], a[220:223], v[24:27], v[176:179]
    v_cvt_pk_bf16_f32 v195, v170, v171
    v_mfma_f32_16x16x32_bf16 v[180:183], a[192:195], v[28:31], v[112:115]
    v_mfma_f32_16x16x32_bf16 v[180:183], a[196:199], v[32:35], v[180:183]
    v_exp_f32 v172, v172
    v_mfma_f32_16x16x32_bf16 v[180:183], a[200:203], v[36:39], v[180:183]
    v_mfma_f32_16x16x32_bf16 v[180:183], a[204:207], v[40:43], v[180:183]
    v_exp_f32 v173, v173
    v_mfma_f32_16x16x32_bf16 v[184:187], a[208:211], v[28:31], v[112:115]
    v_cvt_pk_bf16_f32 v196, v172, v173
    v_add_f32 v132, v132, v172
    v_mfma_f32_16x16x32_bf16 v[184:187], a[212:215], v[32:35], v[184:187]
    v_exp_f32 v174, v174
    v_mfma_f32_16x16x32_bf16 v[184:187], a[216:219], v[36:39], v[184:187]
    v_add_f32 v132, v132, v174
    v_mfma_f32_16x16x32_bf16 v[184:187], a[220:223], v[40:43], v[184:187]
    v_exp_f32 v175, v175
    v_mfma_f32_16x16x32_bf16 a[64:67], a[224:227], v[188:191], a[64:67]
    v_cvt_pk_bf16_f32 v197, v174, v175
    v_add_f32 v133, v133, v173
    v_mfma_f32_16x16x32_bf16 a[68:71], a[228:231], v[188:191], a[68:71]
    v_exp_f32 v176, v176
    v_mfma_f32_16x16x32_bf16 a[72:75], a[232:235], v[188:191], a[72:75]
    v_add_f32 v132, v132, v176
    v_mfma_f32_16x16x32_bf16 a[76:79], a[236:239], v[188:191], a[76:79]
    v_exp_f32 v177, v177
    v_mfma_f32_16x16x32_bf16 a[80:83], a[240:243], v[188:191], a[80:83]
    v_cvt_pk_bf16_f32 v198, v176, v177
    v_add_f32 v133, v133, v175
    v_mfma_f32_16x16x32_bf16 a[84:87], a[244:247], v[188:191], a[84:87]
    v_exp_f32 v178, v178
    v_mfma_f32_16x16x32_bf16 a[88:91], a[248:251], v[188:191], a[88:91]
    v_add_f32 v133, v133, v177
    v_add_f32 v132, v132, v178
    v_mfma_f32_16x16x32_bf16 a[92:95], a[252:255], v[188:191], a[92:95]
    v_exp_f32 v179, v179
    v_mfma_f32_16x16x32_bf16 a[96:99], a[224:227], v[192:195], a[96:99]
    ds_read_b64_tr_b16 a[224:225], v220 offset:0
    v_cvt_pk_bf16_f32 v199, v178, v179
    v_mfma_f32_16x16x32_bf16 a[100:103], a[228:231], v[192:195], a[100:103]
    v_exp_f32 v180, v180
    v_mfma_f32_16x16x32_bf16 a[104:107], a[232:235], v[192:195], a[104:107]
    ds_read_b64_tr_b16 a[228:229], v221 offset:0
    ds_read_b64_tr_b16 a[230:231], v221 offset:4096
    v_mfma_f32_16x16x32_bf16 a[108:111], a[236:239], v[192:195], a[108:111]
    v_exp_f32 v181, v181
    v_mfma_f32_16x16x32_bf16 a[112:115], a[240:243], v[192:195], a[112:115]
    ds_read_b64_tr_b16 a[226:227], v220 offset:4096
    v_cvt_pk_bf16_f32 v200, v180, v181
    v_mfma_f32_16x16x32_bf16 a[116:119], a[244:247], v[192:195], a[116:119]
    v_exp_f32 v182, v182
    v_mfma_f32_16x16x32_bf16 a[120:123], a[248:251], v[192:195], a[120:123]
    ds_read_b64_tr_b16 a[234:235], v222 offset:4096
    ds_read_b64_tr_b16 a[236:237], v223 offset:0
    v_mfma_f32_16x16x32_bf16 a[124:127], a[252:255], v[192:195], a[124:127]
    v_exp_f32 v183, v183
    v_mfma_f32_16x16x32_bf16 v[144:147], v[228:231], v[192:195], v[144:147]
    ds_read_b64_tr_b16 a[232:233], v222 offset:0
    v_cvt_pk_bf16_f32 v201, v182, v183
    v_mfma_f32_16x16x32_bf16 v[156:159], a[192:195], v[44:47], v[116:119]
    v_exp_f32 v184, v184
    v_mfma_f32_16x16x32_bf16 v[156:159], a[196:199], v[48:51], v[156:159]
    ds_read_b64_tr_b16 a[240:241], v220 offset:1024
    ds_read_b64_tr_b16 a[242:243], v220 offset:5120
    v_mfma_f32_16x16x32_bf16 v[156:159], a[200:203], v[52:55], v[156:159]
    v_exp_f32 v185, v185
    v_mfma_f32_16x16x32_bf16 v[156:159], a[204:207], v[56:59], v[156:159]
    ds_read_b64_tr_b16 a[238:239], v223 offset:4096
    v_cvt_pk_bf16_f32 v202, v184, v185
    v_mfma_f32_16x16x32_bf16 v[160:163], a[208:211], v[44:47], v[116:119]
    s_xor_b32 s39, s101, s60
    s_add_u32 s101, s101, 262144
    v_exp_f32 v186, v186
    v_mfma_f32_16x16x32_bf16 v[160:163], a[212:215], v[48:51], v[160:163]
    ds_read_b64_tr_b16 a[246:247], v221 offset:5120
    ds_read_b64_tr_b16 a[248:249], v222 offset:1024
    buffer_load_dword v9, v243, s[28:31], s39 offen
    v_mfma_f32_16x16x32_bf16 v[160:163], a[216:219], v[52:55], v[160:163]
    s_xor_b32 s39, s101, s60
    s_add_u32 s101, s101, 262144
    v_exp_f32 v187, v187
    v_mfma_f32_16x16x32_bf16 v[160:163], a[220:223], v[56:59], v[160:163]
    ds_read_b64_tr_b16 a[244:245], v221 offset:1024
    buffer_load_dword v9, v243, s[28:31], s39 offen
    v_cvt_pk_bf16_f32 v203, v186, v187
    v_mfma_f32_16x16x32_bf16 v[164:167], a[192:195], v[60:63], v[120:123]
    ds_read_b64_tr_b16 a[250:251], v222 offset:5120
    ds_read_b64_tr_b16 a[252:253], v223 offset:1024
    v_mfma_f32_16x16x32_bf16 v[164:167], a[196:199], v[64:67], v[164:167]
    v_exp_f32 v156, v156
    v_mfma_f32_16x16x32_bf16 v[164:167], a[200:203], v[68:71], v[164:167]
    ds_read_b128 a[192:195], v210 offset:0
    ds_read_b128 a[196:199], v211 offset:0
    v_mfma_f32_16x16x32_bf16 v[164:167], a[204:207], v[72:75], v[164:167]
    v_exp_f32 v157, v157
    v_mfma_f32_16x16x32_bf16 v[168:171], a[208:211], v[60:63], v[120:123]
    ds_read_b64_tr_b16 a[254:255], v223 offset:5120
    v_cvt_pk_bf16_f32 v188, v156, v157
    v_mfma_f32_16x16x32_bf16 v[168:171], a[212:215], v[64:67], v[168:171]
    v_exp_f32 v158, v158
    v_mfma_f32_16x16x32_bf16 v[168:171], a[216:219], v[68:71], v[168:171]
    ds_read_b128 a[204:207], v211 offset:1024
    ds_read_b128 a[208:211], v210 offset:4096
    v_mfma_f32_16x16x32_bf16 v[168:171], a[220:223], v[72:75], v[168:171]
    s_waitcnt lgkmcnt(5)
    v_exp_f32 v159, v159
    v_mfma_f32_16x16x32_bf16 a[0:3], a[224:227], v[196:199], a[0:3]
    ds_read_b128 a[200:203], v210 offset:1024
    v_cvt_pk_bf16_f32 v189, v158, v159
    v_mfma_f32_16x16x32_bf16 a[4:7], a[228:231], v[196:199], a[4:7]
    v_exp_f32 v160, v160
    v_mfma_f32_16x16x32_bf16 a[8:11], a[232:235], v[196:199], a[8:11]
    ds_read_b128 a[216:219], v210 offset:5120
    ds_read_b128 a[220:223], v211 offset:5120
    v_mfma_f32_16x16x32_bf16 a[12:15], a[236:239], v[196:199], a[12:15]
    v_exp_f32 v161, v161
    v_mfma_f32_16x16x32_bf16 a[16:19], a[240:243], v[196:199], a[16:19]
    ds_read_b128 a[212:215], v211 offset:4096
    v_cvt_pk_bf16_f32 v190, v160, v161
    v_mfma_f32_16x16x32_bf16 a[20:23], a[244:247], v[196:199], a[20:23]
    v_exp_f32 v162, v162
    v_mfma_f32_16x16x32_bf16 a[24:27], a[248:251], v[196:199], a[24:27]
    s_waitcnt lgkmcnt(3)
    v_add_f32 v140, v140, v156
    v_add_f32 v141, v141, v157
    v_mfma_f32_16x16x32_bf16 a[28:31], a[252:255], v[196:199], a[28:31]
    v_exp_f32 v163, v163
    v_mfma_f32_16x16x32_bf16 a[32:35], a[224:227], v[200:203], a[32:35]
    v_cvt_pk_bf16_f32 v191, v162, v163
    v_add_f32 v133, v133, v179
    v_mfma_f32_16x16x32_bf16 a[36:39], a[228:231], v[200:203], a[36:39]
    v_exp_f32 v164, v164
    v_mfma_f32_16x16x32_bf16 a[40:43], a[232:235], v[200:203], a[40:43]
    v_add_f32 v141, v141, v159
    v_add_f32 v140, v140, v160
    v_mfma_f32_16x16x32_bf16 a[44:47], a[236:239], v[200:203], a[44:47]
    v_exp_f32 v165, v165
    v_mfma_f32_16x16x32_bf16 a[48:51], a[240:243], v[200:203], a[48:51]
    v_cvt_pk_bf16_f32 v192, v164, v165
    v_add_f32 v140, v140, v158
    v_mfma_f32_16x16x32_bf16 a[52:55], a[244:247], v[200:203], a[52:55]
    v_exp_f32 v166, v166
    v_mfma_f32_16x16x32_bf16 a[56:59], a[248:251], v[200:203], a[56:59]
    v_add_f32 v140, v140, v162
    v_add_f32 v141, v141, v163
    v_mfma_f32_16x16x32_bf16 a[60:63], a[252:255], v[200:203], a[60:63]
    v_exp_f32 v167, v167
    v_mfma_f32_16x16x32_bf16 v[136:139], v[228:231], v[200:203], v[136:139]
    v_cvt_pk_bf16_f32 v193, v166, v167
    v_add_f32 v141, v141, v161
    v_mfma_f32_16x16x32_bf16 v[172:175], a[192:195], v[12:15], v[108:111]
    v_exp_f32 v168, v168
    v_mfma_f32_16x16x32_bf16 v[172:175], a[196:199], v[16:19], v[172:175]
    v_mfma_f32_16x16x32_bf16 v[172:175], a[200:203], v[20:23], v[172:175]
    v_exp_f32 v169, v169
    v_mfma_f32_16x16x32_bf16 v[172:175], a[204:207], v[24:27], v[172:175]
    v_cvt_pk_bf16_f32 v194, v168, v169
    v_mfma_f32_16x16x32_bf16 v[176:179], a[208:211], v[12:15], v[108:111]
    s_waitcnt lgkmcnt(0)
    v_exp_f32 v170, v170
    v_mfma_f32_16x16x32_bf16 v[176:179], a[212:215], v[16:19], v[176:179]
    v_mfma_f32_16x16x32_bf16 v[176:179], a[216:219], v[20:23], v[176:179]
    v_exp_f32 v171, v171
    v_mfma_f32_16x16x32_bf16 v[176:179], a[220:223], v[24:27], v[176:179]
    v_cvt_pk_bf16_f32 v195, v170, v171
    v_mfma_f32_16x16x32_bf16 v[180:183], a[192:195], v[28:31], v[112:115]
    v_mfma_f32_16x16x32_bf16 v[180:183], a[196:199], v[32:35], v[180:183]
    s_mov_b32 s100, s67
    s_cmp_eq_u32 s67, s86
    s_cselect_b32 s69, s66, s65
    v_exp_f32 v172, v172
    v_mfma_f32_16x16x32_bf16 v[180:183], a[200:203], v[36:39], v[180:183]
    s_add_u32 s67, s67, s69
    v_add_f32 v132, v132, v172
    v_mfma_f32_16x16x32_bf16 v[180:183], a[204:207], v[40:43], v[180:183]
    v_exp_f32 v173, v173
    v_mfma_f32_16x16x32_bf16 v[184:187], a[208:211], v[28:31], v[112:115]
    v_cvt_pk_bf16_f32 v196, v172, v173
    v_add_u32 v204, s69, v204
    v_mfma_f32_16x16x32_bf16 v[184:187], a[212:215], v[32:35], v[184:187]
    v_exp_f32 v174, v174
    v_mfma_f32_16x16x32_bf16 v[184:187], a[216:219], v[36:39], v[184:187]
    v_add_u32 v206, s69, v206
    v_add_u32 v207, s69, v207
    v_mfma_f32_16x16x32_bf16 v[184:187], a[220:223], v[40:43], v[184:187]
    v_exp_f32 v175, v175
    v_mfma_f32_16x16x32_bf16 a[64:67], a[224:227], v[188:191], a[64:67]
    v_cvt_pk_bf16_f32 v197, v174, v175
    v_add_u32 v205, s69, v205
    v_mfma_f32_16x16x32_bf16 a[68:71], a[228:231], v[188:191], a[68:71]
    v_exp_f32 v176, v176
    v_mfma_f32_16x16x32_bf16 a[72:75], a[232:235], v[188:191], a[72:75]
    v_add_u32 v209, s69, v209
    v_add_u32 v210, s69, v210
    v_mfma_f32_16x16x32_bf16 a[76:79], a[236:239], v[188:191], a[76:79]
    v_exp_f32 v177, v177
    v_mfma_f32_16x16x32_bf16 a[80:83], a[240:243], v[188:191], a[80:83]
    v_cvt_pk_bf16_f32 v198, v176, v177
    v_add_u32 v208, s69, v208
    v_mfma_f32_16x16x32_bf16 a[84:87], a[244:247], v[188:191], a[84:87]
    v_exp_f32 v178, v178
    v_mfma_f32_16x16x32_bf16 a[88:91], a[248:251], v[188:191], a[88:91]
    v_add_u32 v211, s69, v211
    v_add_f32 v133, v133, v173
    v_mfma_f32_16x16x32_bf16 a[92:95], a[252:255], v[188:191], a[92:95]
    v_exp_f32 v179, v179
    v_mfma_f32_16x16x32_bf16 a[96:99], a[224:227], v[192:195], a[96:99]
    ds_read_b64_tr_b16 a[224:225], v224 offset:0
    v_cvt_pk_bf16_f32 v199, v178, v179
    v_mfma_f32_16x16x32_bf16 a[100:103], a[228:231], v[192:195], a[100:103]
    v_exp_f32 v180, v180
    v_mfma_f32_16x16x32_bf16 a[104:107], a[232:235], v[192:195], a[104:107]
    ds_read_b64_tr_b16 a[228:229], v225 offset:0
    ds_read_b64_tr_b16 a[230:231], v225 offset:4096
    v_mfma_f32_16x16x32_bf16 a[108:111], a[236:239], v[192:195], a[108:111]
    v_exp_f32 v181, v181
    v_mfma_f32_16x16x32_bf16 a[112:115], a[240:243], v[192:195], a[112:115]
    ds_read_b64_tr_b16 a[226:227], v224 offset:4096
    v_cvt_pk_bf16_f32 v200, v180, v181
    v_mfma_f32_16x16x32_bf16 a[116:119], a[244:247], v[192:195], a[116:119]
    v_exp_f32 v182, v182
    v_mfma_f32_16x16x32_bf16 a[120:123], a[248:251], v[192:195], a[120:123]
    ds_read_b64_tr_b16 a[234:235], v226 offset:4096
    ds_read_b64_tr_b16 a[236:237], v227 offset:0
    v_mfma_f32_16x16x32_bf16 a[124:127], a[252:255], v[192:195], a[124:127]
    v_exp_f32 v183, v183
    v_mfma_f32_16x16x32_bf16 v[144:147], v[228:231], v[192:195], v[144:147]
    ds_read_b64_tr_b16 a[232:233], v226 offset:0
    v_cvt_pk_bf16_f32 v201, v182, v183
    v_mfma_f32_16x16x32_bf16 v[156:159], a[192:195], v[44:47], v[116:119]
    v_exp_f32 v184, v184
    v_mfma_f32_16x16x32_bf16 v[156:159], a[196:199], v[48:51], v[156:159]
    ds_read_b64_tr_b16 a[240:241], v224 offset:1024
    ds_read_b64_tr_b16 a[242:243], v224 offset:5120
    v_mfma_f32_16x16x32_bf16 v[156:159], a[200:203], v[52:55], v[156:159]
    v_exp_f32 v185, v185
    v_mfma_f32_16x16x32_bf16 v[156:159], a[204:207], v[56:59], v[156:159]
    ds_read_b64_tr_b16 a[238:239], v227 offset:4096
    v_cvt_pk_bf16_f32 v202, v184, v185
    v_mfma_f32_16x16x32_bf16 v[160:163], a[208:211], v[44:47], v[116:119]
    v_exp_f32 v186, v186
    v_mfma_f32_16x16x32_bf16 v[160:163], a[212:215], v[48:51], v[160:163]
    ds_read_b64_tr_b16 a[246:247], v225 offset:5120
    ds_read_b64_tr_b16 a[248:249], v226 offset:1024
    v_mfma_f32_16x16x32_bf16 v[160:163], a[216:219], v[52:55], v[160:163]
    v_exp_f32 v187, v187
    v_mfma_f32_16x16x32_bf16 v[160:163], a[220:223], v[56:59], v[160:163]
    ds_read_b64_tr_b16 a[244:245], v225 offset:1024
    v_cvt_pk_bf16_f32 v203, v186, v187
    v_mfma_f32_16x16x32_bf16 v[164:167], a[192:195], v[60:63], v[120:123]
    ds_read_b64_tr_b16 a[250:251], v226 offset:5120
    ds_read_b64_tr_b16 a[252:253], v227 offset:1024
    v_mfma_f32_16x16x32_bf16 v[164:167], a[196:199], v[64:67], v[164:167]
    v_exp_f32 v156, v156
    v_mfma_f32_16x16x32_bf16 v[164:167], a[200:203], v[68:71], v[164:167]
    ds_read_b64_tr_b16 a[254:255], v227 offset:5120
    v_add_f32 v132, v132, v174
    v_mfma_f32_16x16x32_bf16 v[164:167], a[204:207], v[72:75], v[164:167]
    v_exp_f32 v157, v157
    v_mfma_f32_16x16x32_bf16 v[168:171], a[208:211], v[60:63], v[120:123]
    v_cvt_pk_bf16_f32 v188, v156, v157
    v_add_f32 v133, v133, v175
    v_mfma_f32_16x16x32_bf16 v[168:171], a[212:215], v[64:67], v[168:171]
    v_exp_f32 v158, v158
    v_mfma_f32_16x16x32_bf16 v[168:171], a[216:219], v[68:71], v[168:171]
    v_add_f32 v132, v132, v176
    v_add_f32 v133, v133, v177
    v_mfma_f32_16x16x32_bf16 v[168:171], a[220:223], v[72:75], v[168:171]
    s_waitcnt lgkmcnt(1)
    v_exp_f32 v159, v159
    v_mfma_f32_16x16x32_bf16 a[0:3], a[224:227], v[196:199], a[0:3]
    s_waitcnt vmcnt(8) lgkmcnt(0)
    s_barrier
    ds_read_b128 a[192:195], v204 offset:0
    v_cvt_pk_bf16_f32 v189, v158, v159
    v_mfma_f32_16x16x32_bf16 a[4:7], a[228:231], v[196:199], a[4:7]
    v_exp_f32 v160, v160
    v_mfma_f32_16x16x32_bf16 a[8:11], a[232:235], v[196:199], a[8:11]
    ds_read_b128 a[200:203], v204 offset:1024
    ds_read_b128 a[204:207], v205 offset:1024
    v_mfma_f32_16x16x32_bf16 a[12:15], a[236:239], v[196:199], a[12:15]
    v_exp_f32 v161, v161
    v_mfma_f32_16x16x32_bf16 a[16:19], a[240:243], v[196:199], a[16:19]
    ds_read_b128 a[196:199], v205 offset:0
    v_cvt_pk_bf16_f32 v190, v160, v161
    v_mfma_f32_16x16x32_bf16 a[20:23], a[244:247], v[196:199], a[20:23]
    v_exp_f32 v162, v162
    v_mfma_f32_16x16x32_bf16 a[24:27], a[248:251], v[196:199], a[24:27]
    ds_read_b128 a[212:215], v205 offset:4096
    ds_read_b128 a[216:219], v204 offset:5120
    v_mfma_f32_16x16x32_bf16 a[28:31], a[252:255], v[196:199], a[28:31]
    v_exp_f32 v163, v163
    v_mfma_f32_16x16x32_bf16 a[32:35], a[224:227], v[200:203], a[32:35]
    ds_read_b128 a[208:211], v204 offset:4096
    v_cvt_pk_bf16_f32 v191, v162, v163
    v_mfma_f32_16x16x32_bf16 a[36:39], a[228:231], v[200:203], a[36:39]
    v_exp_f32 v164, v164
    v_mfma_f32_16x16x32_bf16 a[40:43], a[232:235], v[200:203], a[40:43]
    v_add_f32 v132, v132, v178
    v_add_f32 v133, v133, v179
    v_mfma_f32_16x16x32_bf16 a[44:47], a[236:239], v[200:203], a[44:47]
    v_exp_f32 v165, v165
    v_mfma_f32_16x16x32_bf16 a[48:51], a[240:243], v[200:203], a[48:51]
    ds_read_b128 a[220:223], v205 offset:5120
    v_cvt_pk_bf16_f32 v192, v164, v165
    v_mfma_f32_16x16x32_bf16 a[52:55], a[244:247], v[200:203], a[52:55]
    v_exp_f32 v166, v166
    v_mfma_f32_16x16x32_bf16 a[56:59], a[248:251], v[200:203], a[56:59]
    v_add_f32 v141, v141, v157
    v_add_f32 v140, v140, v158
    v_mfma_f32_16x16x32_bf16 a[60:63], a[252:255], v[200:203], a[60:63]
    v_exp_f32 v167, v167
    v_mfma_f32_16x16x32_bf16 v[136:139], v[228:231], v[200:203], v[136:139]
    s_waitcnt lgkmcnt(1)
    v_cvt_pk_bf16_f32 v193, v166, v167
    v_add_f32 v140, v140, v156
    v_mfma_f32_16x16x32_bf16 v[172:175], a[192:195], v[76:79], v[124:127]
    v_exp_f32 v168, v168
    v_mfma_f32_16x16x32_bf16 v[172:175], a[196:199], v[80:83], v[172:175]
    v_add_f32 v140, v140, v160
    v_add_f32 v141, v141, v161
    v_mfma_f32_16x16x32_bf16 v[172:175], a[200:203], v[84:87], v[172:175]
    v_exp_f32 v169, v169
    v_mfma_f32_16x16x32_bf16 v[172:175], a[204:207], v[88:91], v[172:175]
    s_lshl_b32 s6, s3, 14
    s_lshr_b32 s7, s3, 1
    s_mul_i32 s7, s7, 98304
    s_add_u32 s6, s6, s7
    v_cvt_pk_bf16_f32 v194, v168, v169
    v_add_f32 v141, v141, v159
    v_mfma_f32_16x16x32_bf16 v[176:179], a[208:211], v[76:79], v[124:127]
    v_exp_f32 v170, v170
    v_mfma_f32_16x16x32_bf16 v[176:179], a[212:215], v[80:83], v[176:179]
    v_add_f32 v141, v141, v163
    v_add_u32 v232, s6, v10
    v_mfma_f32_16x16x32_bf16 v[176:179], a[216:219], v[84:87], v[176:179]
    s_waitcnt lgkmcnt(0)
    s_lshl_b32 s6, s3, 11
    v_exp_f32 v171, v171
    v_mfma_f32_16x16x32_bf16 v[176:179], a[220:223], v[88:91], v[176:179]
    v_cvt_pk_bf16_f32 v195, v170, v171
    v_add_f32 v140, v140, v162
    v_mfma_f32_16x16x32_bf16 v[180:183], a[192:195], v[92:95], v[128:131]
    v_add_u32 v233, s6, v10
    v_mfma_f32_16x16x32_bf16 v[180:183], a[196:199], v[96:99], v[180:183]
    v_exp_f32 v172, v172
    v_mfma_f32_16x16x32_bf16 v[180:183], a[200:203], v[100:103], v[180:183]
    v_add_u32 v234, 131072, v233
    v_mfma_f32_16x16x32_bf16 v[180:183], a[204:207], v[104:107], v[180:183]
    v_exp_f32 v173, v173
    v_mfma_f32_16x16x32_bf16 v[184:187], a[208:211], v[92:95], v[128:131]
    v_cvt_pk_bf16_f32 v196, v172, v173
    v_add_f32 v148, v148, v172
    v_mfma_f32_16x16x32_bf16 v[184:187], a[212:215], v[96:99], v[184:187]
    v_exp_f32 v174, v174
    v_mfma_f32_16x16x32_bf16 v[184:187], a[216:219], v[100:103], v[184:187]
    v_add_f32 v148, v148, v174
    v_lshlrev_b32 v242, 2, v0
    v_mfma_f32_16x16x32_bf16 v[184:187], a[220:223], v[104:107], v[184:187]
    v_exp_f32 v175, v175
    v_mfma_f32_16x16x32_bf16 a[64:67], a[224:227], v[188:191], a[64:67]
    v_cvt_pk_bf16_f32 v197, v174, v175
    v_add_f32 v149, v149, v173
    v_mfma_f32_16x16x32_bf16 a[68:71], a[228:231], v[188:191], a[68:71]
    v_exp_f32 v176, v176
    v_mfma_f32_16x16x32_bf16 a[72:75], a[232:235], v[188:191], a[72:75]
    v_add_f32 v148, v148, v176
    v_add_u32 v242, 69632, v242
    v_mfma_f32_16x16x32_bf16 a[76:79], a[236:239], v[188:191], a[76:79]
    v_exp_f32 v177, v177
    v_add_u32 v235, s91, v242
    v_mfma_f32_16x16x32_bf16 a[80:83], a[240:243], v[188:191], a[80:83]
    s_lshl_b32 s7, s5, 12
    s_lshl_b32 s66, s3, 10
    s_add_u32 s66, s66, s7
    s_add_u32 s66, s66, 2097152
    s_lshl_b32 s6, s3, 19
    s_add_u32 s6, s6, s7
    s_add_u32 s7, s66, 131072
    v_cvt_pk_bf16_f32 v198, v176, v177
    v_add_f32 v149, v149, v175
    v_mfma_f32_16x16x32_bf16 a[84:87], a[244:247], v[188:191], a[84:87]
    v_exp_f32 v178, v178
    v_mfma_f32_16x16x32_bf16 a[88:91], a[248:251], v[188:191], a[88:91]
    v_add_f32 v149, v149, v177
    v_add_f32 v148, v148, v178
    v_mfma_f32_16x16x32_bf16 a[92:95], a[252:255], v[188:191], a[92:95]
    v_exp_f32 v179, v179
    v_mfma_f32_16x16x32_bf16 a[96:99], a[224:227], v[192:195], a[96:99]
    ds_read_b64_tr_b16 a[224:225], v212 offset:32768
    v_cvt_pk_bf16_f32 v199, v178, v179
    v_mfma_f32_16x16x32_bf16 a[100:103], a[228:231], v[192:195], a[100:103]
    v_exp_f32 v180, v180
    v_mfma_f32_16x16x32_bf16 a[104:107], a[232:235], v[192:195], a[104:107]
    ds_read_b64_tr_b16 a[228:229], v213 offset:32768
    ds_read_b64_tr_b16 a[230:231], v213 offset:36864
    v_mfma_f32_16x16x32_bf16 a[108:111], a[236:239], v[192:195], a[108:111]
    v_exp_f32 v181, v181
    v_mfma_f32_16x16x32_bf16 a[112:115], a[240:243], v[192:195], a[112:115]
    ds_read_b64_tr_b16 a[226:227], v212 offset:36864
    v_cvt_pk_bf16_f32 v200, v180, v181
    v_mfma_f32_16x16x32_bf16 a[116:119], a[244:247], v[192:195], a[116:119]
    v_exp_f32 v182, v182
    v_mfma_f32_16x16x32_bf16 a[120:123], a[248:251], v[192:195], a[120:123]
    ds_read_b64_tr_b16 a[234:235], v214 offset:36864
    ds_read_b64_tr_b16 a[236:237], v215 offset:32768
    v_mfma_f32_16x16x32_bf16 a[124:127], a[252:255], v[192:195], a[124:127]
    v_exp_f32 v183, v183
    v_mfma_f32_16x16x32_bf16 v[144:147], v[228:231], v[192:195], v[144:147]
    ds_read_b64_tr_b16 a[232:233], v214 offset:32768
    v_cvt_pk_bf16_f32 v201, v182, v183
    v_mfma_f32_16x16x32_bf16 v[156:159], a[192:195], v[12:15], v[108:111]
    v_exp_f32 v184, v184
    v_mfma_f32_16x16x32_bf16 v[156:159], a[196:199], v[16:19], v[156:159]
    ds_read_b64_tr_b16 a[240:241], v212 offset:33792
    ds_read_b64_tr_b16 a[242:243], v212 offset:37888
    v_mfma_f32_16x16x32_bf16 v[156:159], a[200:203], v[20:23], v[156:159]
    v_exp_f32 v185, v185
    v_mfma_f32_16x16x32_bf16 v[156:159], a[204:207], v[24:27], v[156:159]
    ds_read_b64_tr_b16 a[238:239], v215 offset:36864
    v_cvt_pk_bf16_f32 v202, v184, v185
    v_mfma_f32_16x16x32_bf16 v[160:163], a[208:211], v[12:15], v[108:111]
    v_exp_f32 v186, v186
    v_mfma_f32_16x16x32_bf16 v[160:163], a[212:215], v[16:19], v[160:163]
    ds_read_b64_tr_b16 a[246:247], v213 offset:37888
    ds_read_b64_tr_b16 a[248:249], v214 offset:33792
    v_mfma_f32_16x16x32_bf16 v[160:163], a[216:219], v[20:23], v[160:163]
    v_exp_f32 v187, v187
    v_mfma_f32_16x16x32_bf16 v[160:163], a[220:223], v[24:27], v[160:163]
    ds_read_b64_tr_b16 a[244:245], v213 offset:33792
    v_cvt_pk_bf16_f32 v203, v186, v187
    v_mfma_f32_16x16x32_bf16 v[164:167], a[192:195], v[28:31], v[112:115]
    ds_read_b64_tr_b16 a[250:251], v214 offset:37888
    ds_read_b64_tr_b16 a[252:253], v215 offset:33792
    v_mfma_f32_16x16x32_bf16 v[164:167], a[196:199], v[32:35], v[164:167]
    v_exp_f32 v156, v156
    v_mfma_f32_16x16x32_bf16 v[164:167], a[200:203], v[36:39], v[164:167]
    v_add_f32 v149, v149, v179
    v_add_f32 v132, v132, v156
    v_mfma_f32_16x16x32_bf16 v[164:167], a[204:207], v[40:43], v[164:167]
    v_exp_f32 v157, v157
    v_mfma_f32_16x16x32_bf16 v[168:171], a[208:211], v[28:31], v[112:115]
    ds_read_b64_tr_b16 a[254:255], v215 offset:37888
    v_cvt_pk_bf16_f32 v188, v156, v157
    v_mfma_f32_16x16x32_bf16 v[168:171], a[212:215], v[32:35], v[168:171]
    v_exp_f32 v158, v158
    v_mfma_f32_16x16x32_bf16 v[168:171], a[216:219], v[36:39], v[168:171]
    v_add_f32 v132, v132, v158
    v_mfma_f32_16x16x32_bf16 v[168:171], a[220:223], v[40:43], v[168:171]
    s_waitcnt lgkmcnt(1)
    v_exp_f32 v159, v159
    v_mfma_f32_16x16x32_bf16 a[128:131], a[224:227], v[196:199], a[128:131]
    v_cvt_pk_bf16_f32 v189, v158, v159
    v_add_f32 v133, v133, v157
    v_mfma_f32_16x16x32_bf16 a[132:135], a[228:231], v[196:199], a[132:135]
    v_exp_f32 v160, v160
    v_mfma_f32_16x16x32_bf16 a[136:139], a[232:235], v[196:199], a[136:139]
    v_add_f32 v132, v132, v160
    v_mfma_f32_16x16x32_bf16 a[140:143], a[236:239], v[196:199], a[140:143]
    v_exp_f32 v161, v161
    v_mfma_f32_16x16x32_bf16 a[144:147], a[240:243], v[196:199], a[144:147]
    v_cvt_pk_bf16_f32 v190, v160, v161
    v_add_f32 v133, v133, v159
    v_mfma_f32_16x16x32_bf16 a[148:151], a[244:247], v[196:199], a[148:151]
    v_exp_f32 v162, v162
    v_mfma_f32_16x16x32_bf16 a[152:155], a[248:251], v[196:199], a[152:155]
    s_waitcnt lgkmcnt(0)
    v_add_f32 v132, v132, v162
    v_mfma_f32_16x16x32_bf16 a[156:159], a[252:255], v[196:199], a[156:159]
    v_exp_f32 v163, v163
    v_mfma_f32_16x16x32_bf16 a[160:163], a[224:227], v[200:203], a[160:163]
    v_cvt_pk_bf16_f32 v191, v162, v163
    v_add_f32 v133, v133, v161
    v_mfma_f32_16x16x32_bf16 a[164:167], a[228:231], v[200:203], a[164:167]
    v_exp_f32 v164, v164
    v_mfma_f32_16x16x32_bf16 a[168:171], a[232:235], v[200:203], a[168:171]
    v_mfma_f32_16x16x32_bf16 a[172:175], a[236:239], v[200:203], a[172:175]
    v_exp_f32 v165, v165
    v_mfma_f32_16x16x32_bf16 a[176:179], a[240:243], v[200:203], a[176:179]
    v_cvt_pk_bf16_f32 v192, v164, v165
    v_add_f32 v133, v133, v163
    v_mfma_f32_16x16x32_bf16 a[180:183], a[244:247], v[200:203], a[180:183]
    v_exp_f32 v166, v166
    v_mfma_f32_16x16x32_bf16 a[184:187], a[248:251], v[200:203], a[184:187]
    v_mfma_f32_16x16x32_bf16 a[188:191], a[252:255], v[200:203], a[188:191]
    v_exp_f32 v167, v167
    v_mfma_f32_16x16x32_bf16 v[152:155], v[228:231], v[200:203], v[152:155]
    v_cvt_pk_bf16_f32 v193, v166, v167
    v_mfma_f32_16x16x32_bf16 v[172:175], a[192:195], v[44:47], v[116:119]
    v_exp_f32 v168, v168
    v_mfma_f32_16x16x32_bf16 v[172:175], a[196:199], v[48:51], v[172:175]
    v_mfma_f32_16x16x32_bf16 v[172:175], a[200:203], v[52:55], v[172:175]
    v_exp_f32 v169, v169
    v_mfma_f32_16x16x32_bf16 v[172:175], a[204:207], v[56:59], v[172:175]
    v_cvt_pk_bf16_f32 v194, v168, v169
    v_mfma_f32_16x16x32_bf16 v[176:179], a[208:211], v[44:47], v[116:119]
    v_exp_f32 v170, v170
    v_mfma_f32_16x16x32_bf16 v[176:179], a[212:215], v[48:51], v[176:179]
    v_mfma_f32_16x16x32_bf16 v[176:179], a[216:219], v[52:55], v[176:179]
    v_exp_f32 v171, v171
    v_add_f32 v148, v148, v149
    v_mov_b32 v150, v148
    s_nop 1
    v_permlane32_swap_b32 v148, v150
    v_add_f32 v148, v148, v150
    v_mov_b32 v150, v148
    s_nop 1
    v_permlane16_swap_b32 v148, v150
    v_add_f32 v148, v148, v150
    v_mfma_f32_16x16x32_bf16 v[176:179], a[220:223], v[56:59], v[176:179]
    ds_write_b128 v232, a[128:131] offset:0
    v_cvt_pk_bf16_f32 v195, v170, v171
    v_mfma_f32_16x16x32_bf16 v[180:183], a[192:195], v[60:63], v[120:123]
    ds_read_b128 a[192:195], v206 offset:0
    ds_write_b128 v232, a[132:135] offset:1024
    v_mfma_f32_16x16x32_bf16 v[180:183], a[196:199], v[64:67], v[180:183]
    v_exp_f32 v172, v172
    v_mfma_f32_16x16x32_bf16 v[180:183], a[200:203], v[68:71], v[180:183]
    ds_read_b128 a[200:203], v206 offset:1024
    ds_write_b128 v232, a[136:139] offset:2048
    v_add_f32 v140, v140, v172
    v_mfma_f32_16x16x32_bf16 v[180:183], a[204:207], v[72:75], v[180:183]
    v_exp_f32 v173, v173
    v_mfma_f32_16x16x32_bf16 v[184:187], a[208:211], v[60:63], v[120:123]
    ds_read_b128 a[196:199], v207 offset:0
    ds_write_b128 v232, a[140:143] offset:3072
    v_cvt_pk_bf16_f32 v196, v172, v173
    v_mfma_f32_16x16x32_bf16 v[184:187], a[212:215], v[64:67], v[184:187]
    v_exp_f32 v174, v174
    v_mfma_f32_16x16x32_bf16 v[184:187], a[216:219], v[68:71], v[184:187]
    ds_read_b128 a[208:211], v206 offset:4096
    ds_read_b128 a[212:215], v207 offset:4096
    ds_write_b128 v232, a[144:147] offset:4096
    v_mfma_f32_16x16x32_bf16 v[184:187], a[220:223], v[72:75], v[184:187]
    v_exp_f32 v175, v175
    v_mfma_f32_16x16x32_bf16 a[0:3], a[224:227], v[188:191], a[0:3]
    ds_read_b128 a[204:207], v207 offset:1024
    ds_write_b128 v232, a[148:151] offset:5120
    v_cvt_pk_bf16_f32 v197, v174, v175
    v_mfma_f32_16x16x32_bf16 a[4:7], a[228:231], v[188:191], a[4:7]
    v_exp_f32 v176, v176
    v_mfma_f32_16x16x32_bf16 a[8:11], a[232:235], v[188:191], a[8:11]
    ds_read_b128 a[220:223], v207 offset:5120
    ds_write_b128 v232, a[152:155] offset:6144
    v_add_f32 v141, v141, v173
    v_mfma_f32_16x16x32_bf16 a[12:15], a[236:239], v[188:191], a[12:15]
    v_exp_f32 v177, v177
    v_mfma_f32_16x16x32_bf16 a[16:19], a[240:243], v[188:191], a[16:19]
    ds_read_b128 a[216:219], v206 offset:5120
    ds_write_b128 v232, a[156:159] offset:7168
    v_cvt_pk_bf16_f32 v198, v176, v177
    v_mfma_f32_16x16x32_bf16 a[20:23], a[244:247], v[188:191], a[20:23]
    v_exp_f32 v178, v178
    v_mfma_f32_16x16x32_bf16 a[24:27], a[248:251], v[188:191], a[24:27]
    ds_write_b128 v232, a[160:163] offset:8192
    v_add_f32 v141, v141, v175
    v_add_f32 v140, v140, v176
    v_mfma_f32_16x16x32_bf16 a[28:31], a[252:255], v[188:191], a[28:31]
    v_exp_f32 v179, v179
    v_mfma_f32_16x16x32_bf16 a[32:35], a[224:227], v[192:195], a[32:35]
    ds_write_b128 v232, a[164:167] offset:9216
    v_cvt_pk_bf16_f32 v199, v178, v179
    v_add_f32 v140, v140, v174
    v_mfma_f32_16x16x32_bf16 a[36:39], a[228:231], v[192:195], a[36:39]
    v_exp_f32 v180, v180
    v_mfma_f32_16x16x32_bf16 a[40:43], a[232:235], v[192:195], a[40:43]
    ds_write_b128 v232, a[168:171] offset:10240
    v_add_f32 v140, v140, v178
    v_add_f32 v141, v141, v179
    v_mfma_f32_16x16x32_bf16 a[44:47], a[236:239], v[192:195], a[44:47]
    v_exp_f32 v181, v181
    v_mfma_f32_16x16x32_bf16 a[48:51], a[240:243], v[192:195], a[48:51]
    ds_write_b128 v232, a[172:175] offset:11264
    v_cvt_pk_bf16_f32 v200, v180, v181
    v_add_f32 v141, v141, v177
    v_mfma_f32_16x16x32_bf16 a[52:55], a[244:247], v[192:195], a[52:55]
    v_exp_f32 v182, v182
    v_mfma_f32_16x16x32_bf16 a[56:59], a[248:251], v[192:195], a[56:59]
    ds_write_b128 v232, a[176:179] offset:12288
    v_mfma_f32_16x16x32_bf16 a[60:63], a[252:255], v[192:195], a[60:63]
    v_exp_f32 v183, v183
    v_mfma_f32_16x16x32_bf16 v[136:139], v[228:231], v[192:195], v[136:139]
    s_waitcnt lgkmcnt(2)
    ds_write_b128 v232, a[180:183] offset:13312
    v_cvt_pk_bf16_f32 v201, v182, v183
    v_mfma_f32_16x16x32_bf16 v[156:159], a[192:195], v[12:15], v[108:111]
    v_exp_f32 v184, v184
    v_mfma_f32_16x16x32_bf16 v[156:159], a[196:199], v[16:19], v[156:159]
    s_mov_b32 s69, 0x5f800000
    ds_write_b128 v232, a[184:187] offset:14336
    v_mfma_f32_16x16x32_bf16 v[156:159], a[200:203], v[20:23], v[156:159]
    v_exp_f32 v185, v185
    v_mfma_f32_16x16x32_bf16 v[156:159], a[204:207], v[24:27], v[156:159]
    ds_write_b128 v232, a[188:191] offset:15360
    v_cvt_pk_bf16_f32 v202, v184, v185
    v_mfma_f32_16x16x32_bf16 v[160:163], a[208:211], v[12:15], v[108:111]
    v_exp_f32 v186, v186
    v_mfma_f32_16x16x32_bf16 v[160:163], a[212:215], v[16:19], v[160:163]
    ds_write_b32 v235, v148
    ds_write_b32 v235, v152 offset:256
    v_add_f32 v240, v148, v152
    v_mfma_f32_16x16x32_bf16 v[160:163], a[216:219], v[20:23], v[160:163]
    v_exp_f32 v187, v187
    v_mfma_f32_16x16x32_bf16 v[160:163], a[220:223], v[24:27], v[160:163]
    s_add_u32 m0, s91, 65536
    s_xor_b32 s64, s63, 0
    v_cvt_pk_bf16_f32 v203, v186, v187
    v_cmp_nge_f32 s[54:55], s69, v240
    v_mfma_f32_16x16x32_bf16 v[164:167], a[192:195], v[28:31], v[112:115]
    buffer_load_dwordx4 v1, s[8:11], s64 offen offset:0 lds
    v_mfma_f32_16x16x32_bf16 v[164:167], a[196:199], v[32:35], v[164:167]
    v_exp_f32 v156, v156
    v_mfma_f32_16x16x32_bf16 v[164:167], a[200:203], v[36:39], v[164:167]
    buffer_load_dwordx4 v2, s[8:11], s64 offen offset:1024 lds
    v_mfma_f32_16x16x32_bf16 v[164:167], a[204:207], v[40:43], v[164:167]
    v_exp_f32 v157, v157
    v_mfma_f32_16x16x32_bf16 v[168:171], a[208:211], v[28:31], v[112:115]
    buffer_load_dwordx4 v3, s[8:11], s64 offen offset:2048 lds
    v_cvt_pk_bf16_f32 v188, v156, v157
    v_add_f32 v132, v132, v156
    v_mfma_f32_16x16x32_bf16 v[168:171], a[212:215], v[32:35], v[168:171]
    v_exp_f32 v158, v158
    v_mfma_f32_16x16x32_bf16 v[168:171], a[216:219], v[36:39], v[168:171]
    s_waitcnt lgkmcnt(0)
    s_barrier
    ds_read_b128 v[76:79], v233 offset:0
    buffer_load_dwordx4 v4, s[8:11], s64 offen offset:3072 lds
    v_add_f32 v132, v132, v158
    v_mfma_f32_16x16x32_bf16 v[168:171], a[220:223], v[40:43], v[168:171]
    v_exp_f32 v159, v159
    v_mfma_f32_16x16x32_bf16 a[64:67], a[224:227], v[196:199], a[64:67]
    ds_read_b128 v[80:83], v233 offset:1024
    ds_read_b128 v[84:87], v233 offset:8192
    v_cvt_pk_bf16_f32 v189, v158, v159
    v_add_f32 v133, v133, v157
    v_mfma_f32_16x16x32_bf16 a[68:71], a[228:231], v[196:199], a[68:71]
    v_exp_f32 v160, v160
    v_mfma_f32_16x16x32_bf16 a[72:75], a[232:235], v[196:199], a[72:75]
    ds_read_b128 v[88:91], v233 offset:9216
    ds_read_b128 v[92:95], v233 offset:16384
    v_add_f32 v132, v132, v160
    v_mfma_f32_16x16x32_bf16 a[76:79], a[236:239], v[196:199], a[76:79]
    v_exp_f32 v161, v161
    v_mfma_f32_16x16x32_bf16 a[80:83], a[240:243], v[196:199], a[80:83]
    ds_read_b128 v[96:99], v233 offset:17408
    ds_read_b128 v[100:103], v233 offset:24576
    v_cvt_pk_bf16_f32 v190, v160, v161
    v_add_f32 v133, v133, v159
    v_mfma_f32_16x16x32_bf16 a[84:87], a[244:247], v[196:199], a[84:87]
    v_exp_f32 v162, v162
    v_mfma_f32_16x16x32_bf16 a[88:91], a[248:251], v[196:199], a[88:91]
    ds_read_b128 v[104:107], v233 offset:25600
    ds_read_b128 v[124:127], v234 offset:0
    v_add_f32 v133, v133, v161
    v_add_f32 v132, v132, v162
    v_mfma_f32_16x16x32_bf16 a[92:95], a[252:255], v[196:199], a[92:95]
    v_exp_f32 v163, v163
    v_mfma_f32_16x16x32_bf16 a[96:99], a[224:227], v[200:203], a[96:99]
    ds_read_b64_tr_b16 a[224:225], v216 offset:32768
    ds_read_b128 v[128:131], v234 offset:1024
    ds_read_b128 v[148:151], v234 offset:8192
    v_cvt_pk_bf16_f32 v191, v162, v163
    v_mfma_f32_16x16x32_bf16 a[100:103], a[228:231], v[200:203], a[100:103]
    v_exp_f32 v164, v164
    v_mfma_f32_16x16x32_bf16 a[104:107], a[232:235], v[200:203], a[104:107]
    ds_read_b64_tr_b16 a[228:229], v217 offset:32768
    ds_read_b64_tr_b16 a[230:231], v217 offset:36864
    ds_read_b128 v[152:155], v234 offset:9216
    ds_read_b32 v236, v242 offset:0
    v_mfma_f32_16x16x32_bf16 a[108:111], a[236:239], v[200:203], a[108:111]
    v_exp_f32 v165, v165
    v_mfma_f32_16x16x32_bf16 a[112:115], a[240:243], v[200:203], a[112:115]
    ds_read_b64_tr_b16 a[226:227], v216 offset:36864
    ds_read_b32 v5, v242 offset:256
    ds_read_b32 v237, v242 offset:8192
    v_cvt_pk_bf16_f32 v192, v164, v165
    v_mfma_f32_16x16x32_bf16 a[116:119], a[244:247], v[200:203], a[116:119]
    v_exp_f32 v166, v166
    v_mfma_f32_16x16x32_bf16 a[120:123], a[248:251], v[200:203], a[120:123]
    ds_read_b64_tr_b16 a[234:235], v218 offset:36864
    ds_read_b64_tr_b16 a[236:237], v219 offset:32768
    ds_read_b32 v6, v242 offset:8448
    ds_read_b32 v238, v242 offset:16384
    v_mfma_f32_16x16x32_bf16 a[124:127], a[252:255], v[200:203], a[124:127]
    v_exp_f32 v167, v167
    v_mfma_f32_16x16x32_bf16 v[144:147], v[228:231], v[200:203], v[144:147]
    ds_read_b64_tr_b16 a[232:233], v218 offset:32768
    ds_read_b32 v7, v242 offset:16640
    ds_read_b32 v239, v242 offset:24576
    v_cvt_pk_bf16_f32 v193, v166, v167
    v_mfma_f32_16x16x32_bf16 v[172:175], a[192:195], v[44:47], v[116:119]
    v_exp_f32 v168, v168
    v_mfma_f32_16x16x32_bf16 v[172:175], a[196:199], v[48:51], v[172:175]
    ds_read_b64_tr_b16 a[240:241], v216 offset:33792
    ds_read_b64_tr_b16 a[242:243], v216 offset:37888
    ds_read_b32 v8, v242 offset:24832
    v_mfma_f32_16x16x32_bf16 v[172:175], a[200:203], v[52:55], v[172:175]
    v_exp_f32 v169, v169
    v_mfma_f32_16x16x32_bf16 v[172:175], a[204:207], v[56:59], v[172:175]
    ds_read_b64_tr_b16 a[238:239], v219 offset:36864
    v_cvt_pk_bf16_f32 v194, v168, v169
    v_mfma_f32_16x16x32_bf16 v[176:179], a[208:211], v[44:47], v[116:119]
    v_exp_f32 v170, v170
    v_mfma_f32_16x16x32_bf16 v[176:179], a[212:215], v[48:51], v[176:179]
    ds_read_b64_tr_b16 a[246:247], v217 offset:37888
    ds_read_b64_tr_b16 a[248:249], v218 offset:33792
    v_mfma_f32_16x16x32_bf16 v[176:179], a[216:219], v[52:55], v[176:179]
    v_exp_f32 v171, v171
    v_mfma_f32_16x16x32_bf16 v[176:179], a[220:223], v[56:59], v[176:179]
    ds_read_b64_tr_b16 a[244:245], v217 offset:33792
    v_cvt_pk_bf16_f32 v195, v170, v171
    v_mfma_f32_16x16x32_bf16 v[180:183], a[192:195], v[60:63], v[120:123]
    ds_read_b64_tr_b16 a[250:251], v218 offset:37888
    ds_read_b64_tr_b16 a[252:253], v219 offset:33792
    v_mfma_f32_16x16x32_bf16 v[180:183], a[196:199], v[64:67], v[180:183]
    v_exp_f32 v172, v172
    v_mfma_f32_16x16x32_bf16 v[180:183], a[200:203], v[68:71], v[180:183]
    ds_read_b128 a[192:195], v208 offset:0
    ds_read_b128 a[196:199], v209 offset:0
    s_waitcnt lgkmcnt(7)
    v_pk_add_f32 v[76:77], v[76:77], v[92:93]
    v_pk_add_f32 v[78:79], v[78:79], v[94:95]
    v_pk_add_f32 v[80:81], v[80:81], v[96:97]
    v_pk_add_f32 v[82:83], v[82:83], v[98:99]
    v_pk_add_f32 v[84:85], v[84:85], v[100:101]
    v_pk_add_f32 v[86:87], v[86:87], v[102:103]
    v_pk_add_f32 v[88:89], v[88:89], v[104:105]
    v_pk_add_f32 v[90:91], v[90:91], v[106:107]
    v_mfma_f32_16x16x32_bf16 v[180:183], a[204:207], v[72:75], v[180:183]
    v_exp_f32 v173, v173
    v_mfma_f32_16x16x32_bf16 v[184:187], a[208:211], v[60:63], v[120:123]
    ds_read_b64_tr_b16 a[254:255], v219 offset:37888
    ds_read_b128 v[92:95], v234 offset:16384
    v_cvt_pk_bf16_f32 v196, v172, v173
    v_pk_add_f32 v[76:77], v[76:77], v[124:125]
    v_pk_add_f32 v[78:79], v[78:79], v[126:127]
    v_pk_add_f32 v[80:81], v[80:81], v[128:129]
    v_pk_add_f32 v[82:83], v[82:83], v[130:131]
    v_pk_add_f32 v[84:85], v[84:85], v[148:149]
    v_pk_add_f32 v[86:87], v[86:87], v[150:151]
    v_pk_add_f32 v[88:89], v[88:89], v[152:153]
    v_pk_add_f32 v[90:91], v[90:91], v[154:155]
    v_add_f32 v236, v236, v237
    v_add_f32 v238, v238, v239
    v_add_f32 v236, v236, v238
    v_add_f32 v5, v5, v6
    v_add_f32 v7, v7, v8
    v_add_f32 v5, v5, v7
    v_rcp_f32 v236, v236
    v_rcp_f32 v237, v5
    v_mfma_f32_16x16x32_bf16 v[184:187], a[212:215], v[64:67], v[184:187]
    v_exp_f32 v174, v174
    v_mfma_f32_16x16x32_bf16 v[184:187], a[216:219], v[68:71], v[184:187]
    ds_read_b128 a[204:207], v209 offset:1024
    ds_read_b128 a[208:211], v208 offset:4096
    ds_read_b128 v[96:99], v234 offset:17408
    ds_read_b128 v[100:103], v234 offset:24576
    v_mfma_f32_16x16x32_bf16 v[184:187], a[220:223], v[72:75], v[184:187]
    v_exp_f32 v175, v175
    v_mfma_f32_16x16x32_bf16 a[0:3], a[224:227], v[188:191], a[0:3]
    ds_read_b128 a[200:203], v208 offset:1024
    ds_read_b128 v[104:107], v234 offset:25600
    v_cvt_pk_bf16_f32 v197, v174, v175
    v_mfma_f32_16x16x32_bf16 a[4:7], a[228:231], v[188:191], a[4:7]
    v_exp_f32 v176, v176
    v_mfma_f32_16x16x32_bf16 a[8:11], a[232:235], v[188:191], a[8:11]
    ds_read_b128 a[216:219], v208 offset:5120
    ds_read_b128 a[220:223], v209 offset:5120
    v_mfma_f32_16x16x32_bf16 a[12:15], a[236:239], v[188:191], a[12:15]
    v_exp_f32 v177, v177
    v_mfma_f32_16x16x32_bf16 a[16:19], a[240:243], v[188:191], a[16:19]
    s_waitcnt lgkmcnt(4)
    ds_read_b128 a[212:215], v209 offset:4096
    v_cvt_pk_bf16_f32 v198, v176, v177
    v_mfma_f32_16x16x32_bf16 a[20:23], a[244:247], v[188:191], a[20:23]
    v_exp_f32 v178, v178
    v_mfma_f32_16x16x32_bf16 a[24:27], a[248:251], v[188:191], a[24:27]
    v_add_f32 v140, v140, v172
    v_add_f32 v141, v141, v173
    v_mfma_f32_16x16x32_bf16 a[28:31], a[252:255], v[188:191], a[28:31]
    v_exp_f32 v179, v179
    v_mfma_f32_16x16x32_bf16 a[32:35], a[224:227], v[192:195], a[32:35]
    v_cvt_pk_bf16_f32 v199, v178, v179
    v_add_f32 v133, v133, v163
    v_mfma_f32_16x16x32_bf16 a[36:39], a[228:231], v[192:195], a[36:39]
    v_exp_f32 v180, v180
    v_mfma_f32_16x16x32_bf16 a[40:43], a[232:235], v[192:195], a[40:43]
    s_waitcnt lgkmcnt(0)
    s_barrier
    s_add_u32 m0, s91, 69632
    s_xor_b32 s64, s63, 32768
    v_add_f32 v141, v141, v175
    v_add_f32 v140, v140, v176
    v_pk_add_f32 v[76:77], v[76:77], v[92:93]
    v_pk_add_f32 v[78:79], v[78:79], v[94:95]
    v_pk_add_f32 v[80:81], v[80:81], v[96:97]
    v_pk_add_f32 v[82:83], v[82:83], v[98:99]
    v_pk_add_f32 v[84:85], v[84:85], v[100:101]
    v_pk_add_f32 v[86:87], v[86:87], v[102:103]
    v_pk_add_f32 v[88:89], v[88:89], v[104:105]
    v_pk_add_f32 v[90:91], v[90:91], v[106:107]
    v_pk_mul_f32 v[76:77], v[76:77], v[236:237] op_sel:[0,0] op_sel_hi:[1,0]
    v_pk_mul_f32 v[78:79], v[78:79], v[236:237] op_sel:[0,0] op_sel_hi:[1,0]
    v_pk_mul_f32 v[80:81], v[80:81], v[236:237] op_sel:[0,0] op_sel_hi:[1,0]
    v_pk_mul_f32 v[82:83], v[82:83], v[236:237] op_sel:[0,0] op_sel_hi:[1,0]
    v_pk_mul_f32 v[84:85], v[84:85], v[236:237] op_sel:[0,1] op_sel_hi:[1,1]
    v_pk_mul_f32 v[86:87], v[86:87], v[236:237] op_sel:[0,1] op_sel_hi:[1,1]
    v_pk_mul_f32 v[88:89], v[88:89], v[236:237] op_sel:[0,1] op_sel_hi:[1,1]
    v_pk_mul_f32 v[90:91], v[90:91], v[236:237] op_sel:[0,1] op_sel_hi:[1,1]
    v_cvt_pk_bf16_f32 v92, v76, v77
    v_cvt_pk_bf16_f32 v93, v78, v79
    v_cvt_pk_bf16_f32 v94, v80, v81
    v_cvt_pk_bf16_f32 v95, v82, v83
    v_cvt_pk_bf16_f32 v96, v84, v85
    v_cvt_pk_bf16_f32 v97, v86, v87
    v_cvt_pk_bf16_f32 v98, v88, v89
    v_cvt_pk_bf16_f32 v99, v90, v91
    v_mfma_f32_16x16x32_bf16 a[44:47], a[236:239], v[192:195], a[44:47]
    buffer_load_dwordx4 v1, s[8:11], s64 offen offset:0 lds
    v_exp_f32 v181, v181
    v_mfma_f32_16x16x32_bf16 a[48:51], a[240:243], v[192:195], a[48:51]
    buffer_store_dwordx4 v[92:95], v10, s[24:27], s66 offen sc1
    s_waitcnt vmcnt(2)
    ds_read_b64_tr_b16 a[128:129], v248 offset:0
    v_cvt_pk_bf16_f32 v200, v180, v181
    v_add_f32 v140, v140, v174
    v_mfma_f32_16x16x32_bf16 a[52:55], a[244:247], v[192:195], a[52:55]
    buffer_load_dwordx4 v2, s[8:11], s64 offen offset:1024 lds
    v_exp_f32 v182, v182
    v_mfma_f32_16x16x32_bf16 a[56:59], a[248:251], v[192:195], a[56:59]
    buffer_store_dwordx4 v[96:99], v10, s[24:27], s7 offen sc1
    ds_read_b64_tr_b16 a[130:131], v248 offset:2048
    v_add_f32 v140, v140, v178
    v_add_f32 v141, v141, v179
    v_mfma_f32_16x16x32_bf16 a[60:63], a[252:255], v[192:195], a[60:63]
    ds_read_b64_tr_b16 a[132:133], v249 offset:0
    v_exp_f32 v183, v183
    v_mfma_f32_16x16x32_bf16 v[136:139], v[228:231], v[192:195], v[136:139]
    buffer_load_dwordx4 v3, s[8:11], s64 offen offset:2048 lds
    v_cvt_pk_bf16_f32 v201, v182, v183
    v_add_f32 v141, v141, v177
    v_mfma_f32_16x16x32_bf16 v[156:159], a[192:195], v[12:15], v[108:111]
    ds_read_b64_tr_b16 a[134:135], v249 offset:2048
    v_exp_f32 v184, v184
    v_mfma_f32_16x16x32_bf16 v[156:159], a[196:199], v[16:19], v[156:159]
    buffer_load_dwordx4 v4, s[8:11], s64 offen offset:3072 lds
    ds_read_b64_tr_b16 a[136:137], v250 offset:0
    v_mfma_f32_16x16x32_bf16 v[156:159], a[200:203], v[20:23], v[156:159]
    v_exp_f32 v185, v185
    v_mfma_f32_16x16x32_bf16 v[156:159], a[204:207], v[24:27], v[156:159]
    ds_read_b64_tr_b16 a[138:139], v250 offset:2048
    ds_read_b64_tr_b16 a[140:141], v251 offset:0
    v_cvt_pk_bf16_f32 v202, v184, v185
    v_mfma_f32_16x16x32_bf16 v[160:163], a[208:211], v[12:15], v[108:111]
    v_exp_f32 v186, v186
    v_mfma_f32_16x16x32_bf16 v[160:163], a[212:215], v[16:19], v[160:163]
    ds_read_b64_tr_b16 a[142:143], v251 offset:2048
    v_mfma_f32_16x16x32_bf16 v[160:163], a[216:219], v[20:23], v[160:163]
    v_exp_f32 v187, v187
    v_mfma_f32_16x16x32_bf16 v[160:163], a[220:223], v[24:27], v[160:163]
    v_cvt_pk_bf16_f32 v203, v186, v187
    v_mfma_f32_16x16x32_bf16 v[164:167], a[192:195], v[28:31], v[112:115]
    v_mfma_f32_16x16x32_bf16 v[164:167], a[196:199], v[32:35], v[164:167]
    v_exp_f32 v156, v156
    v_mfma_f32_16x16x32_bf16 v[164:167], a[200:203], v[36:39], v[164:167]
    v_mfma_f32_16x16x32_bf16 v[164:167], a[204:207], v[40:43], v[164:167]
    s_add_u32 m0, s91, 0
    s_xor_b32 s64, s63, 65536
    v_exp_f32 v157, v157
    v_mfma_f32_16x16x32_bf16 v[168:171], a[208:211], v[28:31], v[112:115]
    buffer_load_dwordx4 v1, s[8:11], s64 offen offset:0 lds
    v_cvt_pk_bf16_f32 v188, v156, v157
    v_add_f32 v132, v132, v156
    v_mfma_f32_16x16x32_bf16 v[168:171], a[212:215], v[32:35], v[168:171]
    v_exp_f32 v158, v158
    v_mfma_f32_16x16x32_bf16 v[168:171], a[216:219], v[36:39], v[168:171]
    buffer_load_dwordx4 v2, s[8:11], s64 offen offset:1024 lds
    v_add_f32 v132, v132, v158
    v_mfma_f32_16x16x32_bf16 v[168:171], a[220:223], v[40:43], v[168:171]
    v_exp_f32 v159, v159
    v_mfma_f32_16x16x32_bf16 a[64:67], a[224:227], v[196:199], a[64:67]
    buffer_load_dwordx4 v3, s[8:11], s64 offen offset:2048 lds
    v_cvt_pk_bf16_f32 v189, v158, v159
    v_add_f32 v133, v133, v157
    v_mfma_f32_16x16x32_bf16 a[68:71], a[228:231], v[196:199], a[68:71]
    v_exp_f32 v160, v160
    v_mfma_f32_16x16x32_bf16 a[72:75], a[232:235], v[196:199], a[72:75]
    buffer_load_dwordx4 v4, s[8:11], s64 offen offset:3072 lds
    v_add_f32 v132, v132, v160
    v_mfma_f32_16x16x32_bf16 a[76:79], a[236:239], v[196:199], a[76:79]
    v_exp_f32 v161, v161
    v_mfma_f32_16x16x32_bf16 a[80:83], a[240:243], v[196:199], a[80:83]
    v_cvt_pk_bf16_f32 v190, v160, v161
    v_add_f32 v133, v133, v159
    v_mfma_f32_16x16x32_bf16 a[84:87], a[244:247], v[196:199], a[84:87]
    v_exp_f32 v162, v162
    v_mfma_f32_16x16x32_bf16 a[88:91], a[248:251], v[196:199], a[88:91]
    v_add_f32 v133, v133, v161
    v_add_f32 v132, v132, v162
    v_mfma_f32_16x16x32_bf16 a[92:95], a[252:255], v[196:199], a[92:95]
    v_exp_f32 v163, v163
    v_mfma_f32_16x16x32_bf16 a[96:99], a[224:227], v[200:203], a[96:99]
    ds_read_b64_tr_b16 a[224:225], v220 offset:32768
    v_cvt_pk_bf16_f32 v191, v162, v163
    v_mfma_f32_16x16x32_bf16 a[100:103], a[228:231], v[200:203], a[100:103]
    v_exp_f32 v164, v164
    v_mfma_f32_16x16x32_bf16 a[104:107], a[232:235], v[200:203], a[104:107]
    ds_read_b64_tr_b16 a[228:229], v221 offset:32768
    ds_read_b64_tr_b16 a[230:231], v221 offset:36864
    v_mfma_f32_16x16x32_bf16 a[108:111], a[236:239], v[200:203], a[108:111]
    s_add_u32 m0, s91, 4096
    s_xor_b32 s64, s63, 98304
    v_exp_f32 v165, v165
    v_mfma_f32_16x16x32_bf16 a[112:115], a[240:243], v[200:203], a[112:115]
    ds_read_b64_tr_b16 a[226:227], v220 offset:36864
    buffer_load_dwordx4 v1, s[8:11], s64 offen offset:0 lds
    v_cvt_pk_bf16_f32 v192, v164, v165
    v_mfma_f32_16x16x32_bf16 a[116:119], a[244:247], v[200:203], a[116:119]
    v_exp_f32 v166, v166
    v_mfma_f32_16x16x32_bf16 a[120:123], a[248:251], v[200:203], a[120:123]
    ds_read_b64_tr_b16 a[234:235], v222 offset:36864
    ds_read_b64_tr_b16 a[236:237], v223 offset:32768
    buffer_load_dwordx4 v2, s[8:11], s64 offen offset:1024 lds
    v_mfma_f32_16x16x32_bf16 a[124:127], a[252:255], v[200:203], a[124:127]
    v_exp_f32 v167, v167
    v_mfma_f32_16x16x32_bf16 v[144:147], v[228:231], v[200:203], v[144:147]
    ds_read_b64_tr_b16 a[232:233], v222 offset:32768
    buffer_load_dwordx4 v3, s[8:11], s64 offen offset:2048 lds
    v_cvt_pk_bf16_f32 v193, v166, v167
    v_mfma_f32_16x16x32_bf16 v[172:175], a[192:195], v[44:47], v[116:119]
    v_exp_f32 v168, v168
    v_mfma_f32_16x16x32_bf16 v[172:175], a[196:199], v[48:51], v[172:175]
    ds_read_b64_tr_b16 a[240:241], v220 offset:33792
    ds_read_b64_tr_b16 a[242:243], v220 offset:37888
    buffer_load_dwordx4 v4, s[8:11], s64 offen offset:3072 lds
    v_mfma_f32_16x16x32_bf16 v[172:175], a[200:203], v[52:55], v[172:175]
    v_exp_f32 v169, v169
    v_mfma_f32_16x16x32_bf16 v[172:175], a[204:207], v[56:59], v[172:175]
    ds_read_b64_tr_b16 a[238:239], v223 offset:36864
    v_cvt_pk_bf16_f32 v194, v168, v169
    v_mfma_f32_16x16x32_bf16 v[176:179], a[208:211], v[44:47], v[116:119]
    v_exp_f32 v170, v170
    v_mfma_f32_16x16x32_bf16 v[176:179], a[212:215], v[48:51], v[176:179]
    ds_read_b64_tr_b16 a[246:247], v221 offset:37888
    ds_read_b64_tr_b16 a[248:249], v222 offset:33792
    v_mfma_f32_16x16x32_bf16 v[176:179], a[216:219], v[52:55], v[176:179]
    v_exp_f32 v171, v171
    v_mfma_f32_16x16x32_bf16 v[176:179], a[220:223], v[56:59], v[176:179]
    ds_read_b64_tr_b16 a[244:245], v221 offset:33792
    v_cvt_pk_bf16_f32 v195, v170, v171
    v_mfma_f32_16x16x32_bf16 v[180:183], a[192:195], v[60:63], v[120:123]
    s_cmp_lg_u32 s3, 0
    s_cbranch_scc1 L_noget
    v_mov_b32 v243, 0
    s_mov_b64 exec, 1
    global_load_dword v243, v243, s[44:45] sc1
    s_mov_b64 exec, -1
    s_nop 3
L_noget:
    ds_read_b64_tr_b16 a[250:251], v222 offset:37888
    ds_read_b64_tr_b16 a[252:253], v223 offset:33792
    v_mfma_f32_16x16x32_bf16 v[180:183], a[196:199], v[64:67], v[180:183]
    v_exp_f32 v172, v172
    v_mfma_f32_16x16x32_bf16 v[180:183], a[200:203], v[68:71], v[180:183]
    ds_read_b128 a[192:195], v210 offset:0
    ds_read_b128 a[196:199], v211 offset:0
    v_mfma_f32_16x16x32_bf16 v[180:183], a[204:207], v[72:75], v[180:183]
    s_add_u32 m0, s91, 131072
    s_xor_b32 s64, s63, 131072
    v_exp_f32 v173, v173
    v_mfma_f32_16x16x32_bf16 v[184:187], a[208:211], v[60:63], v[120:123]
    ds_read_b64_tr_b16 a[254:255], v223 offset:37888
    buffer_load_dwordx4 v1, s[8:11], s64 offen offset:0 lds
    v_cvt_pk_bf16_f32 v196, v172, v173
    v_mfma_f32_16x16x32_bf16 v[184:187], a[212:215], v[64:67], v[184:187]
    v_exp_f32 v174, v174
    v_mfma_f32_16x16x32_bf16 v[184:187], a[216:219], v[68:71], v[184:187]
    ds_read_b128 a[204:207], v211 offset:1024
    ds_read_b128 a[208:211], v210 offset:4096
    buffer_load_dwordx4 v2, s[8:11], s64 offen offset:1024 lds
    v_mfma_f32_16x16x32_bf16 v[184:187], a[220:223], v[72:75], v[184:187]
    s_waitcnt lgkmcnt(5)
    s_waitcnt vmcnt(10)
    ds_read_b64_tr_b16 a[144:145], v248 offset:4096
    v_exp_f32 v175, v175
    v_mfma_f32_16x16x32_bf16 a[0:3], a[224:227], v[188:191], a[0:3]
    ds_read_b128 a[200:203], v210 offset:1024
    buffer_load_dwordx4 v3, s[8:11], s64 offen offset:2048 lds
    v_cvt_pk_bf16_f32 v197, v174, v175
    v_mfma_f32_16x16x32_bf16 a[4:7], a[228:231], v[188:191], a[4:7]
    ds_read_b64_tr_b16 a[146:147], v248 offset:6144
    ds_read_b64_tr_b16 a[148:149], v249 offset:4096
    v_exp_f32 v176, v176
    v_mfma_f32_16x16x32_bf16 a[8:11], a[232:235], v[188:191], a[8:11]
    ds_read_b128 a[216:219], v210 offset:5120
    ds_read_b128 a[220:223], v211 offset:5120
    buffer_load_dwordx4 v4, s[8:11], s64 offen offset:3072 lds
    v_mfma_f32_16x16x32_bf16 a[12:15], a[236:239], v[188:191], a[12:15]
    ds_read_b64_tr_b16 a[150:151], v249 offset:6144
    v_exp_f32 v177, v177
    v_mfma_f32_16x16x32_bf16 a[16:19], a[240:243], v[188:191], a[16:19]
    ds_read_b128 a[212:215], v211 offset:4096
    ds_read_b64_tr_b16 a[152:153], v250 offset:4096
    v_cvt_pk_bf16_f32 v198, v176, v177
    v_mfma_f32_16x16x32_bf16 a[20:23], a[244:247], v[188:191], a[20:23]
    v_exp_f32 v178, v178
    v_mfma_f32_16x16x32_bf16 a[24:27], a[248:251], v[188:191], a[24:27]
    s_waitcnt lgkmcnt(7)
    ds_read_b64_tr_b16 a[154:155], v250 offset:6144
    ds_read_b64_tr_b16 a[156:157], v251 offset:4096
    v_add_f32 v140, v140, v172
    v_add_f32 v141, v141, v173
    v_mfma_f32_16x16x32_bf16 a[28:31], a[252:255], v[188:191], a[28:31]
    v_exp_f32 v179, v179
    v_mfma_f32_16x16x32_bf16 a[32:35], a[224:227], v[192:195], a[32:35]
    ds_read_b64_tr_b16 a[158:159], v251 offset:6144
    v_cvt_pk_bf16_f32 v199, v178, v179
    v_add_f32 v133, v133, v163
    v_mfma_f32_16x16x32_bf16 a[36:39], a[228:231], v[192:195], a[36:39]
    v_exp_f32 v180, v180
    v_mfma_f32_16x16x32_bf16 a[40:43], a[232:235], v[192:195], a[40:43]
    v_add_f32 v141, v141, v175
    v_add_f32 v140, v140, v176
    v_mfma_f32_16x16x32_bf16 a[44:47], a[236:239], v[192:195], a[44:47]
    v_exp_f32 v181, v181
    v_mfma_f32_16x16x32_bf16 a[48:51], a[240:243], v[192:195], a[48:51]
    v_cvt_pk_bf16_f32 v200, v180, v181
    v_add_f32 v140, v140, v174
    v_mfma_f32_16x16x32_bf16 a[52:55], a[244:247], v[192:195], a[52:55]
    s_add_u32 m0, s91, 135168
    s_xor_b32 s64, s63, 163840
    v_exp_f32 v182, v182
    v_mfma_f32_16x16x32_bf16 a[56:59], a[248:251], v[192:195], a[56:59]
    buffer_load_dwordx4 v1, s[8:11], s64 offen offset:0 lds
    v_add_f32 v140, v140, v178
    v_add_f32 v141, v141, v179
    v_mfma_f32_16x16x32_bf16 a[60:63], a[252:255], v[192:195], a[60:63]
    v_exp_f32 v183, v183
    v_mfma_f32_16x16x32_bf16 v[136:139], v[228:231], v[192:195], v[136:139]
    buffer_load_dwordx4 v2, s[8:11], s64 offen offset:1024 lds
    v_cvt_pk_bf16_f32 v201, v182, v183
    v_add_f32 v141, v141, v177
    v_mfma_f32_16x16x32_bf16 v[156:159], a[192:195], v[12:15], v[108:111]
    s_waitcnt vmcnt(10)
    ds_read_b64_tr_b16 a[160:161], v244 offset:0
    v_exp_f32 v184, v184
    v_mfma_f32_16x16x32_bf16 v[156:159], a[196:199], v[16:19], v[156:159]
    buffer_load_dwordx4 v3, s[8:11], s64 offen offset:2048 lds
    ds_read_b64_tr_b16 a[162:163], v244 offset:2048
    ds_read_b64_tr_b16 a[164:165], v245 offset:0
    v_mfma_f32_16x16x32_bf16 v[156:159], a[200:203], v[20:23], v[156:159]
    ds_read_b64_tr_b16 a[166:167], v245 offset:2048
    v_exp_f32 v185, v185
    v_mfma_f32_16x16x32_bf16 v[156:159], a[204:207], v[24:27], v[156:159]
    buffer_load_dwordx4 v4, s[8:11], s64 offen offset:3072 lds
    ds_read_b64_tr_b16 a[168:169], v246 offset:0
    v_cvt_pk_bf16_f32 v202, v184, v185
    v_mfma_f32_16x16x32_bf16 v[160:163], a[208:211], v[12:15], v[108:111]
    s_waitcnt lgkmcnt(5)
    v_exp_f32 v186, v186
    v_mfma_f32_16x16x32_bf16 v[160:163], a[212:215], v[16:19], v[160:163]
    ds_read_b64_tr_b16 a[170:171], v246 offset:2048
    ds_read_b64_tr_b16 a[172:173], v247 offset:0
    v_mfma_f32_16x16x32_bf16 v[160:163], a[216:219], v[20:23], v[160:163]
    v_exp_f32 v187, v187
    v_mfma_f32_16x16x32_bf16 v[160:163], a[220:223], v[24:27], v[160:163]
    ds_read_b64_tr_b16 a[174:175], v247 offset:2048
    v_cvt_pk_bf16_f32 v203, v186, v187
    v_mfma_f32_16x16x32_bf16 v[164:167], a[192:195], v[28:31], v[112:115]
    v_mfma_f32_16x16x32_bf16 v[164:167], a[196:199], v[32:35], v[164:167]
    v_exp_f32 v156, v156
    v_mfma_f32_16x16x32_bf16 v[164:167], a[200:203], v[36:39], v[164:167]
    v_mfma_f32_16x16x32_bf16 v[164:167], a[204:207], v[40:43], v[164:167]
    v_exp_f32 v157, v157
    v_mfma_f32_16x16x32_bf16 v[168:171], a[208:211], v[28:31], v[112:115]
    v_cvt_pk_bf16_f32 v188, v156, v157
    v_add_f32 v132, v132, v156
    v_mfma_f32_16x16x32_bf16 v[168:171], a[212:215], v[32:35], v[168:171]
    s_waitcnt lgkmcnt(15)
    s_add_u32 m0, s91, 65536
    s_xor_b32 s64, s63, 196608
    v_exp_f32 v158, v158
    v_mfma_f32_16x16x32_bf16 v[168:171], a[216:219], v[36:39], v[168:171]
    buffer_load_dwordx4 v1, s[8:11], s64 offen offset:0 lds
    v_add_f32 v132, v132, v158
    v_mfma_f32_16x16x32_bf16 v[168:171], a[220:223], v[40:43], v[168:171]
    s_waitcnt vmcnt(9)
    ds_read_b64_tr_b16 a[176:177], v244 offset:4096
    v_exp_f32 v159, v159
    v_mfma_f32_16x16x32_bf16 a[64:67], a[224:227], v[196:199], a[64:67]
    buffer_load_dwordx4 v2, s[8:11], s64 offen offset:1024 lds
    v_cvt_pk_bf16_f32 v189, v158, v159
    v_add_f32 v133, v133, v157
    v_mfma_f32_16x16x32_bf16 a[68:71], a[228:231], v[196:199], a[68:71]
    ds_read_b64_tr_b16 a[178:179], v244 offset:6144
    v_exp_f32 v160, v160
    v_mfma_f32_16x16x32_bf16 a[72:75], a[232:235], v[196:199], a[72:75]
    buffer_load_dwordx4 v3, s[8:11], s64 offen offset:2048 lds
    ds_read_b64_tr_b16 a[180:181], v245 offset:4096
    v_add_f32 v132, v132, v160
    v_mfma_f32_16x16x32_bf16 a[76:79], a[236:239], v[196:199], a[76:79]
    ds_read_b64_tr_b16 a[182:183], v245 offset:6144
    ds_read_b64_tr_b16 a[184:185], v246 offset:4096
    v_exp_f32 v161, v161
    v_mfma_f32_16x16x32_bf16 a[80:83], a[240:243], v[196:199], a[80:83]
    buffer_load_dwordx4 v4, s[8:11], s64 offen offset:3072 lds
    v_cvt_pk_bf16_f32 v190, v160, v161
    v_add_f32 v133, v133, v159
    v_mfma_f32_16x16x32_bf16 a[84:87], a[244:247], v[196:199], a[84:87]
    ds_read_b64_tr_b16 a[186:187], v246 offset:6144
    v_exp_f32 v162, v162
    v_mfma_f32_16x16x32_bf16 a[88:91], a[248:251], v[196:199], a[88:91]
    ds_read_b64_tr_b16 a[188:189], v247 offset:4096
    v_add_f32 v133, v133, v161
    v_add_f32 v132, v132, v162
    v_mfma_f32_16x16x32_bf16 a[92:95], a[252:255], v[196:199], a[92:95]
    v_exp_f32 v163, v163
    v_mfma_f32_16x16x32_bf16 a[96:99], a[224:227], v[200:203], a[96:99]
    ds_read_b64_tr_b16 a[224:225], v224 offset:32768
    ds_read_b64_tr_b16 a[190:191], v247 offset:6144
    v_cvt_pk_bf16_f32 v191, v162, v163
    v_mfma_f32_16x16x32_bf16 a[100:103], a[228:231], v[200:203], a[100:103]
    v_exp_f32 v164, v164
    v_mfma_f32_16x16x32_bf16 a[104:107], a[232:235], v[200:203], a[104:107]
    ds_read_b64_tr_b16 a[228:229], v225 offset:32768
    ds_read_b64_tr_b16 a[230:231], v225 offset:36864
    v_mfma_f32_16x16x32_bf16 a[108:111], a[236:239], v[200:203], a[108:111]
    v_exp_f32 v165, v165
    v_mfma_f32_16x16x32_bf16 a[112:115], a[240:243], v[200:203], a[112:115]
    ds_read_b64_tr_b16 a[226:227], v224 offset:36864
    v_cvt_pk_bf16_f32 v192, v164, v165
    v_mfma_f32_16x16x32_bf16 a[116:119], a[244:247], v[200:203], a[116:119]
    s_waitcnt lgkmcnt(15)
    s_add_u32 m0, s91, 69632
    s_xor_b32 s64, s63, 229376
    v_exp_f32 v166, v166
    v_mfma_f32_16x16x32_bf16 a[120:123], a[248:251], v[200:203], a[120:123]
    ds_read_b64_tr_b16 a[234:235], v226 offset:36864
    ds_read_b64_tr_b16 a[236:237], v227 offset:32768
    buffer_load_dwordx4 v1, s[8:11], s64 offen offset:0 lds
    v_mfma_f32_16x16x32_bf16 a[124:127], a[252:255], v[200:203], a[124:127]
    v_exp_f32 v167, v167
    v_mfma_f32_16x16x32_bf16 v[144:147], v[228:231], v[200:203], v[144:147]
    ds_read_b64_tr_b16 a[232:233], v226 offset:32768
    buffer_load_dwordx4 v2, s[8:11], s64 offen offset:1024 lds
    v_cvt_pk_bf16_f32 v193, v166, v167
    v_mfma_f32_16x16x32_bf16 v[172:175], a[192:195], v[44:47], v[116:119]
    s_waitcnt vmcnt(10)
    ds_read_b64_tr_b16 v[76:77], v252 offset:0
    v_exp_f32 v168, v168
    v_mfma_f32_16x16x32_bf16 v[172:175], a[196:199], v[48:51], v[172:175]
    ds_read_b64_tr_b16 a[240:241], v224 offset:33792
    ds_read_b64_tr_b16 a[242:243], v224 offset:37888
    buffer_load_dwordx4 v3, s[8:11], s64 offen offset:2048 lds
    v_mfma_f32_16x16x32_bf16 v[172:175], a[200:203], v[52:55], v[172:175]
    ds_read_b64_tr_b16 v[78:79], v252 offset:2048
    ds_read_b64_tr_b16 v[80:81], v253 offset:0
    v_exp_f32 v169, v169
    v_mfma_f32_16x16x32_bf16 v[172:175], a[204:207], v[56:59], v[172:175]
    ds_read_b64_tr_b16 a[238:239], v227 offset:36864
    buffer_load_dwordx4 v4, s[8:11], s64 offen offset:3072 lds
    v_cvt_pk_bf16_f32 v194, v168, v169
    v_mfma_f32_16x16x32_bf16 v[176:179], a[208:211], v[44:47], v[116:119]
    ds_read_b64_tr_b16 v[82:83], v253 offset:2048
    v_exp_f32 v170, v170
    v_mfma_f32_16x16x32_bf16 v[176:179], a[212:215], v[48:51], v[176:179]
    ds_read_b64_tr_b16 a[246:247], v225 offset:37888
    ds_read_b64_tr_b16 a[248:249], v226 offset:33792
    ds_read_b64_tr_b16 v[84:85], v254 offset:0
    v_mfma_f32_16x16x32_bf16 v[176:179], a[216:219], v[52:55], v[176:179]
    v_exp_f32 v171, v171
    v_mfma_f32_16x16x32_bf16 v[176:179], a[220:223], v[56:59], v[176:179]
    ds_read_b64_tr_b16 a[244:245], v225 offset:33792
    ds_read_b64_tr_b16 v[86:87], v254 offset:2048
    v_cvt_pk_bf16_f32 v195, v170, v171
    v_mfma_f32_16x16x32_bf16 v[180:183], a[192:195], v[60:63], v[120:123]
    ds_read_b64_tr_b16 a[250:251], v226 offset:37888
    ds_read_b64_tr_b16 a[252:253], v227 offset:33792
    ds_read_b64_tr_b16 v[88:89], v255 offset:0
    v_mfma_f32_16x16x32_bf16 v[180:183], a[196:199], v[64:67], v[180:183]
    v_exp_f32 v172, v172
    v_mfma_f32_16x16x32_bf16 v[180:183], a[200:203], v[68:71], v[180:183]
    ds_read_b64_tr_b16 a[254:255], v227 offset:37888
    ds_read_b64_tr_b16 v[90:91], v255 offset:2048
    v_add_f32 v133, v133, v163
    v_mfma_f32_16x16x32_bf16 v[180:183], a[204:207], v[72:75], v[180:183]
    v_exp_f32 v173, v173
    v_mfma_f32_16x16x32_bf16 v[184:187], a[208:211], v[60:63], v[120:123]
    v_cvt_pk_bf16_f32 v196, v172, v173
    v_add_f32 v140, v140, v172
    v_mfma_f32_16x16x32_bf16 v[184:187], a[212:215], v[64:67], v[184:187]
    s_waitcnt lgkmcnt(15)
    s_add_u32 m0, s91, 0
    s_xor_b32 s64, s63, 262144
    v_exp_f32 v174, v174
    v_mfma_f32_16x16x32_bf16 v[184:187], a[216:219], v[68:71], v[184:187]
    buffer_load_dwordx4 v1, s[8:11], s64 offen offset:0 lds
    v_add_f32 v140, v140, v174
    v_mfma_f32_16x16x32_bf16 v[184:187], a[220:223], v[72:75], v[184:187]
    s_waitcnt lgkmcnt(2)
    v_exp_f32 v175, v175
    v_mfma_f32_16x16x32_bf16 a[0:3], a[224:227], v[188:191], a[0:3]
    s_waitcnt lgkmcnt(0)
    s_barrier
    buffer_load_dwordx4 v2, s[8:11], s64 offen offset:1024 lds
    v_cvt_pk_bf16_f32 v197, v174, v175
    v_add_f32 v141, v141, v173
    v_mfma_f32_16x16x32_bf16 a[4:7], a[228:231], v[188:191], a[4:7]
    s_waitcnt vmcnt(10)
    ds_read_b64_tr_b16 v[92:93], v252 offset:4096
    v_exp_f32 v176, v176
    v_mfma_f32_16x16x32_bf16 a[8:11], a[232:235], v[188:191], a[8:11]
    buffer_load_dwordx4 v3, s[8:11], s64 offen offset:2048 lds
    ds_read_b64_tr_b16 v[94:95], v252 offset:6144
    v_add_f32 v140, v140, v176
    v_mfma_f32_16x16x32_bf16 a[12:15], a[236:239], v[188:191], a[12:15]
    ds_read_b64_tr_b16 v[96:97], v253 offset:4096
    v_exp_f32 v177, v177
    v_mfma_f32_16x16x32_bf16 a[16:19], a[240:243], v[188:191], a[16:19]
    buffer_load_dwordx4 v4, s[8:11], s64 offen offset:3072 lds
    v_cvt_pk_bf16_f32 v198, v176, v177
    v_add_f32 v141, v141, v175
    v_mfma_f32_16x16x32_bf16 a[20:23], a[244:247], v[188:191], a[20:23]
    ds_read_b64_tr_b16 v[98:99], v253 offset:6144
    v_exp_f32 v178, v178
    v_mfma_f32_16x16x32_bf16 a[24:27], a[248:251], v[188:191], a[24:27]
    ds_read_b64_tr_b16 v[100:101], v254 offset:4096
    v_add_f32 v140, v140, v178
    v_mfma_f32_16x16x32_bf16 a[28:31], a[252:255], v[188:191], a[28:31]
    v_exp_f32 v179, v179
    v_mfma_f32_16x16x32_bf16 a[32:35], a[224:227], v[192:195], a[32:35]
    ds_read_b64_tr_b16 v[102:103], v254 offset:6144
    ds_read_b64_tr_b16 v[104:105], v255 offset:4096
    v_cvt_pk_bf16_f32 v199, v178, v179
    v_add_f32 v141, v141, v177
    v_mfma_f32_16x16x32_bf16 a[36:39], a[228:231], v[192:195], a[36:39]
    v_exp_f32 v180, v180
    v_mfma_f32_16x16x32_bf16 a[40:43], a[232:235], v[192:195], a[40:43]
    ds_read_b64_tr_b16 v[106:107], v255 offset:6144
    v_mfma_f32_16x16x32_bf16 a[44:47], a[236:239], v[192:195], a[44:47]
    v_exp_f32 v181, v181
    v_mfma_f32_16x16x32_bf16 a[48:51], a[240:243], v[192:195], a[48:51]
    v_cvt_pk_bf16_f32 v200, v180, v181
    v_add_f32 v141, v141, v179
    v_mfma_f32_16x16x32_bf16 a[52:55], a[244:247], v[192:195], a[52:55]
    v_exp_f32 v182, v182
    v_mfma_f32_16x16x32_bf16 a[56:59], a[248:251], v[192:195], a[56:59]
    v_mfma_f32_16x16x32_bf16 a[60:63], a[252:255], v[192:195], a[60:63]
    s_waitcnt lgkmcnt(15)
    s_add_u32 m0, s91, 4096
    s_xor_b32 s64, s63, 294912
    v_exp_f32 v183, v183
    v_mfma_f32_16x16x32_bf16 v[136:139], v[228:231], v[192:195], v[136:139]
    buffer_load_dwordx4 v1, s[8:11], s64 offen offset:0 lds
    v_cvt_pk_bf16_f32 v201, v182, v183
    v_mfma_f32_16x16x32_bf16 a[64:67], a[224:227], v[196:199], a[64:67]
    v_exp_f32 v184, v184
    v_mfma_f32_16x16x32_bf16 a[68:71], a[228:231], v[196:199], a[68:71]
    s_waitcnt vmcnt(9)
    ds_read_b64_tr_b16 a[192:193], v248 offset:0
    v_exp_f32 v185, v185
    v_mfma_f32_16x16x32_bf16 a[72:75], a[232:235], v[196:199], a[72:75]
    buffer_load_dwordx4 v2, s[8:11], s64 offen offset:1024 lds
    ds_read_b64_tr_b16 a[194:195], v248 offset:2048
    v_cvt_pk_bf16_f32 v202, v184, v185
    v_mfma_f32_16x16x32_bf16 a[76:79], a[236:239], v[196:199], a[76:79]
    ds_read_b64_tr_b16 a[196:197], v249 offset:0
    v_exp_f32 v186, v186
    v_mfma_f32_16x16x32_bf16 a[80:83], a[240:243], v[196:199], a[80:83]
    ds_read_b64_tr_b16 a[198:199], v249 offset:2048
    v_exp_f32 v187, v187
    v_mfma_f32_16x16x32_bf16 a[84:87], a[244:247], v[196:199], a[84:87]
    buffer_load_dwordx4 v3, s[8:11], s64 offen offset:2048 lds
    ds_read_b64_tr_b16 a[200:201], v250 offset:0
    v_cvt_pk_bf16_f32 v203, v186, v187
    v_mfma_f32_16x16x32_bf16 a[88:91], a[248:251], v[196:199], a[88:91]
    ds_read_b64_tr_b16 a[202:203], v250 offset:2048
    ds_read_b64_tr_b16 a[204:205], v251 offset:0
    v_mfma_f32_16x16x32_bf16 a[92:95], a[252:255], v[196:199], a[92:95]
    buffer_load_dwordx4 v4, s[8:11], s64 offen offset:3072 lds
    v_mfma_f32_16x16x32_bf16 a[96:99], a[224:227], v[200:203], a[96:99]
    ds_read_b64_tr_b16 a[206:207], v251 offset:2048
    v_mfma_f32_16x16x32_bf16 a[100:103], a[228:231], v[200:203], a[100:103]
    v_mfma_f32_16x16x32_bf16 a[104:107], a[232:235], v[200:203], a[104:107]
    v_mfma_f32_16x16x32_bf16 a[108:111], a[236:239], v[200:203], a[108:111]
    v_mfma_f32_16x16x32_bf16 a[112:115], a[240:243], v[200:203], a[112:115]
    v_mfma_f32_16x16x32_bf16 a[116:119], a[244:247], v[200:203], a[116:119]
    v_mfma_f32_16x16x32_bf16 a[120:123], a[248:251], v[200:203], a[120:123]
    v_mfma_f32_16x16x32_bf16 a[124:127], a[252:255], v[200:203], a[124:127]
    v_mfma_f32_16x16x32_bf16 v[144:147], v[228:231], v[200:203], v[144:147]
L_tail:
    v_add_f32 v132, v132, v133
    v_add_f32 v140, v140, v141
    v_mov_b32 v134, v132
    v_mov_b32 v142, v140
    s_nop 0
    v_permlane32_swap_b32 v132, v134
    v_permlane32_swap_b32 v140, v142
    v_add_f32 v132, v132, v134
    v_add_f32 v140, v140, v142
    v_mov_b32 v134, v132
    v_mov_b32 v142, v140
    s_nop 0
    v_permlane16_swap_b32 v132, v134
    v_permlane16_swap_b32 v140, v142
    v_add_f32 v132, v132, v134
    v_add_f32 v140, v140, v142
    v_rcp_f32 v236, v132
    v_rcp_f32 v237, v136
    v_rcp_f32 v238, v140
    v_rcp_f32 v239, v144
    v_accvgpr_read_b32 v108, a0
    v_accvgpr_read_b32 v109, a1
    v_accvgpr_read_b32 v110, a2
    v_accvgpr_read_b32 v111, a3
    v_accvgpr_read_b32 v112, a4
    v_accvgpr_read_b32 v113, a5
    v_accvgpr_read_b32 v114, a6
    v_accvgpr_read_b32 v115, a7
    v_pk_mul_f32 v[108:109], v[108:109], v[236:237] op_sel:[0,0] op_sel_hi:[1,0]
    v_pk_mul_f32 v[110:111], v[110:111], v[236:237] op_sel:[0,0] op_sel_hi:[1,0]
    v_pk_mul_f32 v[112:113], v[112:113], v[236:237] op_sel:[0,0] op_sel_hi:[1,0]
    v_pk_mul_f32 v[114:115], v[114:115], v[236:237] op_sel:[0,0] op_sel_hi:[1,0]
    v_cvt_pk_bf16_f32 v116, v108, v109
    v_cvt_pk_bf16_f32 v117, v110, v111
    v_cvt_pk_bf16_f32 v118, v112, v113
    v_cvt_pk_bf16_f32 v119, v114, v115
    buffer_store_dwordx4 v[116:119], v10, s[24:27], s6 offen offset:0 sc1
    v_accvgpr_read_b32 v120, a8
    v_accvgpr_read_b32 v121, a9
    v_accvgpr_read_b32 v122, a10
    v_accvgpr_read_b32 v123, a11
    v_accvgpr_read_b32 v124, a12
    v_accvgpr_read_b32 v125, a13
    v_accvgpr_read_b32 v126, a14
    v_accvgpr_read_b32 v127, a15
    v_pk_mul_f32 v[120:121], v[120:121], v[236:237] op_sel:[0,0] op_sel_hi:[1,0]
    v_pk_mul_f32 v[122:123], v[122:123], v[236:237] op_sel:[0,0] op_sel_hi:[1,0]
    v_pk_mul_f32 v[124:125], v[124:125], v[236:237] op_sel:[0,0] op_sel_hi:[1,0]
    v_pk_mul_f32 v[126:127], v[126:127], v[236:237] op_sel:[0,0] op_sel_hi:[1,0]
    v_cvt_pk_bf16_f32 v128, v120, v121
    v_cvt_pk_bf16_f32 v129, v122, v123
    v_cvt_pk_bf16_f32 v130, v124, v125
    v_cvt_pk_bf16_f32 v131, v126, v127
    buffer_store_dwordx4 v[128:131], v10, s[24:27], s6 offen offset:1024 sc1
    s_mov_b32 s66, 0x5f800000
    v_add_f32 v232, v132, v136
    v_add_f32 v233, v140, v144
    v_add_f32 v232, v232, v233
    v_cmp_nge_f32 vcc, s66, v232
    v_lshlrev_b32 v242, 2, v0
    v_add_u32 v242, 32768, v242
    v_add_u32 v233, s91, v242
    s_nop 0
    s_or_b64 vcc, vcc, s[54:55]
    s_cselect_b32 s66, 1, 0
    v_mov_b32 v234, s66
    s_waitcnt lgkmcnt(0)
    ds_write_b32 v233, v234
    v_accvgpr_read_b32 v108, a16
    v_accvgpr_read_b32 v109, a17
    v_accvgpr_read_b32 v110, a18
    v_accvgpr_read_b32 v111, a19
    v_accvgpr_read_b32 v112, a20
    v_accvgpr_read_b32 v113, a21
    v_accvgpr_read_b32 v114, a22
    v_accvgpr_read_b32 v115, a23
    v_pk_mul_f32 v[108:109], v[108:109], v[236:237] op_sel:[0,0] op_sel_hi:[1,0]
    v_pk_mul_f32 v[110:111], v[110:111], v[236:237] op_sel:[0,0] op_sel_hi:[1,0]
    v_pk_mul_f32 v[112:113], v[112:113], v[236:237] op_sel:[0,0] op_sel_hi:[1,0]
    v_pk_mul_f32 v[114:115], v[114:115], v[236:237] op_sel:[0,0] op_sel_hi:[1,0]
    v_cvt_pk_bf16_f32 v116, v108, v109
    v_cvt_pk_bf16_f32 v117, v110, v111
    v_cvt_pk_bf16_f32 v118, v112, v113
    v_cvt_pk_bf16_f32 v119, v114, v115
    buffer_store_dwordx4 v[116:119], v10, s[24:27], s6 offen offset:2048 sc1
    s_waitcnt lgkmcnt(0)
    s_barrier
    ds_read_b32 v220, v242 offset:0
    ds_read_b32 v221, v242 offset:8192
    ds_read_b32 v222, v242 offset:16384
    ds_read_b32 v223, v242 offset:24576
    v_accvgpr_read_b32 v120, a24
    v_accvgpr_read_b32 v121, a25
    v_accvgpr_read_b32 v122, a26
    v_accvgpr_read_b32 v123, a27
    v_accvgpr_read_b32 v124, a28
    v_accvgpr_read_b32 v125, a29
    v_accvgpr_read_b32 v126, a30
    v_accvgpr_read_b32 v127, a31
    v_pk_mul_f32 v[120:121], v[120:121], v[236:237] op_sel:[0,0] op_sel_hi:[1,0]
    v_pk_mul_f32 v[122:123], v[122:123], v[236:237] op_sel:[0,0] op_sel_hi:[1,0]
    v_pk_mul_f32 v[124:125], v[124:125], v[236:237] op_sel:[0,0] op_sel_hi:[1,0]
    v_pk_mul_f32 v[126:127], v[126:127], v[236:237] op_sel:[0,0] op_sel_hi:[1,0]
    v_cvt_pk_bf16_f32 v128, v120, v121
    v_cvt_pk_bf16_f32 v129, v122, v123
    v_cvt_pk_bf16_f32 v130, v124, v125
    v_cvt_pk_bf16_f32 v131, v126, v127
    buffer_store_dwordx4 v[128:131], v10, s[24:27], s6 offen offset:3072 sc1
    s_add_u32 s6, s6, 131072
    s_waitcnt lgkmcnt(0)
    v_or_b32 v220, v220, v221
    v_or3_b32 v220, v220, v222, v223
    s_nop 0
    v_readfirstlane_b32 s64, v220
    s_nop 3
    s_andn2_b32 s64, s64, s59
    s_cmp_lg_u32 s64, 0
    s_cbranch_scc1 L_fallback
    v_accvgpr_read_b32 v108, a32
    v_accvgpr_read_b32 v109, a33
    v_accvgpr_read_b32 v110, a34
    v_accvgpr_read_b32 v111, a35
    v_accvgpr_read_b32 v112, a36
    v_accvgpr_read_b32 v113, a37
    v_accvgpr_read_b32 v114, a38
    v_accvgpr_read_b32 v115, a39
    v_pk_mul_f32 v[108:109], v[108:109], v[236:237] op_sel:[0,1] op_sel_hi:[1,1]
    v_pk_mul_f32 v[110:111], v[110:111], v[236:237] op_sel:[0,1] op_sel_hi:[1,1]
    v_pk_mul_f32 v[112:113], v[112:113], v[236:237] op_sel:[0,1] op_sel_hi:[1,1]
    v_pk_mul_f32 v[114:115], v[114:115], v[236:237] op_sel:[0,1] op_sel_hi:[1,1]
    v_cvt_pk_bf16_f32 v116, v108, v109
    v_cvt_pk_bf16_f32 v117, v110, v111
    v_cvt_pk_bf16_f32 v118, v112, v113
    v_cvt_pk_bf16_f32 v119, v114, v115
    buffer_store_dwordx4 v[116:119], v10, s[24:27], s6 offen offset:0 sc1
    s_waitcnt vmcnt(13)
    ds_read_b64_tr_b16 a[208:209], v248 offset:4096
    ds_read_b64_tr_b16 a[210:211], v248 offset:6144
    ds_read_b64_tr_b16 a[212:213], v249 offset:4096
    ds_read_b64_tr_b16 a[214:215], v249 offset:6144
    ds_read_b64_tr_b16 a[216:217], v250 offset:4096
    ds_read_b64_tr_b16 a[218:219], v250 offset:6144
    ds_read_b64_tr_b16 a[220:221], v251 offset:4096
    ds_read_b64_tr_b16 a[222:223], v251 offset:6144
    v_accvgpr_read_b32 v120, a40
    v_accvgpr_read_b32 v121, a41
    v_accvgpr_read_b32 v122, a42
    v_accvgpr_read_b32 v123, a43
    v_accvgpr_read_b32 v124, a44
    v_accvgpr_read_b32 v125, a45
    v_accvgpr_read_b32 v126, a46
    v_accvgpr_read_b32 v127, a47
    v_pk_mul_f32 v[120:121], v[120:121], v[236:237] op_sel:[0,1] op_sel_hi:[1,1]
    v_pk_mul_f32 v[122:123], v[122:123], v[236:237] op_sel:[0,1] op_sel_hi:[1,1]
    v_pk_mul_f32 v[124:125], v[124:125], v[236:237] op_sel:[0,1] op_sel_hi:[1,1]
    v_pk_mul_f32 v[126:127], v[126:127], v[236:237] op_sel:[0,1] op_sel_hi:[1,1]
    v_cvt_pk_bf16_f32 v128, v120, v121
    v_cvt_pk_bf16_f32 v129, v122, v123
    v_cvt_pk_bf16_f32 v130, v124, v125
    v_cvt_pk_bf16_f32 v131, v126, v127
    buffer_store_dwordx4 v[128:131], v10, s[24:27], s6 offen offset:1024 sc1
    s_waitcnt vmcnt(10)
    ds_read_b64_tr_b16 v[156:157], v244 offset:0
    ds_read_b64_tr_b16 v[158:159], v244 offset:2048
    ds_read_b64_tr_b16 v[160:161], v245 offset:0
    ds_read_b64_tr_b16 v[162:163], v245 offset:2048
    ds_read_b64_tr_b16 v[164:165], v246 offset:0
    ds_read_b64_tr_b16 v[166:167], v246 offset:2048
    ds_read_b64_tr_b16 v[168:169], v247 offset:0
    ds_read_b64_tr_b16 v[170:171], v247 offset:2048
    v_accvgpr_read_b32 v108, a48
    v_accvgpr_read_b32 v109, a49
    v_accvgpr_read_b32 v110, a50
    v_accvgpr_read_b32 v111, a51
    v_accvgpr_read_b32 v112, a52
    v_accvgpr_read_b32 v113, a53
    v_accvgpr_read_b32 v114, a54
    v_accvgpr_read_b32 v115, a55
    v_pk_mul_f32 v[108:109], v[108:109], v[236:237] op_sel:[0,1] op_sel_hi:[1,1]
    v_pk_mul_f32 v[110:111], v[110:111], v[236:237] op_sel:[0,1] op_sel_hi:[1,1]
    v_pk_mul_f32 v[112:113], v[112:113], v[236:237] op_sel:[0,1] op_sel_hi:[1,1]
    v_pk_mul_f32 v[114:115], v[114:115], v[236:237] op_sel:[0,1] op_sel_hi:[1,1]
    v_cvt_pk_bf16_f32 v116, v108, v109
    v_cvt_pk_bf16_f32 v117, v110, v111
    v_cvt_pk_bf16_f32 v118, v112, v113
    v_cvt_pk_bf16_f32 v119, v114, v115
    buffer_store_dwordx4 v[116:119], v10, s[24:27], s6 offen offset:2048 sc1
    s_waitcnt vmcnt(7)
    ds_read_b64_tr_b16 v[172:173], v244 offset:4096
    ds_read_b64_tr_b16 v[174:175], v244 offset:6144
    ds_read_b64_tr_b16 v[176:177], v245 offset:4096
    ds_read_b64_tr_b16 v[178:179], v245 offset:6144
    ds_read_b64_tr_b16 v[180:181], v246 offset:4096
    ds_read_b64_tr_b16 v[182:183], v246 offset:6144
    ds_read_b64_tr_b16 v[184:185], v247 offset:4096
    ds_read_b64_tr_b16 v[186:187], v247 offset:6144
    v_accvgpr_read_b32 v120, a56
    v_accvgpr_read_b32 v121, a57
    v_accvgpr_read_b32 v122, a58
    v_accvgpr_read_b32 v123, a59
    v_accvgpr_read_b32 v124, a60
    v_accvgpr_read_b32 v125, a61
    v_accvgpr_read_b32 v126, a62
    v_accvgpr_read_b32 v127, a63
    v_pk_mul_f32 v[120:121], v[120:121], v[236:237] op_sel:[0,1] op_sel_hi:[1,1]
    v_pk_mul_f32 v[122:123], v[122:123], v[236:237] op_sel:[0,1] op_sel_hi:[1,1]
    v_pk_mul_f32 v[124:125], v[124:125], v[236:237] op_sel:[0,1] op_sel_hi:[1,1]
    v_pk_mul_f32 v[126:127], v[126:127], v[236:237] op_sel:[0,1] op_sel_hi:[1,1]
    v_cvt_pk_bf16_f32 v128, v120, v121
    v_cvt_pk_bf16_f32 v129, v122, v123
    v_cvt_pk_bf16_f32 v130, v124, v125
    v_cvt_pk_bf16_f32 v131, v126, v127
    buffer_store_dwordx4 v[128:131], v10, s[24:27], s6 offen offset:3072 sc1
    s_add_u32 s6, s6, 131072
    v_accvgpr_read_b32 v108, a64
    v_accvgpr_read_b32 v109, a65
    v_accvgpr_read_b32 v110, a66
    v_accvgpr_read_b32 v111, a67
    v_accvgpr_read_b32 v112, a68
    v_accvgpr_read_b32 v113, a69
    v_accvgpr_read_b32 v114, a70
    v_accvgpr_read_b32 v115, a71
    v_pk_mul_f32 v[108:109], v[108:109], v[238:239] op_sel:[0,0] op_sel_hi:[1,0]
    v_pk_mul_f32 v[110:111], v[110:111], v[238:239] op_sel:[0,0] op_sel_hi:[1,0]
    v_pk_mul_f32 v[112:113], v[112:113], v[238:239] op_sel:[0,0] op_sel_hi:[1,0]
    v_pk_mul_f32 v[114:115], v[114:115], v[238:239] op_sel:[0,0] op_sel_hi:[1,0]
    v_cvt_pk_bf16_f32 v116, v108, v109
    v_cvt_pk_bf16_f32 v117, v110, v111
    v_cvt_pk_bf16_f32 v118, v112, v113
    v_cvt_pk_bf16_f32 v119, v114, v115
    buffer_store_dwordx4 v[116:119], v10, s[24:27], s6 offen offset:0 sc1
    v_accvgpr_read_b32 v120, a72
    v_accvgpr_read_b32 v121, a73
    v_accvgpr_read_b32 v122, a74
    v_accvgpr_read_b32 v123, a75
    v_accvgpr_read_b32 v124, a76
    v_accvgpr_read_b32 v125, a77
    v_accvgpr_read_b32 v126, a78
    v_accvgpr_read_b32 v127, a79
    v_pk_mul_f32 v[120:121], v[120:121], v[238:239] op_sel:[0,0] op_sel_hi:[1,0]
    v_pk_mul_f32 v[122:123], v[122:123], v[238:239] op_sel:[0,0] op_sel_hi:[1,0]
    v_pk_mul_f32 v[124:125], v[124:125], v[238:239] op_sel:[0,0] op_sel_hi:[1,0]
    v_pk_mul_f32 v[126:127], v[126:127], v[238:239] op_sel:[0,0] op_sel_hi:[1,0]
    v_cvt_pk_bf16_f32 v128, v120, v121
    v_cvt_pk_bf16_f32 v129, v122, v123
    v_cvt_pk_bf16_f32 v130, v124, v125
    v_cvt_pk_bf16_f32 v131, v126, v127
    buffer_store_dwordx4 v[128:131], v10, s[24:27], s6 offen offset:1024 sc1
    v_accvgpr_read_b32 v108, a80
    v_accvgpr_read_b32 v109, a81
    v_accvgpr_read_b32 v110, a82
    v_accvgpr_read_b32 v111, a83
    v_accvgpr_read_b32 v112, a84
    v_accvgpr_read_b32 v113, a85
    v_accvgpr_read_b32 v114, a86
    v_accvgpr_read_b32 v115, a87
    v_pk_mul_f32 v[108:109], v[108:109], v[238:239] op_sel:[0,0] op_sel_hi:[1,0]
    v_pk_mul_f32 v[110:111], v[110:111], v[238:239] op_sel:[0,0] op_sel_hi:[1,0]
    v_pk_mul_f32 v[112:113], v[112:113], v[238:239] op_sel:[0,0] op_sel_hi:[1,0]
    v_pk_mul_f32 v[114:115], v[114:115], v[238:239] op_sel:[0,0] op_sel_hi:[1,0]
    v_cvt_pk_bf16_f32 v116, v108, v109
    v_cvt_pk_bf16_f32 v117, v110, v111
    v_cvt_pk_bf16_f32 v118, v112, v113
    v_cvt_pk_bf16_f32 v119, v114, v115
    buffer_store_dwordx4 v[116:119], v10, s[24:27], s6 offen offset:2048 sc1
    v_accvgpr_read_b32 v120, a88
    v_accvgpr_read_b32 v121, a89
    v_accvgpr_read_b32 v122, a90
    v_accvgpr_read_b32 v123, a91
    v_accvgpr_read_b32 v124, a92
    v_accvgpr_read_b32 v125, a93
    v_accvgpr_read_b32 v126, a94
    v_accvgpr_read_b32 v127, a95
    v_pk_mul_f32 v[120:121], v[120:121], v[238:239] op_sel:[0,0] op_sel_hi:[1,0]
    v_pk_mul_f32 v[122:123], v[122:123], v[238:239] op_sel:[0,0] op_sel_hi:[1,0]
    v_pk_mul_f32 v[124:125], v[124:125], v[238:239] op_sel:[0,0] op_sel_hi:[1,0]
    v_pk_mul_f32 v[126:127], v[126:127], v[238:239] op_sel:[0,0] op_sel_hi:[1,0]
    v_cvt_pk_bf16_f32 v128, v120, v121
    v_cvt_pk_bf16_f32 v129, v122, v123
    v_cvt_pk_bf16_f32 v130, v124, v125
    v_cvt_pk_bf16_f32 v131, v126, v127
    buffer_store_dwordx4 v[128:131], v10, s[24:27], s6 offen offset:3072 sc1
    s_add_u32 s6, s6, 131072
    v_accvgpr_read_b32 v108, a96
    v_accvgpr_read_b32 v109, a97
    v_accvgpr_read_b32 v110, a98
    v_accvgpr_read_b32 v111, a99
    v_accvgpr_read_b32 v112, a100
    v_accvgpr_read_b32 v113, a101
    v_accvgpr_read_b32 v114, a102
    v_accvgpr_read_b32 v115, a103
    v_pk_mul_f32 v[108:109], v[108:109], v[238:239] op_sel:[0,1] op_sel_hi:[1,1]
    v_pk_mul_f32 v[110:111], v[110:111], v[238:239] op_sel:[0,1] op_sel_hi:[1,1]
    v_pk_mul_f32 v[112:113], v[112:113], v[238:239] op_sel:[0,1] op_sel_hi:[1,1]
    v_pk_mul_f32 v[114:115], v[114:115], v[238:239] op_sel:[0,1] op_sel_hi:[1,1]
    v_cvt_pk_bf16_f32 v116, v108, v109
    v_cvt_pk_bf16_f32 v117, v110, v111
    v_cvt_pk_bf16_f32 v118, v112, v113
    v_cvt_pk_bf16_f32 v119, v114, v115
    buffer_store_dwordx4 v[116:119], v10, s[24:27], s6 offen offset:0 sc1
    v_accvgpr_read_b32 v120, a104
    v_accvgpr_read_b32 v121, a105
    v_accvgpr_read_b32 v122, a106
    v_accvgpr_read_b32 v123, a107
    v_accvgpr_read_b32 v124, a108
    v_accvgpr_read_b32 v125, a109
    v_accvgpr_read_b32 v126, a110
    v_accvgpr_read_b32 v127, a111
    v_pk_mul_f32 v[120:121], v[120:121], v[238:239] op_sel:[0,1] op_sel_hi:[1,1]
    v_pk_mul_f32 v[122:123], v[122:123], v[238:239] op_sel:[0,1] op_sel_hi:[1,1]
    v_pk_mul_f32 v[124:125], v[124:125], v[238:239] op_sel:[0,1] op_sel_hi:[1,1]
    v_pk_mul_f32 v[126:127], v[126:127], v[238:239] op_sel:[0,1] op_sel_hi:[1,1]
    v_cvt_pk_bf16_f32 v128, v120, v121
    v_cvt_pk_bf16_f32 v129, v122, v123
    v_cvt_pk_bf16_f32 v130, v124, v125
    v_cvt_pk_bf16_f32 v131, v126, v127
    buffer_store_dwordx4 v[128:131], v10, s[24:27], s6 offen offset:1024 sc1
    v_accvgpr_read_b32 v108, a112
    v_accvgpr_read_b32 v109, a113
    v_accvgpr_read_b32 v110, a114
    v_accvgpr_read_b32 v111, a115
    v_accvgpr_read_b32 v112, a116
    v_accvgpr_read_b32 v113, a117
    v_accvgpr_read_b32 v114, a118
    v_accvgpr_read_b32 v115, a119
    v_pk_mul_f32 v[108:109], v[108:109], v[238:239] op_sel:[0,1] op_sel_hi:[1,1]
    v_pk_mul_f32 v[110:111], v[110:111], v[238:239] op_sel:[0,1] op_sel_hi:[1,1]
    v_pk_mul_f32 v[112:113], v[112:113], v[238:239] op_sel:[0,1] op_sel_hi:[1,1]
    v_pk_mul_f32 v[114:115], v[114:115], v[238:239] op_sel:[0,1] op_sel_hi:[1,1]
    v_cvt_pk_bf16_f32 v116, v108, v109
    v_cvt_pk_bf16_f32 v117, v110, v111
    v_cvt_pk_bf16_f32 v118, v112, v113
    v_cvt_pk_bf16_f32 v119, v114, v115
    buffer_store_dwordx4 v[116:119], v10, s[24:27], s6 offen offset:2048 sc1
    v_accvgpr_read_b32 v120, a120
    v_accvgpr_read_b32 v121, a121
    v_accvgpr_read_b32 v122, a122
    v_accvgpr_read_b32 v123, a123
    v_accvgpr_read_b32 v124, a124
    v_accvgpr_read_b32 v125, a125
    v_accvgpr_read_b32 v126, a126
    v_accvgpr_read_b32 v127, a127
    v_pk_mul_f32 v[120:121], v[120:121], v[238:239] op_sel:[0,1] op_sel_hi:[1,1]
    v_pk_mul_f32 v[122:123], v[122:123], v[238:239] op_sel:[0,1] op_sel_hi:[1,1]
    v_pk_mul_f32 v[124:125], v[124:125], v[238:239] op_sel:[0,1] op_sel_hi:[1,1]
    v_pk_mul_f32 v[126:127], v[126:127], v[238:239] op_sel:[0,1] op_sel_hi:[1,1]
    v_cvt_pk_bf16_f32 v128, v120, v121
    v_cvt_pk_bf16_f32 v129, v122, v123
    v_cvt_pk_bf16_f32 v130, v124, v125
    v_cvt_pk_bf16_f32 v131, v126, v127
    buffer_store_dwordx4 v[128:131], v10, s[24:27], s6 offen offset:3072 sc1
    s_waitcnt lgkmcnt(0)
    s_add_u32 m0, s91, 36864
    s_xor_b32 s64, s63, 327680
    buffer_load_dwordx4 v1, s[8:11], s64 offen offset:0 lds
    buffer_load_dwordx4 v2, s[8:11], s64 offen offset:1024 lds
    buffer_load_dwordx4 v3, s[8:11], s64 offen offset:2048 lds
    buffer_load_dwordx4 v4, s[8:11], s64 offen offset:3072 lds
    s_add_u32 m0, s91, 98304
    s_xor_b32 s64, s63, 360448
    buffer_load_dwordx4 v1, s[8:11], s64 offen offset:0 lds
    buffer_load_dwordx4 v2, s[8:11], s64 offen offset:1024 lds
    buffer_load_dwordx4 v3, s[8:11], s64 offen offset:2048 lds
    buffer_load_dwordx4 v4, s[8:11], s64 offen offset:3072 lds
    s_add_u32 m0, s91, 102400
    s_xor_b32 s64, s63, 393216
    buffer_load_dwordx4 v1, s[8:11], s64 offen offset:0 lds
    buffer_load_dwordx4 v2, s[8:11], s64 offen offset:1024 lds
    buffer_load_dwordx4 v3, s[8:11], s64 offen offset:2048 lds
    buffer_load_dwordx4 v4, s[8:11], s64 offen offset:3072 lds
    s_mov_b32 s28, s44
    s_mov_b32 s29, s45
    s_mov_b32 s30, 256
    s_mov_b32 s31, 0x20000
    s_lshl_b32 s6, s89, 17
    s_add_u32 s16, s46, s6
    s_addc_u32 s17, s47, 0
    s_mov_b32 s18, 1179648
    s_mov_b32 s19, 0x20000
    s_lshl_b32 s6, s89, 14
    s_add_u32 s20, s42, s6
    s_addc_u32 s21, s43, 0
    s_mov_b32 s22, 147456
    s_mov_b32 s23, 0x20000
    v_mov_b32 v11, 0
    v_mov_b32 v232, 1
    s_mul_i32 s64, s90, 655360
    v_add_u32 v220, s64, v10
    v_add_u32 v224, 524288, v10
    v_subrev_u32 v225, s64, v10
    v_add_u32 v225, 655360, v225
    v_add_u32 v221, 131072, v220
    v_add_u32 v226, 131072, v225
    v_add_u32 v222, 262144, v220
    v_add_u32 v227, 262144, v225
    v_add_u32 v223, 393216, v220
    v_add_u32 v228, 393216, v225
    s_lshr_b32 s61, s63, 5
    s_lshl_b32 s6, s4, 1
    s_lshr_b32 s7, s5, 4
    s_add_u32 s6, s6, s7
    s_lshl_b32 s6, s6, 4
    s_lshl_b32 s7, s87, 1
    s_add_u32 s7, s7, s90
    s_lshl_b32 s7, s7, 4
    v_mov_b32 v233, s6
    v_writelane_b32 v233, s7, 0
    s_lshl_b32 s64, s4, 5
    s_add_u32 s64, s64, s5
    s_lshl_b32 s7, s7, 7
    s_add_u32 s7, s7, 19922944
    s_xor_b32 s6, s62, 512
    v_lshlrev_b32 v233, 7, v0
    v_add_u32 v233, s7, v233
    v_mov_b32 v234, s6
    v_cmp_gt_u32 vcc, 16, v0
    s_nop 1
    v_cndmask_b32 v233, v234, v233, vcc
    v_mov_b32 v234, s62
    s_waitcnt vmcnt(12)
    s_barrier
    s_cmp_lg_u32 s3, 0
    s_cbranch_scc1 L_nosig
    s_mov_b64 exec, 1
    global_store_dword v234, v232, s[46:47] sc1
    s_mov_b64 exec, -1
L_nosig:
    s_getpc_b64 s[48:49]
    v_min_u32 v241, 1, v0
    v_lshlrev_b32 v241, 13, v241
    s_lshr_b32 s64, s2, 3
    s_lshl_b32 s64, s64, 2
    s_add_u32 s64, s64, s3
    s_lshl_b32 s64, s64, 6
    v_add_u32 v241, s64, v241
    v_min_u32 v241, L_end-L_nosig, v241
    global_load_dword v241, v241, s[48:49]
    s_add_u32 m0, s91, 131072
    s_xor_b32 s64, s63, 425984
    buffer_load_dwordx4 v1, s[8:11], s64 offen offset:0 lds
    buffer_load_dwordx4 v2, s[8:11], s64 offen offset:1024 lds
    buffer_load_dwordx4 v3, s[8:11], s64 offen offset:2048 lds
    buffer_load_dwordx4 v4, s[8:11], s64 offen offset:3072 lds
    s_add_u32 m0, s91, 135168
    s_xor_b32 s64, s63, 458752
    buffer_load_dwordx4 v1, s[8:11], s64 offen offset:0 lds
    buffer_load_dwordx4 v2, s[8:11], s64 offen offset:1024 lds
    buffer_load_dwordx4 v3, s[8:11], s64 offen offset:2048 lds
    buffer_load_dwordx4 v4, s[8:11], s64 offen offset:3072 lds
    s_add_u32 m0, s91, 65536
    s_xor_b32 s64, s63, 491520
    buffer_load_dwordx4 v1, s[8:11], s64 offen offset:0 lds
    buffer_load_dwordx4 v2, s[8:11], s64 offen offset:1024 lds
    buffer_load_dwordx4 v3, s[8:11], s64 offen offset:2048 lds
    buffer_load_dwordx4 v4, s[8:11], s64 offen offset:3072 lds
    s_cmp_lg_u32 s3, 0
    s_cbranch_scc1 L_ready
    s_mov_b32 s58, 0x40000
L_cnt:
    v_readfirstlane_b32 s6, v243
    s_sub_u32 s58, s58, 1
    s_cmp_eq_u32 s58, 0
    s_cbranch_scc1 L_ready
    s_nop 0
    s_cmp_ge_u32 s6, 256
    s_cbranch_scc1 L_cntok
    s_sleep 16
    global_load_dword v243, v11, s[44:45] sc1
    s_waitcnt vmcnt(0)
    s_branch L_cnt
L_cntok:
    s_mov_b64 exec, 0x1ffff
L_poll:
    global_load_dword v235, v233, s[46:47] sc1
    s_waitcnt vmcnt(0)
    v_cmp_ne_u32 vcc, 1, v235
    s_sub_u32 s58, s58, 1
    s_cmp_eq_u32 s58, 0
    s_cbranch_scc1 L_got
    s_nop 0
    s_cmp_eq_u64 vcc, 0
    s_cbranch_scc1 L_got
    s_sleep 4
    s_branch L_poll
L_got:
    s_mov_b64 exec, -1
L_ready:
    s_barrier
    s_xor_b32 s48, s61, 0
    buffer_load_dwordx4 a[108:111], v220, s[16:19], s48 offen sc1
    buffer_load_dwordx4 a[112:115], v221, s[16:19], s48 offen sc1
    buffer_load_dwordx4 a[116:119], v222, s[16:19], s48 offen sc1
    buffer_load_dwordx4 a[120:123], v223, s[16:19], s48 offen sc1
    buffer_load_dwordx4 a[124:127], v224, s[16:19], s48 offen sc1
    buffer_load_dwordx4 v[44:47], v225, s[16:19], s48 offen sc1
    buffer_load_dwordx4 v[48:51], v226, s[16:19], s48 offen sc1
    buffer_load_dwordx4 v[52:55], v227, s[16:19], s48 offen sc1
    buffer_load_dwordx4 v[56:59], v228, s[16:19], s48 offen sc1
    s_xor_b32 s49, s61, 1024
    buffer_load_dwordx4 v[60:63], v220, s[16:19], s49 offen sc1
    s_waitcnt vmcnt(9)
    v_mfma_f32_16x16x32_bf16 v[108:111], a[128:131], a[108:111], 0
    v_mfma_f32_16x16x32_bf16 a[0:3], a[132:135], a[108:111], 0
    buffer_load_dwordx4 v[64:67], v221, s[16:19], s49 offen sc1
    v_mfma_f32_16x16x32_bf16 a[4:7], a[136:139], a[108:111], 0
    s_waitcnt vmcnt(32)
    ds_read_b64_tr_b16 v[188:189], v244 offset:36864
    ds_read_b64_tr_b16 v[190:191], v244 offset:38912
    v_mfma_f32_16x16x32_bf16 a[8:11], a[140:143], a[108:111], 0
    s_waitcnt vmcnt(9)
    v_mfma_f32_16x16x32_bf16 v[112:115], a[128:131], a[112:115], 0
    ds_read_b64_tr_b16 v[192:193], v245 offset:36864
    ds_read_b64_tr_b16 v[194:195], v245 offset:38912
    v_mfma_f32_16x16x32_bf16 a[12:15], a[132:135], a[112:115], 0
    buffer_load_dwordx4 v[68:71], v222, s[16:19], s49 offen sc1
    v_mfma_f32_16x16x32_bf16 a[16:19], a[136:139], a[112:115], 0
    ds_read_b64_tr_b16 v[196:197], v246 offset:36864
    ds_read_b64_tr_b16 v[198:199], v246 offset:38912
    v_mfma_f32_16x16x32_bf16 a[20:23], a[140:143], a[112:115], 0
    s_waitcnt vmcnt(9)
    v_mfma_f32_16x16x32_bf16 v[116:119], a[128:131], a[116:119], 0
    ds_read_b64_tr_b16 v[200:201], v247 offset:36864
    ds_read_b64_tr_b16 v[202:203], v247 offset:38912
    v_mfma_f32_16x16x32_bf16 a[24:27], a[132:135], a[116:119], 0
    buffer_load_dwordx4 v[72:75], v223, s[16:19], s49 offen sc1
    v_mfma_f32_16x16x32_bf16 a[28:31], a[136:139], a[116:119], 0
    s_waitcnt vmcnt(30)
    ds_read_b64_tr_b16 v[204:205], v248 offset:32768
    ds_read_b64_tr_b16 v[206:207], v248 offset:34816
    v_mfma_f32_16x16x32_bf16 a[32:35], a[140:143], a[116:119], 0
    s_waitcnt vmcnt(9)
    v_mfma_f32_16x16x32_bf16 v[120:123], a[128:131], a[120:123], 0
    ds_read_b64_tr_b16 v[208:209], v249 offset:32768
    ds_read_b64_tr_b16 v[210:211], v249 offset:34816
    v_mfma_f32_16x16x32_bf16 a[36:39], a[132:135], a[120:123], 0
    buffer_load_dwordx4 v[144:147], v224, s[16:19], s49 offen sc1
    v_mfma_f32_16x16x32_bf16 a[40:43], a[136:139], a[120:123], 0
    ds_read_b64_tr_b16 v[212:213], v250 offset:32768
    ds_read_b64_tr_b16 v[214:215], v250 offset:34816
    v_mfma_f32_16x16x32_bf16 a[44:47], a[140:143], a[120:123], 0
    s_waitcnt vmcnt(9)
    v_mfma_f32_16x16x32_bf16 v[124:127], a[128:131], a[124:127], 0
    ds_read_b64_tr_b16 v[216:217], v251 offset:32768
    ds_read_b64_tr_b16 v[218:219], v251 offset:34816
    v_mfma_f32_16x16x32_bf16 a[48:51], a[132:135], a[124:127], 0
    buffer_load_dwordx4 v[148:151], v225, s[16:19], s49 offen sc1
    v_mfma_f32_16x16x32_bf16 a[52:55], a[136:139], a[124:127], 0
    s_waitcnt vmcnt(28)
    ds_read_b64_tr_b16 v[12:13], v248 offset:36864
    ds_read_b64_tr_b16 v[14:15], v248 offset:38912
    v_mfma_f32_16x16x32_bf16 a[56:59], a[140:143], a[124:127], 0
    s_waitcnt vmcnt(9)
    v_mfma_f32_16x16x32_bf16 v[128:131], a[128:131], v[44:47], 0
    ds_read_b64_tr_b16 v[16:17], v249 offset:36864
    ds_read_b64_tr_b16 v[18:19], v249 offset:38912
    v_mfma_f32_16x16x32_bf16 a[60:63], a[132:135], v[44:47], 0
    buffer_load_dwordx4 v[152:155], v226, s[16:19], s49 offen sc1
    v_mfma_f32_16x16x32_bf16 a[64:67], a[136:139], v[44:47], 0
    ds_read_b64_tr_b16 v[20:21], v250 offset:36864
    ds_read_b64_tr_b16 v[22:23], v250 offset:38912
    v_mfma_f32_16x16x32_bf16 a[68:71], a[140:143], v[44:47], 0
    s_waitcnt vmcnt(9)
    v_mfma_f32_16x16x32_bf16 v[132:135], a[128:131], v[48:51], 0
    ds_read_b64_tr_b16 v[24:25], v251 offset:36864
    ds_read_b64_tr_b16 v[26:27], v251 offset:38912
    v_mfma_f32_16x16x32_bf16 a[72:75], a[132:135], v[48:51], 0
    buffer_load_dwordx4 a[108:111], v227, s[16:19], s49 offen sc1
    v_mfma_f32_16x16x32_bf16 a[76:79], a[136:139], v[48:51], 0
    s_waitcnt vmcnt(25)
    ds_read_b64_tr_b16 v[28:29], v252 offset:0
    ds_read_b64_tr_b16 v[30:31], v252 offset:2048
    v_mfma_f32_16x16x32_bf16 a[80:83], a[140:143], v[48:51], 0
    s_waitcnt vmcnt(9)
    v_mfma_f32_16x16x32_bf16 v[136:139], a[128:131], v[52:55], 0
    ds_read_b64_tr_b16 v[32:33], v253 offset:0
    ds_read_b64_tr_b16 v[34:35], v253 offset:2048
    v_mfma_f32_16x16x32_bf16 a[84:87], a[132:135], v[52:55], 0
    buffer_load_dwordx4 a[112:115], v228, s[16:19], s49 offen sc1
    v_mfma_f32_16x16x32_bf16 a[88:91], a[136:139], v[52:55], 0
    ds_read_b64_tr_b16 v[36:37], v254 offset:0
    ds_read_b64_tr_b16 v[38:39], v254 offset:2048
    v_mfma_f32_16x16x32_bf16 a[92:95], a[140:143], v[52:55], 0
    s_waitcnt vmcnt(9)
    v_mfma_f32_16x16x32_bf16 v[140:143], a[128:131], v[56:59], 0
    s_xor_b32 s52, s61, 2048
    ds_read_b64_tr_b16 v[40:41], v255 offset:0
    ds_read_b64_tr_b16 v[42:43], v255 offset:2048
    v_mfma_f32_16x16x32_bf16 a[96:99], a[132:135], v[56:59], 0
    buffer_load_dwordx4 a[116:119], v220, s[16:19], s52 offen sc1
    v_mfma_f32_16x16x32_bf16 a[100:103], a[136:139], v[56:59], 0
    s_waitcnt vmcnt(23)
    ds_read_b64_tr_b16 a[224:225], v252 offset:4096
    ds_read_b64_tr_b16 a[226:227], v252 offset:6144
    v_mfma_f32_16x16x32_bf16 a[104:107], a[140:143], v[56:59], 0
    s_waitcnt vmcnt(9)
    v_mfma_f32_16x16x32_bf16 v[108:111], a[144:147], v[60:63], v[108:111]
    ds_read_b64_tr_b16 a[228:229], v253 offset:4096
    ds_read_b64_tr_b16 a[230:231], v253 offset:6144
    v_mfma_f32_16x16x32_bf16 a[0:3], a[148:151], v[60:63], a[0:3]
    buffer_load_dwordx4 a[120:123], v221, s[16:19], s52 offen sc1
    v_mfma_f32_16x16x32_bf16 a[4:7], a[152:155], v[60:63], a[4:7]
    ds_read_b64_tr_b16 a[232:233], v254 offset:4096
    ds_read_b64_tr_b16 a[234:235], v254 offset:6144
    v_mfma_f32_16x16x32_bf16 a[8:11], a[156:159], v[60:63], a[8:11]
    s_waitcnt vmcnt(9)
    v_mfma_f32_16x16x32_bf16 v[112:115], a[144:147], v[64:67], v[112:115]
    ds_read_b64_tr_b16 a[236:237], v255 offset:4096
    ds_read_b64_tr_b16 a[238:239], v255 offset:6144
    v_mfma_f32_16x16x32_bf16 a[12:15], a[148:151], v[64:67], a[12:15]
    buffer_load_dwordx4 a[124:127], v222, s[16:19], s52 offen sc1
    v_mfma_f32_16x16x32_bf16 a[16:19], a[152:155], v[64:67], a[16:19]
    s_waitcnt vmcnt(21)
    ds_read_b64_tr_b16 a[240:241], v248 offset:0
    ds_read_b64_tr_b16 a[242:243], v248 offset:2048
    v_mfma_f32_16x16x32_bf16 a[20:23], a[156:159], v[64:67], a[20:23]
    s_waitcnt vmcnt(9)
    v_mfma_f32_16x16x32_bf16 v[116:119], a[144:147], v[68:71], v[116:119]
    ds_read_b64_tr_b16 a[244:245], v249 offset:0
    ds_read_b64_tr_b16 a[246:247], v249 offset:2048
    v_mfma_f32_16x16x32_bf16 a[24:27], a[148:151], v[68:71], a[24:27]
    buffer_load_dwordx4 v[44:47], v223, s[16:19], s52 offen sc1
    v_mfma_f32_16x16x32_bf16 a[28:31], a[152:155], v[68:71], a[28:31]
    ds_read_b64_tr_b16 a[248:249], v250 offset:0
    ds_read_b64_tr_b16 a[250:251], v250 offset:2048
    v_mfma_f32_16x16x32_bf16 a[32:35], a[156:159], v[68:71], a[32:35]
    s_waitcnt vmcnt(9)
    v_mfma_f32_16x16x32_bf16 v[120:123], a[144:147], v[72:75], v[120:123]
    ds_read_b64_tr_b16 a[252:253], v251 offset:0
    ds_read_b64_tr_b16 a[254:255], v251 offset:2048
    v_mfma_f32_16x16x32_bf16 a[36:39], a[148:151], v[72:75], a[36:39]
    buffer_load_dwordx4 v[48:51], v224, s[16:19], s52 offen sc1
    v_mfma_f32_16x16x32_bf16 a[40:43], a[152:155], v[72:75], a[40:43]
    v_mfma_f32_16x16x32_bf16 a[44:47], a[156:159], v[72:75], a[44:47]
    s_waitcnt vmcnt(9)
    v_mfma_f32_16x16x32_bf16 v[124:127], a[144:147], v[144:147], v[124:127]
    v_mfma_f32_16x16x32_bf16 a[48:51], a[148:151], v[144:147], a[48:51]
    buffer_load_dwordx4 v[52:55], v225, s[16:19], s52 offen sc1
    v_mfma_f32_16x16x32_bf16 a[52:55], a[152:155], v[144:147], a[52:55]
    v_mfma_f32_16x16x32_bf16 a[56:59], a[156:159], v[144:147], a[56:59]
    s_waitcnt vmcnt(9)
    v_mfma_f32_16x16x32_bf16 v[128:131], a[144:147], v[148:151], v[128:131]
    v_mfma_f32_16x16x32_bf16 a[60:63], a[148:151], v[148:151], a[60:63]
    buffer_load_dwordx4 v[56:59], v226, s[16:19], s52 offen sc1
    v_mfma_f32_16x16x32_bf16 a[64:67], a[152:155], v[148:151], a[64:67]
    v_mfma_f32_16x16x32_bf16 a[68:71], a[156:159], v[148:151], a[68:71]
    s_waitcnt vmcnt(9)
    v_mfma_f32_16x16x32_bf16 v[132:135], a[144:147], v[152:155], v[132:135]
    v_mfma_f32_16x16x32_bf16 a[72:75], a[148:151], v[152:155], a[72:75]
    buffer_load_dwordx4 v[60:63], v227, s[16:19], s52 offen sc1
    v_mfma_f32_16x16x32_bf16 a[76:79], a[152:155], v[152:155], a[76:79]
    v_mfma_f32_16x16x32_bf16 a[80:83], a[156:159], v[152:155], a[80:83]
    s_waitcnt vmcnt(9)
    v_mfma_f32_16x16x32_bf16 v[136:139], a[144:147], a[108:111], v[136:139]
    v_mfma_f32_16x16x32_bf16 a[84:87], a[148:151], a[108:111], a[84:87]
    buffer_load_dwordx4 v[64:67], v228, s[16:19], s52 offen sc1
    v_mfma_f32_16x16x32_bf16 a[88:91], a[152:155], a[108:111], a[88:91]
    v_mfma_f32_16x16x32_bf16 a[92:95], a[156:159], a[108:111], a[92:95]
    s_waitcnt vmcnt(9)
    v_mfma_f32_16x16x32_bf16 v[140:143], a[144:147], a[112:115], v[140:143]
    s_xor_b32 s53, s61, 3072
    v_mfma_f32_16x16x32_bf16 a[96:99], a[148:151], a[112:115], a[96:99]
    buffer_load_dwordx4 v[68:71], v220, s[16:19], s53 offen sc1
    v_mfma_f32_16x16x32_bf16 a[100:103], a[152:155], a[112:115], a[100:103]
    v_mfma_f32_16x16x32_bf16 a[104:107], a[156:159], a[112:115], a[104:107]
    s_waitcnt vmcnt(9)
    v_mfma_f32_16x16x32_bf16 v[108:111], a[160:163], a[116:119], v[108:111]
    v_mfma_f32_16x16x32_bf16 a[0:3], a[164:167], a[116:119], a[0:3]
    buffer_load_dwordx4 v[72:75], v221, s[16:19], s53 offen sc1
    v_mfma_f32_16x16x32_bf16 a[4:7], a[168:171], a[116:119], a[4:7]
    v_mfma_f32_16x16x32_bf16 a[8:11], a[172:175], a[116:119], a[8:11]
    s_waitcnt vmcnt(9)
    v_mfma_f32_16x16x32_bf16 v[112:115], a[160:163], a[120:123], v[112:115]
    v_mfma_f32_16x16x32_bf16 a[12:15], a[164:167], a[120:123], a[12:15]
    buffer_load_dwordx4 v[144:147], v222, s[16:19], s53 offen sc1
    v_mfma_f32_16x16x32_bf16 a[16:19], a[168:171], a[120:123], a[16:19]
    v_mfma_f32_16x16x32_bf16 a[20:23], a[172:175], a[120:123], a[20:23]
    s_waitcnt vmcnt(9)
    v_mfma_f32_16x16x32_bf16 v[116:119], a[160:163], a[124:127], v[116:119]
    v_mfma_f32_16x16x32_bf16 a[24:27], a[164:167], a[124:127], a[24:27]
    buffer_load_dwordx4 v[148:151], v223, s[16:19], s53 offen sc1
    v_mfma_f32_16x16x32_bf16 a[28:31], a[168:171], a[124:127], a[28:31]
    v_mfma_f32_16x16x32_bf16 a[32:35], a[172:175], a[124:127], a[32:35]
    s_waitcnt vmcnt(9)
    v_mfma_f32_16x16x32_bf16 v[120:123], a[160:163], v[44:47], v[120:123]
    v_mfma_f32_16x16x32_bf16 a[36:39], a[164:167], v[44:47], a[36:39]
    buffer_load_dwordx4 v[152:155], v224, s[16:19], s53 offen sc1
    v_mfma_f32_16x16x32_bf16 a[40:43], a[168:171], v[44:47], a[40:43]
    v_mfma_f32_16x16x32_bf16 a[44:47], a[172:175], v[44:47], a[44:47]
    s_waitcnt vmcnt(9)
    v_mfma_f32_16x16x32_bf16 v[124:127], a[160:163], v[48:51], v[124:127]
    v_mfma_f32_16x16x32_bf16 a[48:51], a[164:167], v[48:51], a[48:51]
    buffer_load_dwordx4 a[108:111], v225, s[16:19], s53 offen sc1
    v_mfma_f32_16x16x32_bf16 a[52:55], a[168:171], v[48:51], a[52:55]
    v_mfma_f32_16x16x32_bf16 a[56:59], a[172:175], v[48:51], a[56:59]
    s_waitcnt vmcnt(9)
    v_mfma_f32_16x16x32_bf16 v[128:131], a[160:163], v[52:55], v[128:131]
    v_mfma_f32_16x16x32_bf16 a[60:63], a[164:167], v[52:55], a[60:63]
    buffer_load_dwordx4 a[112:115], v226, s[16:19], s53 offen sc1
    v_mfma_f32_16x16x32_bf16 a[64:67], a[168:171], v[52:55], a[64:67]
    v_mfma_f32_16x16x32_bf16 a[68:71], a[172:175], v[52:55], a[68:71]
    s_waitcnt vmcnt(9)
    v_mfma_f32_16x16x32_bf16 v[132:135], a[160:163], v[56:59], v[132:135]
    v_mfma_f32_16x16x32_bf16 a[72:75], a[164:167], v[56:59], a[72:75]
    buffer_load_dwordx4 a[116:119], v227, s[16:19], s53 offen sc1
    v_mfma_f32_16x16x32_bf16 a[76:79], a[168:171], v[56:59], a[76:79]
    v_mfma_f32_16x16x32_bf16 a[80:83], a[172:175], v[56:59], a[80:83]
    s_waitcnt vmcnt(9)
    v_mfma_f32_16x16x32_bf16 v[136:139], a[160:163], v[60:63], v[136:139]
    v_mfma_f32_16x16x32_bf16 a[84:87], a[164:167], v[60:63], a[84:87]
    buffer_load_dwordx4 a[120:123], v228, s[16:19], s53 offen sc1
    v_mfma_f32_16x16x32_bf16 a[88:91], a[168:171], v[60:63], a[88:91]
    v_mfma_f32_16x16x32_bf16 a[92:95], a[172:175], v[60:63], a[92:95]
    s_waitcnt vmcnt(9)
    v_mfma_f32_16x16x32_bf16 v[140:143], a[160:163], v[64:67], v[140:143]
    s_xor_b32 s68, s61, 4096
    v_mfma_f32_16x16x32_bf16 a[96:99], a[164:167], v[64:67], a[96:99]
    buffer_load_dwordx4 a[124:127], v220, s[16:19], s68 offen sc1
    v_mfma_f32_16x16x32_bf16 a[100:103], a[168:171], v[64:67], a[100:103]
    v_mfma_f32_16x16x32_bf16 a[104:107], a[172:175], v[64:67], a[104:107]
    s_waitcnt vmcnt(9)
    v_mfma_f32_16x16x32_bf16 v[108:111], a[176:179], v[68:71], v[108:111]
    v_mfma_f32_16x16x32_bf16 a[0:3], a[180:183], v[68:71], a[0:3]
    buffer_load_dwordx4 v[44:47], v221, s[16:19], s68 offen sc1
    v_mfma_f32_16x16x32_bf16 a[4:7], a[184:187], v[68:71], a[4:7]
    v_mfma_f32_16x16x32_bf16 a[8:11], a[188:191], v[68:71], a[8:11]
    s_waitcnt vmcnt(9)
    v_mfma_f32_16x16x32_bf16 v[112:115], a[176:179], v[72:75], v[112:115]
    v_mfma_f32_16x16x32_bf16 a[12:15], a[180:183], v[72:75], a[12:15]
    buffer_load_dwordx4 v[48:51], v222, s[16:19], s68 offen sc1
    v_mfma_f32_16x16x32_bf16 a[16:19], a[184:187], v[72:75], a[16:19]
    v_mfma_f32_16x16x32_bf16 a[20:23], a[188:191], v[72:75], a[20:23]
    s_waitcnt vmcnt(9)
    v_mfma_f32_16x16x32_bf16 v[116:119], a[176:179], v[144:147], v[116:119]
    v_mfma_f32_16x16x32_bf16 a[24:27], a[180:183], v[144:147], a[24:27]
    buffer_load_dwordx4 v[52:55], v223, s[16:19], s68 offen sc1
    v_mfma_f32_16x16x32_bf16 a[28:31], a[184:187], v[144:147], a[28:31]
    v_mfma_f32_16x16x32_bf16 a[32:35], a[188:191], v[144:147], a[32:35]
    s_waitcnt vmcnt(9)
    v_mfma_f32_16x16x32_bf16 v[120:123], a[176:179], v[148:151], v[120:123]
    v_mfma_f32_16x16x32_bf16 a[36:39], a[180:183], v[148:151], a[36:39]
    buffer_load_dwordx4 v[56:59], v224, s[16:19], s68 offen sc1
    v_mfma_f32_16x16x32_bf16 a[40:43], a[184:187], v[148:151], a[40:43]
    v_mfma_f32_16x16x32_bf16 a[44:47], a[188:191], v[148:151], a[44:47]
    s_waitcnt vmcnt(9)
    v_mfma_f32_16x16x32_bf16 v[124:127], a[176:179], v[152:155], v[124:127]
    v_mfma_f32_16x16x32_bf16 a[48:51], a[180:183], v[152:155], a[48:51]
    buffer_load_dwordx4 v[60:63], v225, s[16:19], s68 offen sc1
    v_mfma_f32_16x16x32_bf16 a[52:55], a[184:187], v[152:155], a[52:55]
    v_mfma_f32_16x16x32_bf16 a[56:59], a[188:191], v[152:155], a[56:59]
    s_waitcnt vmcnt(9)
    v_mfma_f32_16x16x32_bf16 v[128:131], a[176:179], a[108:111], v[128:131]
    v_mfma_f32_16x16x32_bf16 a[60:63], a[180:183], a[108:111], a[60:63]
    buffer_load_dwordx4 v[64:67], v226, s[16:19], s68 offen sc1
    v_mfma_f32_16x16x32_bf16 a[64:67], a[184:187], a[108:111], a[64:67]
    v_mfma_f32_16x16x32_bf16 a[68:71], a[188:191], a[108:111], a[68:71]
    s_waitcnt vmcnt(9)
    v_mfma_f32_16x16x32_bf16 v[132:135], a[176:179], a[112:115], v[132:135]
    v_mfma_f32_16x16x32_bf16 a[72:75], a[180:183], a[112:115], a[72:75]
    buffer_load_dwordx4 v[68:71], v227, s[16:19], s68 offen sc1
    v_mfma_f32_16x16x32_bf16 a[76:79], a[184:187], a[112:115], a[76:79]
    v_mfma_f32_16x16x32_bf16 a[80:83], a[188:191], a[112:115], a[80:83]
    s_waitcnt vmcnt(9)
    v_mfma_f32_16x16x32_bf16 v[136:139], a[176:179], a[116:119], v[136:139]
    v_mfma_f32_16x16x32_bf16 a[84:87], a[180:183], a[116:119], a[84:87]
    buffer_load_dwordx4 v[72:75], v228, s[16:19], s68 offen sc1
    v_mfma_f32_16x16x32_bf16 a[88:91], a[184:187], a[116:119], a[88:91]
    v_mfma_f32_16x16x32_bf16 a[92:95], a[188:191], a[116:119], a[92:95]
    s_waitcnt vmcnt(9)
    v_mfma_f32_16x16x32_bf16 v[140:143], a[176:179], a[120:123], v[140:143]
    s_xor_b32 s69, s61, 5120
    v_mfma_f32_16x16x32_bf16 a[96:99], a[180:183], a[120:123], a[96:99]
    buffer_load_dwordx4 v[144:147], v220, s[16:19], s69 offen sc1
    v_mfma_f32_16x16x32_bf16 a[100:103], a[184:187], a[120:123], a[100:103]
    v_mfma_f32_16x16x32_bf16 a[104:107], a[188:191], a[120:123], a[104:107]
    s_waitcnt vmcnt(9)
    v_mfma_f32_16x16x32_bf16 v[108:111], v[76:79], a[124:127], v[108:111]
    v_mfma_f32_16x16x32_bf16 a[0:3], v[80:83], a[124:127], a[0:3]
    buffer_load_dwordx4 v[148:151], v221, s[16:19], s69 offen sc1
    v_mfma_f32_16x16x32_bf16 a[4:7], v[84:87], a[124:127], a[4:7]
    v_mfma_f32_16x16x32_bf16 a[8:11], v[88:91], a[124:127], a[8:11]
    s_waitcnt vmcnt(9)
    v_mfma_f32_16x16x32_bf16 v[112:115], v[76:79], v[44:47], v[112:115]
    v_mfma_f32_16x16x32_bf16 a[12:15], v[80:83], v[44:47], a[12:15]
    buffer_load_dwordx4 v[152:155], v222, s[16:19], s69 offen sc1
    v_mfma_f32_16x16x32_bf16 a[16:19], v[84:87], v[44:47], a[16:19]
    v_mfma_f32_16x16x32_bf16 a[20:23], v[88:91], v[44:47], a[20:23]
    s_waitcnt vmcnt(9)
    v_mfma_f32_16x16x32_bf16 v[116:119], v[76:79], v[48:51], v[116:119]
    v_mfma_f32_16x16x32_bf16 a[24:27], v[80:83], v[48:51], a[24:27]
    buffer_load_dwordx4 a[108:111], v223, s[16:19], s69 offen sc1
    v_mfma_f32_16x16x32_bf16 a[28:31], v[84:87], v[48:51], a[28:31]
    v_mfma_f32_16x16x32_bf16 a[32:35], v[88:91], v[48:51], a[32:35]
    s_waitcnt vmcnt(9)
    v_mfma_f32_16x16x32_bf16 v[120:123], v[76:79], v[52:55], v[120:123]
    v_mfma_f32_16x16x32_bf16 a[36:39], v[80:83], v[52:55], a[36:39]
    buffer_load_dwordx4 a[112:115], v224, s[16:19], s69 offen sc1
    v_mfma_f32_16x16x32_bf16 a[40:43], v[84:87], v[52:55], a[40:43]
    v_mfma_f32_16x16x32_bf16 a[44:47], v[88:91], v[52:55], a[44:47]
    s_waitcnt vmcnt(9)
    v_mfma_f32_16x16x32_bf16 v[124:127], v[76:79], v[56:59], v[124:127]
    v_mfma_f32_16x16x32_bf16 a[48:51], v[80:83], v[56:59], a[48:51]
    buffer_load_dwordx4 a[116:119], v225, s[16:19], s69 offen sc1
    v_mfma_f32_16x16x32_bf16 a[52:55], v[84:87], v[56:59], a[52:55]
    v_mfma_f32_16x16x32_bf16 a[56:59], v[88:91], v[56:59], a[56:59]
    s_waitcnt vmcnt(9)
    v_mfma_f32_16x16x32_bf16 v[128:131], v[76:79], v[60:63], v[128:131]
    v_mfma_f32_16x16x32_bf16 a[60:63], v[80:83], v[60:63], a[60:63]
    buffer_load_dwordx4 a[120:123], v226, s[16:19], s69 offen sc1
    v_mfma_f32_16x16x32_bf16 a[64:67], v[84:87], v[60:63], a[64:67]
    v_mfma_f32_16x16x32_bf16 a[68:71], v[88:91], v[60:63], a[68:71]
    s_waitcnt vmcnt(9)
    v_mfma_f32_16x16x32_bf16 v[132:135], v[76:79], v[64:67], v[132:135]
    v_mfma_f32_16x16x32_bf16 a[72:75], v[80:83], v[64:67], a[72:75]
    buffer_load_dwordx4 a[124:127], v227, s[16:19], s69 offen sc1
    v_mfma_f32_16x16x32_bf16 a[76:79], v[84:87], v[64:67], a[76:79]
    v_mfma_f32_16x16x32_bf16 a[80:83], v[88:91], v[64:67], a[80:83]
    s_waitcnt vmcnt(9)
    v_mfma_f32_16x16x32_bf16 v[136:139], v[76:79], v[68:71], v[136:139]
    v_mfma_f32_16x16x32_bf16 a[84:87], v[80:83], v[68:71], a[84:87]
    buffer_load_dwordx4 v[44:47], v228, s[16:19], s69 offen sc1
    v_mfma_f32_16x16x32_bf16 a[88:91], v[84:87], v[68:71], a[88:91]
    v_mfma_f32_16x16x32_bf16 a[92:95], v[88:91], v[68:71], a[92:95]
    s_waitcnt vmcnt(9)
    v_mfma_f32_16x16x32_bf16 v[140:143], v[76:79], v[72:75], v[140:143]
    s_xor_b32 s67, s61, 6144
    v_mfma_f32_16x16x32_bf16 a[96:99], v[80:83], v[72:75], a[96:99]
    buffer_load_dwordx4 v[48:51], v220, s[16:19], s67 offen sc1
    v_mfma_f32_16x16x32_bf16 a[100:103], v[84:87], v[72:75], a[100:103]
    v_mfma_f32_16x16x32_bf16 a[104:107], v[88:91], v[72:75], a[104:107]
    s_waitcnt vmcnt(9)
    v_mfma_f32_16x16x32_bf16 v[108:111], v[92:95], v[144:147], v[108:111]
    v_mfma_f32_16x16x32_bf16 a[0:3], v[96:99], v[144:147], a[0:3]
    buffer_load_dwordx4 v[52:55], v221, s[16:19], s67 offen sc1
    v_mfma_f32_16x16x32_bf16 a[4:7], v[100:103], v[144:147], a[4:7]
    v_mfma_f32_16x16x32_bf16 a[8:11], v[104:107], v[144:147], a[8:11]
    s_waitcnt vmcnt(9)
    v_mfma_f32_16x16x32_bf16 v[112:115], v[92:95], v[148:151], v[112:115]
    v_mfma_f32_16x16x32_bf16 a[12:15], v[96:99], v[148:151], a[12:15]
    buffer_load_dwordx4 v[56:59], v222, s[16:19], s67 offen sc1
    v_mfma_f32_16x16x32_bf16 a[16:19], v[100:103], v[148:151], a[16:19]
    v_mfma_f32_16x16x32_bf16 a[20:23], v[104:107], v[148:151], a[20:23]
    s_waitcnt vmcnt(9)
    v_mfma_f32_16x16x32_bf16 v[116:119], v[92:95], v[152:155], v[116:119]
    v_mfma_f32_16x16x32_bf16 a[24:27], v[96:99], v[152:155], a[24:27]
    buffer_load_dwordx4 v[60:63], v223, s[16:19], s67 offen sc1
    v_mfma_f32_16x16x32_bf16 a[28:31], v[100:103], v[152:155], a[28:31]
    v_mfma_f32_16x16x32_bf16 a[32:35], v[104:107], v[152:155], a[32:35]
    s_waitcnt vmcnt(9)
    v_mfma_f32_16x16x32_bf16 v[120:123], v[92:95], a[108:111], v[120:123]
    v_mfma_f32_16x16x32_bf16 a[36:39], v[96:99], a[108:111], a[36:39]
    buffer_load_dwordx4 v[64:67], v224, s[16:19], s67 offen sc1
    v_mfma_f32_16x16x32_bf16 a[40:43], v[100:103], a[108:111], a[40:43]
    v_mfma_f32_16x16x32_bf16 a[44:47], v[104:107], a[108:111], a[44:47]
    s_waitcnt vmcnt(9)
    v_mfma_f32_16x16x32_bf16 v[124:127], v[92:95], a[112:115], v[124:127]
    v_mfma_f32_16x16x32_bf16 a[48:51], v[96:99], a[112:115], a[48:51]
    buffer_load_dwordx4 v[68:71], v225, s[16:19], s67 offen sc1
    v_mfma_f32_16x16x32_bf16 a[52:55], v[100:103], a[112:115], a[52:55]
    v_mfma_f32_16x16x32_bf16 a[56:59], v[104:107], a[112:115], a[56:59]
    s_waitcnt vmcnt(9)
    v_mfma_f32_16x16x32_bf16 v[128:131], v[92:95], a[116:119], v[128:131]
    v_mfma_f32_16x16x32_bf16 a[60:63], v[96:99], a[116:119], a[60:63]
    buffer_load_dwordx4 v[72:75], v226, s[16:19], s67 offen sc1
    v_mfma_f32_16x16x32_bf16 a[64:67], v[100:103], a[116:119], a[64:67]
    v_mfma_f32_16x16x32_bf16 a[68:71], v[104:107], a[116:119], a[68:71]
    s_waitcnt vmcnt(9)
    v_mfma_f32_16x16x32_bf16 v[132:135], v[92:95], a[120:123], v[132:135]
    v_mfma_f32_16x16x32_bf16 a[72:75], v[96:99], a[120:123], a[72:75]
    buffer_load_dwordx4 v[144:147], v227, s[16:19], s67 offen sc1
    v_mfma_f32_16x16x32_bf16 a[76:79], v[100:103], a[120:123], a[76:79]
    v_mfma_f32_16x16x32_bf16 a[80:83], v[104:107], a[120:123], a[80:83]
    s_waitcnt vmcnt(9)
    v_mfma_f32_16x16x32_bf16 v[136:139], v[92:95], a[124:127], v[136:139]
    v_mfma_f32_16x16x32_bf16 a[84:87], v[96:99], a[124:127], a[84:87]
    buffer_load_dwordx4 v[148:151], v228, s[16:19], s67 offen sc1
    v_mfma_f32_16x16x32_bf16 a[88:91], v[100:103], a[124:127], a[88:91]
    v_mfma_f32_16x16x32_bf16 a[92:95], v[104:107], a[124:127], a[92:95]
    s_waitcnt vmcnt(9)
    v_mfma_f32_16x16x32_bf16 v[140:143], v[92:95], v[44:47], v[140:143]
    s_xor_b32 s86, s61, 7168
    v_mfma_f32_16x16x32_bf16 a[96:99], v[96:99], v[44:47], a[96:99]
    buffer_load_dwordx4 v[152:155], v220, s[16:19], s86 offen sc1
    v_mfma_f32_16x16x32_bf16 a[100:103], v[100:103], v[44:47], a[100:103]
    v_mfma_f32_16x16x32_bf16 a[104:107], v[104:107], v[44:47], a[104:107]
    s_waitcnt vmcnt(9)
    v_mfma_f32_16x16x32_bf16 v[108:111], a[192:195], v[48:51], v[108:111]
    v_mfma_f32_16x16x32_bf16 a[0:3], a[196:199], v[48:51], a[0:3]
    buffer_load_dwordx4 a[108:111], v221, s[16:19], s86 offen sc1
    v_mfma_f32_16x16x32_bf16 a[4:7], a[200:203], v[48:51], a[4:7]
    v_mfma_f32_16x16x32_bf16 a[8:11], a[204:207], v[48:51], a[8:11]
    s_waitcnt vmcnt(9)
    v_mfma_f32_16x16x32_bf16 v[112:115], a[192:195], v[52:55], v[112:115]
    v_mfma_f32_16x16x32_bf16 a[12:15], a[196:199], v[52:55], a[12:15]
    buffer_load_dwordx4 a[112:115], v222, s[16:19], s86 offen sc1
    v_mfma_f32_16x16x32_bf16 a[16:19], a[200:203], v[52:55], a[16:19]
    v_mfma_f32_16x16x32_bf16 a[20:23], a[204:207], v[52:55], a[20:23]
    s_waitcnt vmcnt(9)
    v_mfma_f32_16x16x32_bf16 v[116:119], a[192:195], v[56:59], v[116:119]
    v_mfma_f32_16x16x32_bf16 a[24:27], a[196:199], v[56:59], a[24:27]
    buffer_load_dwordx4 a[116:119], v223, s[16:19], s86 offen sc1
    v_mfma_f32_16x16x32_bf16 a[28:31], a[200:203], v[56:59], a[28:31]
    v_mfma_f32_16x16x32_bf16 a[32:35], a[204:207], v[56:59], a[32:35]
    s_waitcnt vmcnt(9)
    v_mfma_f32_16x16x32_bf16 v[120:123], a[192:195], v[60:63], v[120:123]
    v_mfma_f32_16x16x32_bf16 a[36:39], a[196:199], v[60:63], a[36:39]
    buffer_load_dwordx4 a[120:123], v224, s[16:19], s86 offen sc1
    v_mfma_f32_16x16x32_bf16 a[40:43], a[200:203], v[60:63], a[40:43]
    v_mfma_f32_16x16x32_bf16 a[44:47], a[204:207], v[60:63], a[44:47]
    s_waitcnt vmcnt(9)
    v_mfma_f32_16x16x32_bf16 v[124:127], a[192:195], v[64:67], v[124:127]
    v_mfma_f32_16x16x32_bf16 a[48:51], a[196:199], v[64:67], a[48:51]
    buffer_load_dwordx4 a[124:127], v225, s[16:19], s86 offen sc1
    v_mfma_f32_16x16x32_bf16 a[52:55], a[200:203], v[64:67], a[52:55]
    v_mfma_f32_16x16x32_bf16 a[56:59], a[204:207], v[64:67], a[56:59]
    s_waitcnt vmcnt(9)
    v_mfma_f32_16x16x32_bf16 v[128:131], a[192:195], v[68:71], v[128:131]
    v_mfma_f32_16x16x32_bf16 a[60:63], a[196:199], v[68:71], a[60:63]
    buffer_load_dwordx4 v[44:47], v226, s[16:19], s86 offen sc1
    v_mfma_f32_16x16x32_bf16 a[64:67], a[200:203], v[68:71], a[64:67]
    v_mfma_f32_16x16x32_bf16 a[68:71], a[204:207], v[68:71], a[68:71]
    s_waitcnt vmcnt(9)
    v_mfma_f32_16x16x32_bf16 v[132:135], a[192:195], v[72:75], v[132:135]
    v_mfma_f32_16x16x32_bf16 a[72:75], a[196:199], v[72:75], a[72:75]
    buffer_load_dwordx4 v[48:51], v227, s[16:19], s86 offen sc1
    v_mfma_f32_16x16x32_bf16 a[76:79], a[200:203], v[72:75], a[76:79]
    v_mfma_f32_16x16x32_bf16 a[80:83], a[204:207], v[72:75], a[80:83]
    s_waitcnt vmcnt(9)
    v_mfma_f32_16x16x32_bf16 v[136:139], a[192:195], v[144:147], v[136:139]
    v_mfma_f32_16x16x32_bf16 a[84:87], a[196:199], v[144:147], a[84:87]
    buffer_load_dwordx4 v[52:55], v228, s[16:19], s86 offen sc1
    v_mfma_f32_16x16x32_bf16 a[88:91], a[200:203], v[144:147], a[88:91]
    v_mfma_f32_16x16x32_bf16 a[92:95], a[204:207], v[144:147], a[92:95]
    s_waitcnt vmcnt(9)
    v_mfma_f32_16x16x32_bf16 v[140:143], a[192:195], v[148:151], v[140:143]
    s_xor_b32 s48, s61, 8192
    v_mfma_f32_16x16x32_bf16 a[96:99], a[196:199], v[148:151], a[96:99]
    buffer_load_dwordx4 v[56:59], v220, s[16:19], s48 offen sc1
    v_mfma_f32_16x16x32_bf16 a[100:103], a[200:203], v[148:151], a[100:103]
    v_mfma_f32_16x16x32_bf16 a[104:107], a[204:207], v[148:151], a[104:107]
    s_waitcnt vmcnt(9)
    v_mfma_f32_16x16x32_bf16 v[108:111], a[208:211], v[152:155], v[108:111]
    v_mfma_f32_16x16x32_bf16 a[0:3], a[212:215], v[152:155], a[0:3]
    buffer_load_dwordx4 v[60:63], v221, s[16:19], s48 offen sc1
    v_mfma_f32_16x16x32_bf16 a[4:7], a[216:219], v[152:155], a[4:7]
    v_mfma_f32_16x16x32_bf16 a[8:11], a[220:223], v[152:155], a[8:11]
    s_waitcnt vmcnt(9)
    v_mfma_f32_16x16x32_bf16 v[112:115], a[208:211], a[108:111], v[112:115]
    v_mfma_f32_16x16x32_bf16 a[12:15], a[212:215], a[108:111], a[12:15]
    buffer_load_dwordx4 v[64:67], v222, s[16:19], s48 offen sc1
    v_mfma_f32_16x16x32_bf16 a[16:19], a[216:219], a[108:111], a[16:19]
    v_mfma_f32_16x16x32_bf16 a[20:23], a[220:223], a[108:111], a[20:23]
    s_waitcnt vmcnt(9)
    v_mfma_f32_16x16x32_bf16 v[116:119], a[208:211], a[112:115], v[116:119]
    v_mfma_f32_16x16x32_bf16 a[24:27], a[212:215], a[112:115], a[24:27]
    buffer_load_dwordx4 v[68:71], v223, s[16:19], s48 offen sc1
    v_mfma_f32_16x16x32_bf16 a[28:31], a[216:219], a[112:115], a[28:31]
    v_mfma_f32_16x16x32_bf16 a[32:35], a[220:223], a[112:115], a[32:35]
    s_waitcnt vmcnt(9)
    v_mfma_f32_16x16x32_bf16 v[120:123], a[208:211], a[116:119], v[120:123]
    v_mfma_f32_16x16x32_bf16 a[36:39], a[212:215], a[116:119], a[36:39]
    buffer_load_dwordx4 v[72:75], v224, s[16:19], s48 offen sc1
    v_mfma_f32_16x16x32_bf16 a[40:43], a[216:219], a[116:119], a[40:43]
    v_mfma_f32_16x16x32_bf16 a[44:47], a[220:223], a[116:119], a[44:47]
    s_waitcnt vmcnt(9)
    v_mfma_f32_16x16x32_bf16 v[124:127], a[208:211], a[120:123], v[124:127]
    v_mfma_f32_16x16x32_bf16 a[48:51], a[212:215], a[120:123], a[48:51]
    buffer_load_dwordx4 v[144:147], v225, s[16:19], s48 offen sc1
    v_mfma_f32_16x16x32_bf16 a[52:55], a[216:219], a[120:123], a[52:55]
    v_mfma_f32_16x16x32_bf16 a[56:59], a[220:223], a[120:123], a[56:59]
    s_waitcnt vmcnt(9)
    v_mfma_f32_16x16x32_bf16 v[128:131], a[208:211], a[124:127], v[128:131]
    v_mfma_f32_16x16x32_bf16 a[60:63], a[212:215], a[124:127], a[60:63]
    buffer_load_dwordx4 v[148:151], v226, s[16:19], s48 offen sc1
    v_mfma_f32_16x16x32_bf16 a[64:67], a[216:219], a[124:127], a[64:67]
    v_mfma_f32_16x16x32_bf16 a[68:71], a[220:223], a[124:127], a[68:71]
    s_waitcnt vmcnt(9)
    v_mfma_f32_16x16x32_bf16 v[132:135], a[208:211], v[44:47], v[132:135]
    v_mfma_f32_16x16x32_bf16 a[72:75], a[212:215], v[44:47], a[72:75]
    buffer_load_dwordx4 v[152:155], v227, s[16:19], s48 offen sc1
    v_mfma_f32_16x16x32_bf16 a[76:79], a[216:219], v[44:47], a[76:79]
    v_mfma_f32_16x16x32_bf16 a[80:83], a[220:223], v[44:47], a[80:83]
    s_waitcnt vmcnt(9)
    v_mfma_f32_16x16x32_bf16 v[136:139], a[208:211], v[48:51], v[136:139]
    v_mfma_f32_16x16x32_bf16 a[84:87], a[212:215], v[48:51], a[84:87]
    buffer_load_dwordx4 a[108:111], v228, s[16:19], s48 offen sc1
    v_mfma_f32_16x16x32_bf16 a[88:91], a[216:219], v[48:51], a[88:91]
    v_mfma_f32_16x16x32_bf16 a[92:95], a[220:223], v[48:51], a[92:95]
    s_waitcnt vmcnt(9)
    v_mfma_f32_16x16x32_bf16 v[140:143], a[208:211], v[52:55], v[140:143]
    s_xor_b32 s49, s61, 9216
    v_mfma_f32_16x16x32_bf16 a[96:99], a[212:215], v[52:55], a[96:99]
    buffer_load_dwordx4 a[112:115], v220, s[16:19], s49 offen sc1
    v_mfma_f32_16x16x32_bf16 a[100:103], a[216:219], v[52:55], a[100:103]
    v_mfma_f32_16x16x32_bf16 a[104:107], a[220:223], v[52:55], a[104:107]
    s_waitcnt vmcnt(9)
    v_mfma_f32_16x16x32_bf16 v[108:111], v[156:159], v[56:59], v[108:111]
    v_mfma_f32_16x16x32_bf16 a[0:3], v[160:163], v[56:59], a[0:3]
    buffer_load_dwordx4 a[116:119], v221, s[16:19], s49 offen sc1
    v_mfma_f32_16x16x32_bf16 a[4:7], v[164:167], v[56:59], a[4:7]
    v_add_u32 v229, s91, v10
    v_mfma_f32_16x16x32_bf16 a[8:11], v[168:171], v[56:59], a[8:11]
    s_waitcnt vmcnt(9)
    v_mfma_f32_16x16x32_bf16 v[112:115], v[156:159], v[60:63], v[112:115]
    v_mfma_f32_16x16x32_bf16 a[12:15], v[160:163], v[60:63], a[12:15]
    buffer_load_dwordx4 a[120:123], v222, s[16:19], s49 offen sc1
    v_mfma_f32_16x16x32_bf16 a[16:19], v[164:167], v[60:63], a[16:19]
    v_add_u32 v230, 65536, v229
    v_mfma_f32_16x16x32_bf16 a[20:23], v[168:171], v[60:63], a[20:23]
    s_waitcnt vmcnt(9)
    v_mfma_f32_16x16x32_bf16 v[116:119], v[156:159], v[64:67], v[116:119]
    v_mfma_f32_16x16x32_bf16 a[24:27], v[160:163], v[64:67], a[24:27]
    buffer_load_dwordx4 a[124:127], v223, s[16:19], s49 offen sc1
    v_mfma_f32_16x16x32_bf16 a[28:31], v[164:167], v[64:67], a[28:31]
    v_xor_b32 v231, 8192, v229
    v_mfma_f32_16x16x32_bf16 a[32:35], v[168:171], v[64:67], a[32:35]
    s_waitcnt vmcnt(9)
    v_mfma_f32_16x16x32_bf16 v[120:123], v[156:159], v[68:71], v[120:123]
    v_mfma_f32_16x16x32_bf16 a[36:39], v[160:163], v[68:71], a[36:39]
    buffer_load_dwordx4 v[44:47], v224, s[16:19], s49 offen sc1
    v_mfma_f32_16x16x32_bf16 a[40:43], v[164:167], v[68:71], a[40:43]
    v_xor_b32 v236, 16384, v229
    v_mfma_f32_16x16x32_bf16 a[44:47], v[168:171], v[68:71], a[44:47]
    s_waitcnt vmcnt(9)
    v_mfma_f32_16x16x32_bf16 v[124:127], v[156:159], v[72:75], v[124:127]
    v_mfma_f32_16x16x32_bf16 a[48:51], v[160:163], v[72:75], a[48:51]
    buffer_load_dwordx4 v[48:51], v225, s[16:19], s49 offen sc1
    v_mfma_f32_16x16x32_bf16 a[52:55], v[164:167], v[72:75], a[52:55]
    v_xor_b32 v237, 16384, v230
    v_mfma_f32_16x16x32_bf16 a[56:59], v[168:171], v[72:75], a[56:59]
    s_waitcnt vmcnt(9)
    v_mfma_f32_16x16x32_bf16 v[128:131], v[156:159], v[144:147], v[128:131]
    v_mfma_f32_16x16x32_bf16 a[60:63], v[160:163], v[144:147], a[60:63]
    buffer_load_dwordx4 v[52:55], v226, s[16:19], s49 offen sc1
    v_mfma_f32_16x16x32_bf16 a[64:67], v[164:167], v[144:147], a[64:67]
    v_xor_b32 v238, 24576, v230
    v_mfma_f32_16x16x32_bf16 a[68:71], v[168:171], v[144:147], a[68:71]
    s_waitcnt vmcnt(9)
    v_mfma_f32_16x16x32_bf16 v[132:135], v[156:159], v[148:151], v[132:135]
    v_mfma_f32_16x16x32_bf16 a[72:75], v[160:163], v[148:151], a[72:75]
    buffer_load_dwordx4 v[56:59], v227, s[16:19], s49 offen sc1
    v_mfma_f32_16x16x32_bf16 a[76:79], v[164:167], v[148:151], a[76:79]
    v_and_b32 v239, 15, v0
    v_mfma_f32_16x16x32_bf16 a[80:83], v[168:171], v[148:151], a[80:83]
    s_waitcnt vmcnt(9)
    v_mfma_f32_16x16x32_bf16 v[136:139], v[156:159], v[152:155], v[136:139]
    v_mfma_f32_16x16x32_bf16 a[84:87], v[160:163], v[152:155], a[84:87]
    buffer_load_dwordx4 v[60:63], v228, s[16:19], s49 offen sc1
    v_mfma_f32_16x16x32_bf16 a[88:91], v[164:167], v[152:155], a[88:91]
    v_lshlrev_b32 v239, 10, v239
    v_mfma_f32_16x16x32_bf16 a[92:95], v[168:171], v[152:155], a[92:95]
    s_waitcnt vmcnt(9)
    v_mfma_f32_16x16x32_bf16 v[140:143], v[156:159], a[108:111], v[140:143]
    s_xor_b32 s52, s61, 10240
    v_mfma_f32_16x16x32_bf16 a[96:99], v[160:163], a[108:111], a[96:99]
    buffer_load_dwordx4 v[64:67], v220, s[16:19], s52 offen sc1
    v_mfma_f32_16x16x32_bf16 a[100:103], v[164:167], a[108:111], a[100:103]
    v_lshrrev_b32 v240, 4, v0
    v_mfma_f32_16x16x32_bf16 a[104:107], v[168:171], a[108:111], a[104:107]
    s_waitcnt vmcnt(9)
    v_mfma_f32_16x16x32_bf16 v[108:111], v[172:175], a[112:115], v[108:111]
    v_mfma_f32_16x16x32_bf16 a[0:3], v[176:179], a[112:115], a[0:3]
    buffer_load_dwordx4 v[68:71], v221, s[16:19], s52 offen sc1
    v_mfma_f32_16x16x32_bf16 a[4:7], v[180:183], a[112:115], a[4:7]
    v_lshl_add_u32 v239, v240, 3, v239
    v_mfma_f32_16x16x32_bf16 a[8:11], v[184:187], a[112:115], a[8:11]
    s_waitcnt vmcnt(9)
    v_mfma_f32_16x16x32_bf16 v[112:115], v[172:175], a[116:119], v[112:115]
    v_mfma_f32_16x16x32_bf16 a[12:15], v[176:179], a[116:119], a[12:15]
    buffer_load_dwordx4 v[72:75], v222, s[16:19], s52 offen sc1
    v_mfma_f32_16x16x32_bf16 a[16:19], v[180:183], a[116:119], a[16:19]
    s_lshl_b32 s6, s88, 7
    s_lshl_b32 s7, s3, 5
    s_add_u32 s6, s6, s7
    s_add_u32 s66, s6, 65536
    s_mul_i32 s7, s90, 81920
    s_add_u32 s6, s6, s7
    s_add_u32 s7, s50, 4096
    s_add_u32 s64, s51, 4096
    v_mfma_f32_16x16x32_bf16 a[20:23], v[184:187], a[116:119], a[20:23]
    s_waitcnt vmcnt(9)
    v_mfma_f32_16x16x32_bf16 v[116:119], v[172:175], a[120:123], v[116:119]
    v_mfma_f32_16x16x32_bf16 a[24:27], v[176:179], a[120:123], a[24:27]
    buffer_load_dwordx4 v[144:147], v223, s[16:19], s52 offen sc1
    v_mfma_f32_16x16x32_bf16 a[28:31], v[180:183], a[120:123], a[28:31]
    v_mfma_f32_16x16x32_bf16 a[32:35], v[184:187], a[120:123], a[32:35]
    s_waitcnt vmcnt(9)
    v_mfma_f32_16x16x32_bf16 v[120:123], v[172:175], a[124:127], v[120:123]
    v_mfma_f32_16x16x32_bf16 a[36:39], v[176:179], a[124:127], a[36:39]
    buffer_load_dwordx4 v[148:151], v224, s[16:19], s52 offen sc1
    v_mfma_f32_16x16x32_bf16 a[40:43], v[180:183], a[124:127], a[40:43]
    v_mfma_f32_16x16x32_bf16 a[44:47], v[184:187], a[124:127], a[44:47]
    s_waitcnt vmcnt(9)
    v_mfma_f32_16x16x32_bf16 v[124:127], v[172:175], v[44:47], v[124:127]
    v_mfma_f32_16x16x32_bf16 a[48:51], v[176:179], v[44:47], a[48:51]
    buffer_load_dwordx4 v[152:155], v225, s[16:19], s52 offen sc1
    v_mfma_f32_16x16x32_bf16 a[52:55], v[180:183], v[44:47], a[52:55]
    v_mfma_f32_16x16x32_bf16 a[56:59], v[184:187], v[44:47], a[56:59]
    s_waitcnt vmcnt(9)
    v_mfma_f32_16x16x32_bf16 v[128:131], v[172:175], v[48:51], v[128:131]
    v_mfma_f32_16x16x32_bf16 a[60:63], v[176:179], v[48:51], a[60:63]
    buffer_load_dwordx4 a[108:111], v226, s[16:19], s52 offen sc1
    v_mfma_f32_16x16x32_bf16 a[64:67], v[180:183], v[48:51], a[64:67]
    v_mfma_f32_16x16x32_bf16 a[68:71], v[184:187], v[48:51], a[68:71]
    s_waitcnt vmcnt(9)
    v_mfma_f32_16x16x32_bf16 v[132:135], v[172:175], v[52:55], v[132:135]
    v_mfma_f32_16x16x32_bf16 a[72:75], v[176:179], v[52:55], a[72:75]
    buffer_load_dwordx4 a[112:115], v227, s[16:19], s52 offen sc1
    v_mfma_f32_16x16x32_bf16 a[76:79], v[180:183], v[52:55], a[76:79]
    v_mfma_f32_16x16x32_bf16 a[80:83], v[184:187], v[52:55], a[80:83]
    s_waitcnt vmcnt(9)
    v_mfma_f32_16x16x32_bf16 v[136:139], v[172:175], v[56:59], v[136:139]
    v_mfma_f32_16x16x32_bf16 a[84:87], v[176:179], v[56:59], a[84:87]
    buffer_load_dwordx4 a[116:119], v228, s[16:19], s52 offen sc1
    v_mfma_f32_16x16x32_bf16 a[88:91], v[180:183], v[56:59], a[88:91]
    v_mfma_f32_16x16x32_bf16 a[92:95], v[184:187], v[56:59], a[92:95]
    s_waitcnt vmcnt(9)
    v_mfma_f32_16x16x32_bf16 v[140:143], v[172:175], v[60:63], v[140:143]
    s_xor_b32 s53, s61, 11264
    v_mfma_f32_16x16x32_bf16 a[96:99], v[176:179], v[60:63], a[96:99]
    buffer_load_dwordx4 a[120:123], v224, s[16:19], s53 offen sc1
    v_mfma_f32_16x16x32_bf16 a[100:103], v[180:183], v[60:63], a[100:103]
    v_mfma_f32_16x16x32_bf16 a[104:107], v[184:187], v[60:63], a[104:107]
    s_waitcnt vmcnt(9)
    s_waitcnt lgkmcnt(0)
    v_mfma_f32_16x16x32_bf16 v[108:111], v[188:191], v[64:67], v[108:111]
    s_xor_b32 s68, s61, 12288
    v_mfma_f32_16x16x32_bf16 a[0:3], v[192:195], v[64:67], a[0:3]
    buffer_load_dwordx4 a[124:127], v224, s[16:19], s68 offen sc1
    v_mfma_f32_16x16x32_bf16 a[4:7], v[196:199], v[64:67], a[4:7]
    v_mfma_f32_16x16x32_bf16 a[8:11], v[200:203], v[64:67], a[8:11]
    s_waitcnt vmcnt(9)
    v_mfma_f32_16x16x32_bf16 v[112:115], v[188:191], v[68:71], v[112:115]
    s_xor_b32 s69, s61, 13312
    v_mfma_f32_16x16x32_bf16 a[12:15], v[192:195], v[68:71], a[12:15]
    buffer_load_dwordx4 v[44:47], v224, s[16:19], s69 offen sc1
    v_mfma_f32_16x16x32_bf16 a[16:19], v[196:199], v[68:71], a[16:19]
    v_mfma_f32_16x16x32_bf16 a[20:23], v[200:203], v[68:71], a[20:23]
    s_waitcnt vmcnt(9)
    v_mfma_f32_16x16x32_bf16 v[116:119], v[188:191], v[72:75], v[116:119]
    s_xor_b32 s67, s61, 14336
    v_mfma_f32_16x16x32_bf16 a[24:27], v[192:195], v[72:75], a[24:27]
    buffer_load_dwordx4 v[48:51], v224, s[16:19], s67 offen sc1
    v_mfma_f32_16x16x32_bf16 a[28:31], v[196:199], v[72:75], a[28:31]
    v_mfma_f32_16x16x32_bf16 a[32:35], v[200:203], v[72:75], a[32:35]
    s_waitcnt vmcnt(9)
    v_mfma_f32_16x16x32_bf16 v[120:123], v[188:191], v[144:147], v[120:123]
    s_xor_b32 s86, s61, 15360
    v_mfma_f32_16x16x32_bf16 a[36:39], v[192:195], v[144:147], a[36:39]
    buffer_load_dwordx4 v[52:55], v224, s[16:19], s86 offen sc1
    v_mfma_f32_16x16x32_bf16 a[40:43], v[196:199], v[144:147], a[40:43]
    v_mfma_f32_16x16x32_bf16 a[44:47], v[200:203], v[144:147], a[44:47]
    s_waitcnt vmcnt(9)
    v_mfma_f32_16x16x32_bf16 v[124:127], v[188:191], v[148:151], v[124:127]
    v_mfma_f32_16x16x32_bf16 a[48:51], v[192:195], v[148:151], a[48:51]
    buffer_load_dwordx4 v[56:59], v225, s[16:19], s53 offen sc1
    v_mfma_f32_16x16x32_bf16 a[52:55], v[196:199], v[148:151], a[52:55]
    v_mfma_f32_16x16x32_bf16 a[56:59], v[200:203], v[148:151], a[56:59]
    s_waitcnt vmcnt(9)
    v_mfma_f32_16x16x32_bf16 v[128:131], v[188:191], v[152:155], v[128:131]
    v_mfma_f32_16x16x32_bf16 a[60:63], v[192:195], v[152:155], a[60:63]
    buffer_load_dwordx4 v[60:63], v225, s[16:19], s68 offen sc1
    v_mfma_f32_16x16x32_bf16 a[64:67], v[196:199], v[152:155], a[64:67]
    v_mfma_f32_16x16x32_bf16 a[68:71], v[200:203], v[152:155], a[68:71]
    s_waitcnt vmcnt(9)
    v_mfma_f32_16x16x32_bf16 v[132:135], v[188:191], a[108:111], v[132:135]
    v_mfma_f32_16x16x32_bf16 a[72:75], v[192:195], a[108:111], a[72:75]
    buffer_load_dwordx4 v[64:67], v225, s[16:19], s69 offen sc1
    v_mfma_f32_16x16x32_bf16 a[76:79], v[196:199], a[108:111], a[76:79]
    v_mfma_f32_16x16x32_bf16 a[80:83], v[200:203], a[108:111], a[80:83]
    s_waitcnt vmcnt(9)
    v_mfma_f32_16x16x32_bf16 v[136:139], v[188:191], a[112:115], v[136:139]
    v_mfma_f32_16x16x32_bf16 a[84:87], v[192:195], a[112:115], a[84:87]
    buffer_load_dwordx4 v[68:71], v225, s[16:19], s67 offen sc1
    v_mfma_f32_16x16x32_bf16 a[88:91], v[196:199], a[112:115], a[88:91]
    v_mfma_f32_16x16x32_bf16 a[92:95], v[200:203], a[112:115], a[92:95]
    s_waitcnt vmcnt(9)
    v_mfma_f32_16x16x32_bf16 v[140:143], v[188:191], a[116:119], v[140:143]
    s_waitcnt lgkmcnt(0)
    v_mfma_f32_16x16x32_bf16 a[96:99], v[192:195], a[116:119], a[96:99]
    buffer_load_dwordx4 v[72:75], v225, s[16:19], s86 offen sc1
    v_mfma_f32_16x16x32_bf16 a[100:103], v[196:199], a[116:119], a[100:103]
    v_mfma_f32_16x16x32_bf16 a[104:107], v[200:203], a[116:119], a[104:107]
    s_waitcnt vmcnt(9)
    v_mfma_f32_16x16x32_bf16 v[124:127], v[204:207], a[120:123], v[124:127]
    v_mfma_f32_16x16x32_bf16 a[48:51], v[208:211], a[120:123], a[48:51]
    buffer_load_dwordx4 v[144:147], v226, s[16:19], s53 offen sc1
    v_mfma_f32_16x16x32_bf16 a[52:55], v[212:215], a[120:123], a[52:55]
    v_mfma_f32_16x16x32_bf16 a[56:59], v[216:219], a[120:123], a[56:59]
    s_waitcnt vmcnt(9)
    v_mfma_f32_16x16x32_bf16 v[124:127], v[12:15], a[124:127], v[124:127]
    v_mfma_f32_16x16x32_bf16 a[48:51], v[16:19], a[124:127], a[48:51]
    buffer_load_dwordx4 v[148:151], v226, s[16:19], s68 offen sc1
    v_mfma_f32_16x16x32_bf16 a[52:55], v[20:23], a[124:127], a[52:55]
    v_mfma_f32_16x16x32_bf16 a[56:59], v[24:27], a[124:127], a[56:59]
    s_waitcnt vmcnt(9)
    v_mfma_f32_16x16x32_bf16 v[124:127], v[28:31], v[44:47], v[124:127]
    v_mfma_f32_16x16x32_bf16 a[48:51], v[32:35], v[44:47], a[48:51]
    buffer_load_dwordx4 v[152:155], v226, s[16:19], s69 offen sc1
    v_mfma_f32_16x16x32_bf16 a[52:55], v[36:39], v[44:47], a[52:55]
    v_mfma_f32_16x16x32_bf16 a[56:59], v[40:43], v[44:47], a[56:59]
    s_waitcnt vmcnt(9)
    v_mfma_f32_16x16x32_bf16 v[124:127], a[224:227], v[48:51], v[124:127]
    v_mfma_f32_16x16x32_bf16 a[48:51], a[228:231], v[48:51], a[48:51]
    buffer_load_dwordx4 a[108:111], v226, s[16:19], s67 offen sc1
    v_mfma_f32_16x16x32_bf16 a[52:55], a[232:235], v[48:51], a[52:55]
    v_mfma_f32_16x16x32_bf16 a[56:59], a[236:239], v[48:51], a[56:59]
    s_waitcnt vmcnt(9)
    v_mfma_f32_16x16x32_bf16 v[124:127], a[240:243], v[52:55], v[124:127]
    v_mfma_f32_16x16x32_bf16 a[48:51], a[244:247], v[52:55], a[48:51]
    buffer_load_dwordx4 a[112:115], v226, s[16:19], s86 offen sc1
    v_mfma_f32_16x16x32_bf16 a[52:55], a[248:251], v[52:55], a[52:55]
    v_mfma_f32_16x16x32_bf16 a[56:59], a[252:255], v[52:55], a[56:59]
    s_waitcnt vmcnt(9)
    v_mfma_f32_16x16x32_bf16 v[128:131], v[204:207], v[56:59], v[128:131]
    v_mfma_f32_16x16x32_bf16 a[60:63], v[208:211], v[56:59], a[60:63]
    buffer_load_dwordx4 a[116:119], v227, s[16:19], s53 offen sc1
    v_mfma_f32_16x16x32_bf16 a[64:67], v[212:215], v[56:59], a[64:67]
    v_mfma_f32_16x16x32_bf16 a[68:71], v[216:219], v[56:59], a[68:71]
    s_waitcnt vmcnt(9)
    v_mfma_f32_16x16x32_bf16 v[128:131], v[12:15], v[60:63], v[128:131]
    v_mfma_f32_16x16x32_bf16 a[60:63], v[16:19], v[60:63], a[60:63]
    buffer_load_dwordx4 a[120:123], v227, s[16:19], s68 offen sc1
    v_mfma_f32_16x16x32_bf16 a[64:67], v[20:23], v[60:63], a[64:67]
    ds_write_b128 v229, a[48:51] offset:4096
    v_mfma_f32_16x16x32_bf16 a[68:71], v[24:27], v[60:63], a[68:71]
    s_waitcnt vmcnt(9)
    v_mfma_f32_16x16x32_bf16 v[128:131], v[28:31], v[64:67], v[128:131]
    ds_write_b128 v229, a[52:55] offset:37888
    v_mfma_f32_16x16x32_bf16 a[60:63], v[32:35], v[64:67], a[60:63]
    buffer_load_dwordx4 a[124:127], v227, s[16:19], s69 offen sc1
    v_mfma_f32_16x16x32_bf16 a[64:67], v[36:39], v[64:67], a[64:67]
    ds_write_b128 v230, a[56:59] offset:6144
    v_mfma_f32_16x16x32_bf16 a[68:71], v[40:43], v[64:67], a[68:71]
    s_waitcnt vmcnt(9)
    v_mfma_f32_16x16x32_bf16 v[128:131], a[224:227], v[68:71], v[128:131]
    v_mfma_f32_16x16x32_bf16 a[60:63], a[228:231], v[68:71], a[60:63]
    buffer_load_dwordx4 v[44:47], v227, s[16:19], s67 offen sc1
    v_mfma_f32_16x16x32_bf16 a[64:67], a[232:235], v[68:71], a[64:67]
    v_mfma_f32_16x16x32_bf16 a[68:71], a[236:239], v[68:71], a[68:71]
    s_waitcnt vmcnt(9)
    v_mfma_f32_16x16x32_bf16 v[128:131], a[240:243], v[72:75], v[128:131]
    v_mfma_f32_16x16x32_bf16 a[60:63], a[244:247], v[72:75], a[60:63]
    buffer_load_dwordx4 v[48:51], v227, s[16:19], s86 offen sc1
    v_mfma_f32_16x16x32_bf16 a[64:67], a[248:251], v[72:75], a[64:67]
    v_mfma_f32_16x16x32_bf16 a[68:71], a[252:255], v[72:75], a[68:71]
    s_waitcnt vmcnt(9)
    v_mfma_f32_16x16x32_bf16 v[132:135], v[204:207], v[144:147], v[132:135]
    v_mfma_f32_16x16x32_bf16 a[72:75], v[208:211], v[144:147], a[72:75]
    buffer_load_dwordx4 v[52:55], v228, s[16:19], s53 offen sc1
    v_mfma_f32_16x16x32_bf16 a[76:79], v[212:215], v[144:147], a[76:79]
    v_mfma_f32_16x16x32_bf16 a[80:83], v[216:219], v[144:147], a[80:83]
    s_waitcnt vmcnt(9)
    v_mfma_f32_16x16x32_bf16 v[132:135], v[12:15], v[148:151], v[132:135]
    v_mfma_f32_16x16x32_bf16 a[72:75], v[16:19], v[148:151], a[72:75]
    buffer_load_dwordx4 v[56:59], v228, s[16:19], s68 offen sc1
    v_mfma_f32_16x16x32_bf16 a[76:79], v[20:23], v[148:151], a[76:79]
    ds_write_b128 v229, a[60:63] offset:5120
    v_mfma_f32_16x16x32_bf16 a[80:83], v[24:27], v[148:151], a[80:83]
    s_waitcnt vmcnt(9)
    v_mfma_f32_16x16x32_bf16 v[132:135], v[28:31], v[152:155], v[132:135]
    ds_write_b128 v229, a[64:67] offset:38912
    v_mfma_f32_16x16x32_bf16 a[72:75], v[32:35], v[152:155], a[72:75]
    buffer_load_dwordx4 v[60:63], v228, s[16:19], s69 offen sc1
    v_mfma_f32_16x16x32_bf16 a[76:79], v[36:39], v[152:155], a[76:79]
    ds_write_b128 v230, a[68:71] offset:7168
    v_mfma_f32_16x16x32_bf16 a[80:83], v[40:43], v[152:155], a[80:83]
    s_waitcnt vmcnt(9)
    v_mfma_f32_16x16x32_bf16 v[132:135], a[224:227], a[108:111], v[132:135]
    v_mfma_f32_16x16x32_bf16 a[72:75], a[228:231], a[108:111], a[72:75]
    buffer_load_dwordx4 v[64:67], v228, s[16:19], s67 offen sc1
    v_mfma_f32_16x16x32_bf16 a[76:79], a[232:235], a[108:111], a[76:79]
    v_mfma_f32_16x16x32_bf16 a[80:83], a[236:239], a[108:111], a[80:83]
    s_waitcnt vmcnt(9)
    v_mfma_f32_16x16x32_bf16 v[132:135], a[240:243], a[112:115], v[132:135]
    v_mfma_f32_16x16x32_bf16 a[72:75], a[244:247], a[112:115], a[72:75]
    buffer_load_dwordx4 v[68:71], v228, s[16:19], s86 offen sc1
    v_mfma_f32_16x16x32_bf16 a[76:79], a[248:251], a[112:115], a[76:79]
    v_mfma_f32_16x16x32_bf16 a[80:83], a[252:255], a[112:115], a[80:83]
    s_waitcnt vmcnt(9)
    v_mfma_f32_16x16x32_bf16 v[136:139], v[204:207], a[116:119], v[136:139]
    v_mfma_f32_16x16x32_bf16 a[84:87], v[208:211], a[116:119], a[84:87]
    buffer_load_dwordx4 v[72:75], v220, s[16:19], s53 offen sc1
    v_mfma_f32_16x16x32_bf16 a[88:91], v[212:215], a[116:119], a[88:91]
    v_mfma_f32_16x16x32_bf16 a[92:95], v[216:219], a[116:119], a[92:95]
    s_waitcnt vmcnt(9)
    v_mfma_f32_16x16x32_bf16 v[136:139], v[12:15], a[120:123], v[136:139]
    v_mfma_f32_16x16x32_bf16 a[84:87], v[16:19], a[120:123], a[84:87]
    buffer_load_dwordx4 v[144:147], v220, s[16:19], s68 offen sc1
    v_mfma_f32_16x16x32_bf16 a[88:91], v[20:23], a[120:123], a[88:91]
    ds_write_b128 v229, a[72:75] offset:6144
    v_mfma_f32_16x16x32_bf16 a[92:95], v[24:27], a[120:123], a[92:95]
    s_waitcnt vmcnt(9)
    v_mfma_f32_16x16x32_bf16 v[136:139], v[28:31], a[124:127], v[136:139]
    ds_write_b128 v229, a[76:79] offset:39936
    v_mfma_f32_16x16x32_bf16 a[84:87], v[32:35], a[124:127], a[84:87]
    buffer_load_dwordx4 v[148:151], v220, s[16:19], s69 offen sc1
    v_mfma_f32_16x16x32_bf16 a[88:91], v[36:39], a[124:127], a[88:91]
    ds_write_b128 v230, a[80:83] offset:32768
    v_mfma_f32_16x16x32_bf16 a[92:95], v[40:43], a[124:127], a[92:95]
    s_waitcnt vmcnt(9)
    v_mfma_f32_16x16x32_bf16 v[136:139], a[224:227], v[44:47], v[136:139]
    v_mfma_f32_16x16x32_bf16 a[84:87], a[228:231], v[44:47], a[84:87]
    buffer_load_dwordx4 v[152:155], v220, s[16:19], s67 offen sc1
    v_mfma_f32_16x16x32_bf16 a[88:91], a[232:235], v[44:47], a[88:91]
    v_mfma_f32_16x16x32_bf16 a[92:95], a[236:239], v[44:47], a[92:95]
    s_waitcnt vmcnt(9)
    v_mfma_f32_16x16x32_bf16 v[136:139], a[240:243], v[48:51], v[136:139]
    v_mfma_f32_16x16x32_bf16 a[84:87], a[244:247], v[48:51], a[84:87]
    buffer_load_dwordx4 a[108:111], v220, s[16:19], s86 offen sc1
    v_mfma_f32_16x16x32_bf16 a[88:91], a[248:251], v[48:51], a[88:91]
    v_mfma_f32_16x16x32_bf16 a[92:95], a[252:255], v[48:51], a[92:95]
    s_waitcnt vmcnt(9)
    v_mfma_f32_16x16x32_bf16 v[140:143], v[204:207], v[52:55], v[140:143]
    v_mfma_f32_16x16x32_bf16 a[96:99], v[208:211], v[52:55], a[96:99]
    buffer_load_dwordx4 a[112:115], v221, s[16:19], s53 offen sc1
    v_mfma_f32_16x16x32_bf16 a[100:103], v[212:215], v[52:55], a[100:103]
    v_mfma_f32_16x16x32_bf16 a[104:107], v[216:219], v[52:55], a[104:107]
    s_waitcnt vmcnt(9)
    v_mfma_f32_16x16x32_bf16 v[140:143], v[12:15], v[56:59], v[140:143]
    v_mfma_f32_16x16x32_bf16 a[96:99], v[16:19], v[56:59], a[96:99]
    buffer_load_dwordx4 a[116:119], v221, s[16:19], s68 offen sc1
    v_mfma_f32_16x16x32_bf16 a[100:103], v[20:23], v[56:59], a[100:103]
    ds_write_b128 v229, a[84:87] offset:7168
    v_mfma_f32_16x16x32_bf16 a[104:107], v[24:27], v[56:59], a[104:107]
    s_waitcnt vmcnt(9)
    v_mfma_f32_16x16x32_bf16 v[140:143], v[28:31], v[60:63], v[140:143]
    ds_write_b128 v230, a[88:91] offset:0
    v_mfma_f32_16x16x32_bf16 a[96:99], v[32:35], v[60:63], a[96:99]
    buffer_load_dwordx4 a[120:123], v221, s[16:19], s69 offen sc1
    v_mfma_f32_16x16x32_bf16 a[100:103], v[36:39], v[60:63], a[100:103]
    ds_write_b128 v230, a[92:95] offset:33792
    v_mfma_f32_16x16x32_bf16 a[104:107], v[40:43], v[60:63], a[104:107]
    s_waitcnt vmcnt(9)
    v_mfma_f32_16x16x32_bf16 v[140:143], a[224:227], v[64:67], v[140:143]
    v_mfma_f32_16x16x32_bf16 a[96:99], a[228:231], v[64:67], a[96:99]
    buffer_load_dwordx4 a[124:127], v221, s[16:19], s67 offen sc1
    v_mfma_f32_16x16x32_bf16 a[100:103], a[232:235], v[64:67], a[100:103]
    v_mfma_f32_16x16x32_bf16 a[104:107], a[236:239], v[64:67], a[104:107]
    s_waitcnt vmcnt(9)
    v_mfma_f32_16x16x32_bf16 v[140:143], a[240:243], v[68:71], v[140:143]
    v_mfma_f32_16x16x32_bf16 a[96:99], a[244:247], v[68:71], a[96:99]
    buffer_load_dwordx4 v[44:47], v221, s[16:19], s86 offen sc1
    v_mfma_f32_16x16x32_bf16 a[100:103], a[248:251], v[68:71], a[100:103]
    v_mfma_f32_16x16x32_bf16 a[104:107], a[252:255], v[68:71], a[104:107]
    s_waitcnt vmcnt(9)
    v_mfma_f32_16x16x32_bf16 v[108:111], v[204:207], v[72:75], v[108:111]
    v_mfma_f32_16x16x32_bf16 a[0:3], v[208:211], v[72:75], a[0:3]
    buffer_load_dwordx4 v[48:51], v222, s[16:19], s53 offen sc1
    v_mfma_f32_16x16x32_bf16 a[4:7], v[212:215], v[72:75], a[4:7]
    v_mfma_f32_16x16x32_bf16 a[8:11], v[216:219], v[72:75], a[8:11]
    s_waitcnt vmcnt(9)
    v_mfma_f32_16x16x32_bf16 v[108:111], v[12:15], v[144:147], v[108:111]
    v_mfma_f32_16x16x32_bf16 a[0:3], v[16:19], v[144:147], a[0:3]
    buffer_load_dwordx4 v[52:55], v222, s[16:19], s68 offen sc1
    v_mfma_f32_16x16x32_bf16 a[4:7], v[20:23], v[144:147], a[4:7]
    ds_write_b128 v229, a[96:99] offset:32768
    v_mfma_f32_16x16x32_bf16 a[8:11], v[24:27], v[144:147], a[8:11]
    s_waitcnt vmcnt(9)
    v_mfma_f32_16x16x32_bf16 v[108:111], v[28:31], v[148:151], v[108:111]
    ds_write_b128 v230, a[100:103] offset:1024
    v_mfma_f32_16x16x32_bf16 a[0:3], v[32:35], v[148:151], a[0:3]
    buffer_load_dwordx4 v[56:59], v222, s[16:19], s69 offen sc1
    v_mfma_f32_16x16x32_bf16 a[4:7], v[36:39], v[148:151], a[4:7]
    ds_write_b128 v230, a[104:107] offset:34816
    v_mfma_f32_16x16x32_bf16 a[8:11], v[40:43], v[148:151], a[8:11]
    s_waitcnt vmcnt(9)
    v_mfma_f32_16x16x32_bf16 v[108:111], a[224:227], v[152:155], v[108:111]
    v_mfma_f32_16x16x32_bf16 a[0:3], a[228:231], v[152:155], a[0:3]
    buffer_load_dwordx4 v[60:63], v222, s[16:19], s67 offen sc1
    v_mfma_f32_16x16x32_bf16 a[4:7], a[232:235], v[152:155], a[4:7]
    v_mfma_f32_16x16x32_bf16 a[8:11], a[236:239], v[152:155], a[8:11]
    s_waitcnt vmcnt(9)
    v_mfma_f32_16x16x32_bf16 v[108:111], a[240:243], a[108:111], v[108:111]
    s_waitcnt lgkmcnt(0)
    s_barrier
    ds_read_b128 v[76:79], v231 offset:4096
    ds_read_b128 v[80:83], v236 offset:37888
    v_mfma_f32_16x16x32_bf16 a[0:3], a[244:247], a[108:111], a[0:3]
    buffer_load_dwordx4 v[64:67], v222, s[16:19], s86 offen sc1
    ds_read_b128 v[84:87], v238 offset:6144
    ds_read_b128 v[88:91], v231 offset:5120
    v_mfma_f32_16x16x32_bf16 a[4:7], a[248:251], a[108:111], a[4:7]
    ds_read_b128 v[92:95], v236 offset:38912
    ds_read_b128 v[96:99], v238 offset:7168
    v_mfma_f32_16x16x32_bf16 a[8:11], a[252:255], a[108:111], a[8:11]
    s_waitcnt vmcnt(9)
    ds_read_b128 v[100:103], v231 offset:6144
    ds_read_b128 v[104:107], v236 offset:39936
    v_mfma_f32_16x16x32_bf16 v[112:115], v[204:207], a[112:115], v[112:115]
    ds_read_b128 v[156:159], v238 offset:32768
    ds_read_b128 v[160:163], v231 offset:7168
    v_mfma_f32_16x16x32_bf16 a[12:15], v[208:211], a[112:115], a[12:15]
    buffer_load_dwordx4 v[68:71], v223, s[16:19], s53 offen sc1
    ds_read_b128 v[164:167], v237 offset:0
    ds_read_b128 v[168:171], v238 offset:33792
    v_mfma_f32_16x16x32_bf16 a[16:19], v[212:215], a[112:115], a[16:19]
    ds_read_b128 v[172:175], v231 offset:32768
    ds_read_b128 v[176:179], v237 offset:1024
    v_mfma_f32_16x16x32_bf16 a[20:23], v[216:219], a[112:115], a[20:23]
    s_waitcnt vmcnt(9)
    ds_read_b128 v[180:183], v238 offset:34816
    v_mfma_f32_16x16x32_bf16 v[112:115], v[12:15], a[116:119], v[112:115]
    v_mfma_f32_16x16x32_bf16 a[12:15], v[16:19], a[116:119], a[12:15]
    buffer_load_dwordx4 v[72:75], v223, s[16:19], s68 offen sc1
    v_mfma_f32_16x16x32_bf16 a[16:19], v[20:23], a[116:119], a[16:19]
    ds_write_b128 v229, a[0:3] offset:0
    v_mfma_f32_16x16x32_bf16 a[20:23], v[24:27], a[116:119], a[20:23]
    s_waitcnt vmcnt(9)
    v_mfma_f32_16x16x32_bf16 v[112:115], v[28:31], a[120:123], v[112:115]
    ds_write_b128 v229, a[4:7] offset:33792
    v_mfma_f32_16x16x32_bf16 a[12:15], v[32:35], a[120:123], a[12:15]
    buffer_load_dwordx4 v[144:147], v223, s[16:19], s69 offen sc1
    v_mfma_f32_16x16x32_bf16 a[16:19], v[36:39], a[120:123], a[16:19]
    ds_write_b128 v230, a[8:11] offset:2048
    s_waitcnt lgkmcnt(3)
    v_pk_add_f32 v[124:125], v[124:125], v[76:77]
    v_pk_add_f32 v[126:127], v[126:127], v[78:79]
    v_pk_add_f32 v[80:81], v[80:81], v[84:85]
    v_pk_add_f32 v[82:83], v[82:83], v[86:87]
    v_pk_add_f32 v[124:125], v[124:125], v[80:81]
    v_pk_add_f32 v[126:127], v[126:127], v[82:83]
    v_mfma_f32_16x16x32_bf16 a[20:23], v[40:43], a[120:123], a[20:23]
    s_waitcnt vmcnt(9)
    buffer_store_dwordx4 v[124:127], v10, s[12:15], s7 offen offset:0 sc1
    v_mfma_f32_16x16x32_bf16 v[112:115], a[224:227], a[124:127], v[112:115]
    v_pk_add_f32 v[128:129], v[128:129], v[88:89]
    v_pk_add_f32 v[130:131], v[130:131], v[90:91]
    v_pk_add_f32 v[92:93], v[92:93], v[96:97]
    v_pk_add_f32 v[94:95], v[94:95], v[98:99]
    v_pk_add_f32 v[128:129], v[128:129], v[92:93]
    v_pk_add_f32 v[130:131], v[130:131], v[94:95]
    v_mfma_f32_16x16x32_bf16 a[12:15], a[228:231], a[124:127], a[12:15]
    buffer_load_dwordx4 v[148:151], v223, s[16:19], s67 offen sc1
    buffer_store_dwordx4 v[128:131], v10, s[12:15], s50 offen offset:0 sc1
    v_mfma_f32_16x16x32_bf16 a[16:19], a[232:235], a[124:127], a[16:19]
    v_pk_add_f32 v[132:133], v[132:133], v[100:101]
    v_pk_add_f32 v[134:135], v[134:135], v[102:103]
    v_pk_add_f32 v[104:105], v[104:105], v[156:157]
    v_pk_add_f32 v[106:107], v[106:107], v[158:159]
    v_pk_add_f32 v[132:133], v[132:133], v[104:105]
    v_pk_add_f32 v[134:135], v[134:135], v[106:107]
    v_mfma_f32_16x16x32_bf16 a[20:23], a[236:239], a[124:127], a[20:23]
    s_waitcnt vmcnt(11)
    buffer_store_dwordx4 v[132:135], v10, s[12:15], s50 offen offset:1024 sc1
    v_mfma_f32_16x16x32_bf16 v[112:115], a[240:243], v[44:47], v[112:115]
    v_pk_add_f32 v[136:137], v[136:137], v[160:161]
    v_pk_add_f32 v[138:139], v[138:139], v[162:163]
    v_pk_add_f32 v[164:165], v[164:165], v[168:169]
    v_pk_add_f32 v[166:167], v[166:167], v[170:171]
    v_pk_add_f32 v[136:137], v[136:137], v[164:165]
    v_pk_add_f32 v[138:139], v[138:139], v[166:167]
    v_mfma_f32_16x16x32_bf16 a[12:15], a[244:247], v[44:47], a[12:15]
    buffer_load_dwordx4 v[152:155], v223, s[16:19], s86 offen sc1
    buffer_store_dwordx4 v[136:139], v10, s[12:15], s50 offen offset:2048 sc1
    v_mfma_f32_16x16x32_bf16 a[16:19], a[248:251], v[44:47], a[16:19]
    v_pk_add_f32 v[140:141], v[140:141], v[172:173]
    v_pk_add_f32 v[142:143], v[142:143], v[174:175]
    v_pk_add_f32 v[176:177], v[176:177], v[180:181]
    v_pk_add_f32 v[178:179], v[178:179], v[182:183]
    v_pk_add_f32 v[140:141], v[140:141], v[176:177]
    v_pk_add_f32 v[142:143], v[142:143], v[178:179]
    v_mfma_f32_16x16x32_bf16 a[20:23], a[252:255], v[44:47], a[20:23]
    s_waitcnt vmcnt(13)
    buffer_store_dwordx4 v[140:143], v10, s[12:15], s50 offen offset:3072 sc1
    v_mfma_f32_16x16x32_bf16 v[116:119], v[204:207], v[48:51], v[116:119]
    v_mfma_f32_16x16x32_bf16 a[24:27], v[208:211], v[48:51], a[24:27]
    v_mfma_f32_16x16x32_bf16 a[28:31], v[212:215], v[48:51], a[28:31]
    v_mfma_f32_16x16x32_bf16 a[32:35], v[216:219], v[48:51], a[32:35]
    s_waitcnt vmcnt(13)
    v_mfma_f32_16x16x32_bf16 v[116:119], v[12:15], v[52:55], v[116:119]
    v_mfma_f32_16x16x32_bf16 a[24:27], v[16:19], v[52:55], a[24:27]
    v_mfma_f32_16x16x32_bf16 a[28:31], v[20:23], v[52:55], a[28:31]
    ds_write_b128 v229, a[12:15] offset:1024
    v_mfma_f32_16x16x32_bf16 a[32:35], v[24:27], v[52:55], a[32:35]
    s_waitcnt vmcnt(12)
    v_mfma_f32_16x16x32_bf16 v[116:119], v[28:31], v[56:59], v[116:119]
    ds_write_b128 v229, a[16:19] offset:34816
    v_mfma_f32_16x16x32_bf16 a[24:27], v[32:35], v[56:59], a[24:27]
    v_mfma_f32_16x16x32_bf16 a[28:31], v[36:39], v[56:59], a[28:31]
    ds_write_b128 v230, a[20:23] offset:3072
    v_mfma_f32_16x16x32_bf16 a[32:35], v[40:43], v[56:59], a[32:35]
    s_waitcnt vmcnt(11)
    v_mfma_f32_16x16x32_bf16 v[116:119], a[224:227], v[60:63], v[116:119]
    v_mfma_f32_16x16x32_bf16 a[24:27], a[228:231], v[60:63], a[24:27]
    v_mfma_f32_16x16x32_bf16 a[28:31], a[232:235], v[60:63], a[28:31]
    v_mfma_f32_16x16x32_bf16 a[32:35], a[236:239], v[60:63], a[32:35]
    s_waitcnt vmcnt(10)
    v_mfma_f32_16x16x32_bf16 v[116:119], a[240:243], v[64:67], v[116:119]
    v_mfma_f32_16x16x32_bf16 a[24:27], a[244:247], v[64:67], a[24:27]
    v_mfma_f32_16x16x32_bf16 a[28:31], a[248:251], v[64:67], a[28:31]
    v_mfma_f32_16x16x32_bf16 a[32:35], a[252:255], v[64:67], a[32:35]
    s_waitcnt vmcnt(9)
    v_mfma_f32_16x16x32_bf16 v[120:123], v[204:207], v[68:71], v[120:123]
    v_mfma_f32_16x16x32_bf16 a[36:39], v[208:211], v[68:71], a[36:39]
    v_mfma_f32_16x16x32_bf16 a[40:43], v[212:215], v[68:71], a[40:43]
    v_mfma_f32_16x16x32_bf16 a[44:47], v[216:219], v[68:71], a[44:47]
    s_waitcnt vmcnt(8)
    v_mfma_f32_16x16x32_bf16 v[120:123], v[12:15], v[72:75], v[120:123]
    v_mfma_f32_16x16x32_bf16 a[36:39], v[16:19], v[72:75], a[36:39]
    v_mfma_f32_16x16x32_bf16 a[40:43], v[20:23], v[72:75], a[40:43]
    ds_write_b128 v229, a[24:27] offset:2048
    v_mfma_f32_16x16x32_bf16 a[44:47], v[24:27], v[72:75], a[44:47]
    s_waitcnt vmcnt(7)
    v_mfma_f32_16x16x32_bf16 v[120:123], v[28:31], v[144:147], v[120:123]
    ds_write_b128 v229, a[28:31] offset:35840
    v_mfma_f32_16x16x32_bf16 a[36:39], v[32:35], v[144:147], a[36:39]
    v_mfma_f32_16x16x32_bf16 a[40:43], v[36:39], v[144:147], a[40:43]
    ds_write_b128 v230, a[32:35] offset:4096
    v_mfma_f32_16x16x32_bf16 a[44:47], v[40:43], v[144:147], a[44:47]
    s_waitcnt vmcnt(5)
    v_mfma_f32_16x16x32_bf16 v[120:123], a[224:227], v[148:151], v[120:123]
    v_mfma_f32_16x16x32_bf16 a[36:39], a[228:231], v[148:151], a[36:39]
    v_mfma_f32_16x16x32_bf16 a[40:43], a[232:235], v[148:151], a[40:43]
    v_mfma_f32_16x16x32_bf16 a[44:47], a[236:239], v[148:151], a[44:47]
    s_waitcnt vmcnt(2)
    v_mfma_f32_16x16x32_bf16 v[120:123], a[240:243], v[152:155], v[120:123]
    v_mfma_f32_16x16x32_bf16 a[36:39], a[244:247], v[152:155], a[36:39]
    v_mfma_f32_16x16x32_bf16 a[40:43], a[248:251], v[152:155], a[40:43]
    v_mfma_f32_16x16x32_bf16 a[44:47], a[252:255], v[152:155], a[44:47]
    s_nop 5
    ds_write_b128 v229, a[36:39] offset:3072
    ds_write_b128 v229, a[40:43] offset:36864
    ds_write_b128 v230, a[44:47] offset:5120
    buffer_load_dwordx4 v[44:47], v10, s[12:15], s51 offen offset:0 sc1
    buffer_load_dwordx4 v[48:51], v10, s[12:15], s51 offen offset:1024 sc1
    buffer_load_dwordx4 v[52:55], v10, s[12:15], s51 offen offset:2048 sc1
    buffer_load_dwordx4 v[56:59], v10, s[12:15], s51 offen offset:3072 sc1
    buffer_load_dwordx4 v[60:63], v10, s[12:15], s64 offen offset:0 sc1
    s_waitcnt lgkmcnt(0)
    s_barrier
    ds_read_b128 v[156:159], v231 offset:0
    ds_read_b128 v[160:163], v236 offset:33792
    ds_read_b128 v[164:167], v238 offset:2048
    ds_read_b128 v[168:171], v231 offset:1024
    ds_read_b128 v[172:175], v236 offset:34816
    ds_read_b128 v[176:179], v238 offset:3072
    ds_read_b128 v[180:183], v231 offset:2048
    ds_read_b128 v[184:187], v236 offset:35840
    ds_read_b128 v[188:191], v238 offset:4096
    ds_read_b128 v[192:195], v231 offset:3072
    ds_read_b128 v[196:199], v236 offset:36864
    ds_read_b128 v[200:203], v238 offset:5120
    s_waitcnt lgkmcnt(9)
    v_pk_add_f32 v[108:109], v[108:109], v[156:157]
    v_pk_add_f32 v[110:111], v[110:111], v[158:159]
    v_pk_add_f32 v[160:161], v[160:161], v[164:165]
    v_pk_add_f32 v[162:163], v[162:163], v[166:167]
    v_pk_add_f32 v[108:109], v[108:109], v[160:161]
    v_pk_add_f32 v[110:111], v[110:111], v[162:163]
    s_waitcnt lgkmcnt(6)
    v_pk_add_f32 v[112:113], v[112:113], v[168:169]
    v_pk_add_f32 v[114:115], v[114:115], v[170:171]
    v_pk_add_f32 v[172:173], v[172:173], v[176:177]
    v_pk_add_f32 v[174:175], v[174:175], v[178:179]
    v_pk_add_f32 v[112:113], v[112:113], v[172:173]
    v_pk_add_f32 v[114:115], v[114:115], v[174:175]
    s_waitcnt lgkmcnt(3)
    v_pk_add_f32 v[116:117], v[116:117], v[180:181]
    v_pk_add_f32 v[118:119], v[118:119], v[182:183]
    v_pk_add_f32 v[184:185], v[184:185], v[188:189]
    v_pk_add_f32 v[186:187], v[186:187], v[190:191]
    v_pk_add_f32 v[116:117], v[116:117], v[184:185]
    v_pk_add_f32 v[118:119], v[118:119], v[186:187]
    s_waitcnt lgkmcnt(0)
    v_pk_add_f32 v[120:121], v[120:121], v[192:193]
    v_pk_add_f32 v[122:123], v[122:123], v[194:195]
    v_pk_add_f32 v[196:197], v[196:197], v[200:201]
    v_pk_add_f32 v[198:199], v[198:199], v[202:203]
    v_pk_add_f32 v[120:121], v[120:121], v[196:197]
    v_pk_add_f32 v[122:123], v[122:123], v[198:199]
    s_mov_b32 s58, 0x40000
L_rx:
    s_waitcnt vmcnt(0)
    v_max3_u32 v232, v44, v45, v46
    v_max3_u32 v232, v232, v47, v48
    v_max3_u32 v232, v232, v49, v50
    v_max3_u32 v232, v232, v51, v52
    v_max3_u32 v232, v232, v53, v54
    v_max3_u32 v232, v232, v55, v56
    v_max3_u32 v232, v232, v57, v58
    v_max3_u32 v232, v232, v59, v60
    v_max3_u32 v232, v232, v61, v62
    v_max_u32 v232, v232, v63
    v_cmp_eq_u32 vcc, -1, v232
    s_sub_u32 s58, s58, 1
    s_cmp_eq_u32 s58, 0
    s_cbranch_scc1 L_rxd
    s_nop 0
    s_cmp_eq_u64 vcc, 0
    s_cbranch_scc1 L_rxd
    s_sleep 1
    buffer_load_dwordx4 v[44:47], v10, s[12:15], s51 offen offset:0 sc1
    buffer_load_dwordx4 v[48:51], v10, s[12:15], s51 offen offset:1024 sc1
    buffer_load_dwordx4 v[52:55], v10, s[12:15], s51 offen offset:2048 sc1
    buffer_load_dwordx4 v[56:59], v10, s[12:15], s51 offen offset:3072 sc1
    buffer_load_dwordx4 v[60:63], v10, s[12:15], s64 offen offset:0 sc1
    s_branch L_rx
L_rxd:
    v_pk_add_f32 v[108:109], v[108:109], v[44:45]
    v_pk_add_f32 v[110:111], v[110:111], v[46:47]
    v_cvt_pk_bf16_f32 v44, v108, v109
    v_cvt_pk_bf16_f32 v45, v110, v111
    buffer_store_dwordx2 v[44:45], v239, s[20:23], s6 offen
    s_add_u32 s6, s6, 16384
    v_pk_add_f32 v[112:113], v[112:113], v[48:49]
    v_pk_add_f32 v[114:115], v[114:115], v[50:51]
    v_cvt_pk_bf16_f32 v48, v112, v113
    v_cvt_pk_bf16_f32 v49, v114, v115
    buffer_store_dwordx2 v[48:49], v239, s[20:23], s6 offen
    s_add_u32 s6, s6, 16384
    v_pk_add_f32 v[116:117], v[116:117], v[52:53]
    v_pk_add_f32 v[118:119], v[118:119], v[54:55]
    v_cvt_pk_bf16_f32 v52, v116, v117
    v_cvt_pk_bf16_f32 v53, v118, v119
    buffer_store_dwordx2 v[52:53], v239, s[20:23], s6 offen
    s_add_u32 s6, s6, 16384
    v_pk_add_f32 v[120:121], v[120:121], v[56:57]
    v_pk_add_f32 v[122:123], v[122:123], v[58:59]
    v_cvt_pk_bf16_f32 v56, v120, v121
    v_cvt_pk_bf16_f32 v57, v122, v123
    buffer_store_dwordx2 v[56:57], v239, s[20:23], s6 offen
    v_pk_add_f32 v[124:125], v[124:125], v[60:61]
    v_pk_add_f32 v[126:127], v[126:127], v[62:63]
    v_cvt_pk_bf16_f32 v60, v124, v125
    v_cvt_pk_bf16_f32 v61, v126, v127
    buffer_store_dwordx2 v[60:61], v239, s[20:23], s66 offen
L_end:
    s_endpgm
L_fallback:
    s_mov_b32 s59, 1
    s_waitcnt vmcnt(0) lgkmcnt(0)
    s_barrier
    s_load_dwordx16 s[32:47], s[0:1], 0
    s_branch L_restart
L_truemax:
    v_bfe_u32 v237, v0, 2, 2
    v_and_b32 v238, 3, v0
    v_and_b32 v232, 1, v236
    v_lshl_add_u32 v232, v232, 2, v237
    v_lshrrev_b32 v233, 1, v232
    v_lshlrev_b32 v233, 5, v233
    v_lshl_add_u32 v233, v232, 7, v233
    v_lshrrev_b32 v232, 1, v236
    v_lshl_add_u32 v233, v232, 11, v233
    v_lshl_add_u32 v234, v238, 3, v233
    s_add_u32 s6, s3, 0
    s_and_b32 s6, s6, 3
    s_lshl_b32 s6, s6, 13
    v_add_u32 v204, s6, v239
    v_add_u32 v205, s6, v240
    v_add_u32 v212, s6, v234
    v_xor_b32 v213, 32, v212
    v_xor_b32 v214, 64, v212
    v_xor_b32 v215, 96, v212
    s_add_u32 s6, s3, 1
    s_and_b32 s6, s6, 3
    s_lshl_b32 s6, s6, 13
    v_add_u32 v206, s6, v239
    v_add_u32 v207, s6, v240
    v_add_u32 v216, s6, v234
    v_xor_b32 v217, 32, v216
    v_xor_b32 v218, 64, v216
    v_xor_b32 v219, 96, v216
    s_add_u32 s6, s3, 2
    s_and_b32 s6, s6, 3
    s_lshl_b32 s6, s6, 13
    v_add_u32 v208, s6, v239
    v_add_u32 v209, s6, v240
    v_add_u32 v220, s6, v234
    v_xor_b32 v221, 32, v220
    v_xor_b32 v222, 64, v220
    v_xor_b32 v223, 96, v220
    s_add_u32 s6, s3, 3
    s_and_b32 s6, s6, 3
    s_lshl_b32 s6, s6, 13
    v_add_u32 v210, s6, v239
    v_add_u32 v211, s6, v240
    v_add_u32 v224, s6, v234
    v_xor_b32 v225, 32, v224
    v_xor_b32 v226, 64, v224
    v_xor_b32 v227, 96, v224
    v_mov_b32 v228, 0x3f803f80
    v_mov_b32 v229, 0x3f803f80
    v_mov_b32 v230, 0x3f803f80
    v_mov_b32 v231, 0x3f803f80
    v_mov_b32 v244, 0xff800000
    v_mov_b32 v245, 0xff800000
    v_mov_b32 v246, 0xff800000
    v_mov_b32 v247, 0xff800000
    v_mov_b32 v248, 0xff800000
    v_mov_b32 v249, 0xff800000
    s_mov_b32 s58, 8
    s_add_u32 s68, s91, 131072
    s_waitcnt vmcnt(0) lgkmcnt(0)
L_fb_loop:
    s_barrier
    s_mov_b32 m0, s68
    s_nop 0
    buffer_load_dwordx4 v1, s[8:11], s48 offen nt lds
    buffer_load_dwordx4 v2, s[8:11], s48 offen offset:1024 nt lds
    buffer_load_dwordx4 v3, s[8:11], s48 offen offset:2048 nt lds
    buffer_load_dwordx4 v4, s[8:11], s48 offen offset:3072 nt lds
    s_add_u32 m0, s68, 4096
    s_nop 0
    buffer_load_dwordx4 v1, s[8:11], s49 offen nt lds
    buffer_load_dwordx4 v2, s[8:11], s49 offen offset:1024 nt lds
    buffer_load_dwordx4 v3, s[8:11], s49 offen offset:2048 nt lds
    buffer_load_dwordx4 v4, s[8:11], s49 offen offset:3072 nt lds
    s_add_u32 s48, s48, s52
    s_add_u32 s49, s49, s52
    s_and_b32 s48, s48, s32
    s_and_b32 s49, s49, s32
    s_waitcnt vmcnt(0)
    s_barrier
    ds_read_b128 a[192:195], v204 offset:0
    ds_read_b128 a[196:199], v205 offset:0
    ds_read_b128 a[200:203], v204 offset:1024
    ds_read_b128 a[204:207], v205 offset:1024
    ds_read_b128 a[208:211], v204 offset:4096
    ds_read_b128 a[212:215], v205 offset:4096
    ds_read_b128 a[216:219], v204 offset:5120
    ds_read_b128 a[220:223], v205 offset:5120
    s_waitcnt lgkmcnt(0)
    v_mfma_f32_16x16x32_bf16 v[108:111], a[192:195], v[12:15], 0
    v_mfma_f32_16x16x32_bf16 v[108:111], a[196:199], v[16:19], v[108:111]
    v_mfma_f32_16x16x32_bf16 v[108:111], a[200:203], v[20:23], v[108:111]
    v_mfma_f32_16x16x32_bf16 v[108:111], a[204:207], v[24:27], v[108:111]
    v_mfma_f32_16x16x32_bf16 v[112:115], a[192:195], v[28:31], 0
    v_mfma_f32_16x16x32_bf16 v[112:115], a[196:199], v[32:35], v[112:115]
    v_mfma_f32_16x16x32_bf16 v[112:115], a[200:203], v[36:39], v[112:115]
    v_mfma_f32_16x16x32_bf16 v[112:115], a[204:207], v[40:43], v[112:115]
    v_mfma_f32_16x16x32_bf16 v[116:119], a[192:195], v[44:47], 0
    v_mfma_f32_16x16x32_bf16 v[116:119], a[196:199], v[48:51], v[116:119]
    v_mfma_f32_16x16x32_bf16 v[116:119], a[200:203], v[52:55], v[116:119]
    v_mfma_f32_16x16x32_bf16 v[116:119], a[204:207], v[56:59], v[116:119]
    v_mfma_f32_16x16x32_bf16 v[120:123], a[192:195], v[60:63], 0
    v_mfma_f32_16x16x32_bf16 v[120:123], a[196:199], v[64:67], v[120:123]
    v_mfma_f32_16x16x32_bf16 v[120:123], a[200:203], v[68:71], v[120:123]
    v_mfma_f32_16x16x32_bf16 v[120:123], a[204:207], v[72:75], v[120:123]
    v_mfma_f32_16x16x32_bf16 v[124:127], a[192:195], v[76:79], 0
    v_mfma_f32_16x16x32_bf16 v[124:127], a[196:199], v[80:83], v[124:127]
    v_mfma_f32_16x16x32_bf16 v[124:127], a[200:203], v[84:87], v[124:127]
    v_mfma_f32_16x16x32_bf16 v[124:127], a[204:207], v[88:91], v[124:127]
    v_mfma_f32_16x16x32_bf16 v[128:131], a[192:195], v[92:95], 0
    v_mfma_f32_16x16x32_bf16 v[128:131], a[196:199], v[96:99], v[128:131]
    v_mfma_f32_16x16x32_bf16 v[128:131], a[200:203], v[100:103], v[128:131]
    v_mfma_f32_16x16x32_bf16 v[128:131], a[204:207], v[104:107], v[128:131]
    s_nop 7
    v_max3_f32 v244, v244, v108, v109
    v_max3_f32 v244, v244, v110, v111
    v_max3_f32 v245, v245, v112, v113
    v_max3_f32 v245, v245, v114, v115
    v_max3_f32 v246, v246, v116, v117
    v_max3_f32 v246, v246, v118, v119
    v_max3_f32 v247, v247, v120, v121
    v_max3_f32 v247, v247, v122, v123
    v_max3_f32 v248, v248, v124, v125
    v_max3_f32 v248, v248, v126, v127
    v_max3_f32 v249, v249, v128, v129
    v_max3_f32 v249, v249, v130, v131
    s_nop 3
    v_mfma_f32_16x16x32_bf16 v[108:111], a[208:211], v[12:15], 0
    v_mfma_f32_16x16x32_bf16 v[108:111], a[212:215], v[16:19], v[108:111]
    v_mfma_f32_16x16x32_bf16 v[108:111], a[216:219], v[20:23], v[108:111]
    v_mfma_f32_16x16x32_bf16 v[108:111], a[220:223], v[24:27], v[108:111]
    v_mfma_f32_16x16x32_bf16 v[112:115], a[208:211], v[28:31], 0
    v_mfma_f32_16x16x32_bf16 v[112:115], a[212:215], v[32:35], v[112:115]
    v_mfma_f32_16x16x32_bf16 v[112:115], a[216:219], v[36:39], v[112:115]
    v_mfma_f32_16x16x32_bf16 v[112:115], a[220:223], v[40:43], v[112:115]
    v_mfma_f32_16x16x32_bf16 v[116:119], a[208:211], v[44:47], 0
    v_mfma_f32_16x16x32_bf16 v[116:119], a[212:215], v[48:51], v[116:119]
    v_mfma_f32_16x16x32_bf16 v[116:119], a[216:219], v[52:55], v[116:119]
    v_mfma_f32_16x16x32_bf16 v[116:119], a[220:223], v[56:59], v[116:119]
    v_mfma_f32_16x16x32_bf16 v[120:123], a[208:211], v[60:63], 0
    v_mfma_f32_16x16x32_bf16 v[120:123], a[212:215], v[64:67], v[120:123]
    v_mfma_f32_16x16x32_bf16 v[120:123], a[216:219], v[68:71], v[120:123]
    v_mfma_f32_16x16x32_bf16 v[120:123], a[220:223], v[72:75], v[120:123]
    v_mfma_f32_16x16x32_bf16 v[124:127], a[208:211], v[76:79], 0
    v_mfma_f32_16x16x32_bf16 v[124:127], a[212:215], v[80:83], v[124:127]
    v_mfma_f32_16x16x32_bf16 v[124:127], a[216:219], v[84:87], v[124:127]
    v_mfma_f32_16x16x32_bf16 v[124:127], a[220:223], v[88:91], v[124:127]
    v_mfma_f32_16x16x32_bf16 v[128:131], a[208:211], v[92:95], 0
    v_mfma_f32_16x16x32_bf16 v[128:131], a[212:215], v[96:99], v[128:131]
    v_mfma_f32_16x16x32_bf16 v[128:131], a[216:219], v[100:103], v[128:131]
    v_mfma_f32_16x16x32_bf16 v[128:131], a[220:223], v[104:107], v[128:131]
    s_nop 7
    v_max3_f32 v244, v244, v108, v109
    v_max3_f32 v244, v244, v110, v111
    v_max3_f32 v245, v245, v112, v113
    v_max3_f32 v245, v245, v114, v115
    v_max3_f32 v246, v246, v116, v117
    v_max3_f32 v246, v246, v118, v119
    v_max3_f32 v247, v247, v120, v121
    v_max3_f32 v247, v247, v122, v123
    v_max3_f32 v248, v248, v124, v125
    v_max3_f32 v248, v248, v126, v127
    v_max3_f32 v249, v249, v128, v129
    v_max3_f32 v249, v249, v130, v131
    s_nop 3
    ds_read_b128 a[192:195], v206 offset:0
    ds_read_b128 a[196:199], v207 offset:0
    ds_read_b128 a[200:203], v206 offset:1024
    ds_read_b128 a[204:207], v207 offset:1024
    ds_read_b128 a[208:211], v206 offset:4096
    ds_read_b128 a[212:215], v207 offset:4096
    ds_read_b128 a[216:219], v206 offset:5120
    ds_read_b128 a[220:223], v207 offset:5120
    s_waitcnt lgkmcnt(0)
    v_mfma_f32_16x16x32_bf16 v[108:111], a[192:195], v[12:15], 0
    v_mfma_f32_16x16x32_bf16 v[108:111], a[196:199], v[16:19], v[108:111]
    v_mfma_f32_16x16x32_bf16 v[108:111], a[200:203], v[20:23], v[108:111]
    v_mfma_f32_16x16x32_bf16 v[108:111], a[204:207], v[24:27], v[108:111]
    v_mfma_f32_16x16x32_bf16 v[112:115], a[192:195], v[28:31], 0
    v_mfma_f32_16x16x32_bf16 v[112:115], a[196:199], v[32:35], v[112:115]
    v_mfma_f32_16x16x32_bf16 v[112:115], a[200:203], v[36:39], v[112:115]
    v_mfma_f32_16x16x32_bf16 v[112:115], a[204:207], v[40:43], v[112:115]
    v_mfma_f32_16x16x32_bf16 v[116:119], a[192:195], v[44:47], 0
    v_mfma_f32_16x16x32_bf16 v[116:119], a[196:199], v[48:51], v[116:119]
    v_mfma_f32_16x16x32_bf16 v[116:119], a[200:203], v[52:55], v[116:119]
    v_mfma_f32_16x16x32_bf16 v[116:119], a[204:207], v[56:59], v[116:119]
    v_mfma_f32_16x16x32_bf16 v[120:123], a[192:195], v[60:63], 0
    v_mfma_f32_16x16x32_bf16 v[120:123], a[196:199], v[64:67], v[120:123]
    v_mfma_f32_16x16x32_bf16 v[120:123], a[200:203], v[68:71], v[120:123]
    v_mfma_f32_16x16x32_bf16 v[120:123], a[204:207], v[72:75], v[120:123]
    v_mfma_f32_16x16x32_bf16 v[124:127], a[192:195], v[76:79], 0
    v_mfma_f32_16x16x32_bf16 v[124:127], a[196:199], v[80:83], v[124:127]
    v_mfma_f32_16x16x32_bf16 v[124:127], a[200:203], v[84:87], v[124:127]
    v_mfma_f32_16x16x32_bf16 v[124:127], a[204:207], v[88:91], v[124:127]
    v_mfma_f32_16x16x32_bf16 v[128:131], a[192:195], v[92:95], 0
    v_mfma_f32_16x16x32_bf16 v[128:131], a[196:199], v[96:99], v[128:131]
    v_mfma_f32_16x16x32_bf16 v[128:131], a[200:203], v[100:103], v[128:131]
    v_mfma_f32_16x16x32_bf16 v[128:131], a[204:207], v[104:107], v[128:131]
    s_nop 7
    v_max3_f32 v244, v244, v108, v109
    v_max3_f32 v244, v244, v110, v111
    v_max3_f32 v245, v245, v112, v113
    v_max3_f32 v245, v245, v114, v115
    v_max3_f32 v246, v246, v116, v117
    v_max3_f32 v246, v246, v118, v119
    v_max3_f32 v247, v247, v120, v121
    v_max3_f32 v247, v247, v122, v123
    v_max3_f32 v248, v248, v124, v125
    v_max3_f32 v248, v248, v126, v127
    v_max3_f32 v249, v249, v128, v129
    v_max3_f32 v249, v249, v130, v131
    s_nop 3
    v_mfma_f32_16x16x32_bf16 v[108:111], a[208:211], v[12:15], 0
    v_mfma_f32_16x16x32_bf16 v[108:111], a[212:215], v[16:19], v[108:111]
    v_mfma_f32_16x16x32_bf16 v[108:111], a[216:219], v[20:23], v[108:111]
    v_mfma_f32_16x16x32_bf16 v[108:111], a[220:223], v[24:27], v[108:111]
    v_mfma_f32_16x16x32_bf16 v[112:115], a[208:211], v[28:31], 0
    v_mfma_f32_16x16x32_bf16 v[112:115], a[212:215], v[32:35], v[112:115]
    v_mfma_f32_16x16x32_bf16 v[112:115], a[216:219], v[36:39], v[112:115]
    v_mfma_f32_16x16x32_bf16 v[112:115], a[220:223], v[40:43], v[112:115]
    v_mfma_f32_16x16x32_bf16 v[116:119], a[208:211], v[44:47], 0
    v_mfma_f32_16x16x32_bf16 v[116:119], a[212:215], v[48:51], v[116:119]
    v_mfma_f32_16x16x32_bf16 v[116:119], a[216:219], v[52:55], v[116:119]
    v_mfma_f32_16x16x32_bf16 v[116:119], a[220:223], v[56:59], v[116:119]
    v_mfma_f32_16x16x32_bf16 v[120:123], a[208:211], v[60:63], 0
    v_mfma_f32_16x16x32_bf16 v[120:123], a[212:215], v[64:67], v[120:123]
    v_mfma_f32_16x16x32_bf16 v[120:123], a[216:219], v[68:71], v[120:123]
    v_mfma_f32_16x16x32_bf16 v[120:123], a[220:223], v[72:75], v[120:123]
    v_mfma_f32_16x16x32_bf16 v[124:127], a[208:211], v[76:79], 0
    v_mfma_f32_16x16x32_bf16 v[124:127], a[212:215], v[80:83], v[124:127]
    v_mfma_f32_16x16x32_bf16 v[124:127], a[216:219], v[84:87], v[124:127]
    v_mfma_f32_16x16x32_bf16 v[124:127], a[220:223], v[88:91], v[124:127]
    v_mfma_f32_16x16x32_bf16 v[128:131], a[208:211], v[92:95], 0
    v_mfma_f32_16x16x32_bf16 v[128:131], a[212:215], v[96:99], v[128:131]
    v_mfma_f32_16x16x32_bf16 v[128:131], a[216:219], v[100:103], v[128:131]
    v_mfma_f32_16x16x32_bf16 v[128:131], a[220:223], v[104:107], v[128:131]
    s_nop 7
    v_max3_f32 v244, v244, v108, v109
    v_max3_f32 v244, v244, v110, v111
    v_max3_f32 v245, v245, v112, v113
    v_max3_f32 v245, v245, v114, v115
    v_max3_f32 v246, v246, v116, v117
    v_max3_f32 v246, v246, v118, v119
    v_max3_f32 v247, v247, v120, v121
    v_max3_f32 v247, v247, v122, v123
    v_max3_f32 v248, v248, v124, v125
    v_max3_f32 v248, v248, v126, v127
    v_max3_f32 v249, v249, v128, v129
    v_max3_f32 v249, v249, v130, v131
    s_nop 3
    ds_read_b128 a[192:195], v208 offset:0
    ds_read_b128 a[196:199], v209 offset:0
    ds_read_b128 a[200:203], v208 offset:1024
    ds_read_b128 a[204:207], v209 offset:1024
    ds_read_b128 a[208:211], v208 offset:4096
    ds_read_b128 a[212:215], v209 offset:4096
    ds_read_b128 a[216:219], v208 offset:5120
    ds_read_b128 a[220:223], v209 offset:5120
    s_waitcnt lgkmcnt(0)
    v_mfma_f32_16x16x32_bf16 v[108:111], a[192:195], v[12:15], 0
    v_mfma_f32_16x16x32_bf16 v[108:111], a[196:199], v[16:19], v[108:111]
    v_mfma_f32_16x16x32_bf16 v[108:111], a[200:203], v[20:23], v[108:111]
    v_mfma_f32_16x16x32_bf16 v[108:111], a[204:207], v[24:27], v[108:111]
    v_mfma_f32_16x16x32_bf16 v[112:115], a[192:195], v[28:31], 0
    v_mfma_f32_16x16x32_bf16 v[112:115], a[196:199], v[32:35], v[112:115]
    v_mfma_f32_16x16x32_bf16 v[112:115], a[200:203], v[36:39], v[112:115]
    v_mfma_f32_16x16x32_bf16 v[112:115], a[204:207], v[40:43], v[112:115]
    v_mfma_f32_16x16x32_bf16 v[116:119], a[192:195], v[44:47], 0
    v_mfma_f32_16x16x32_bf16 v[116:119], a[196:199], v[48:51], v[116:119]
    v_mfma_f32_16x16x32_bf16 v[116:119], a[200:203], v[52:55], v[116:119]
    v_mfma_f32_16x16x32_bf16 v[116:119], a[204:207], v[56:59], v[116:119]
    v_mfma_f32_16x16x32_bf16 v[120:123], a[192:195], v[60:63], 0
    v_mfma_f32_16x16x32_bf16 v[120:123], a[196:199], v[64:67], v[120:123]
    v_mfma_f32_16x16x32_bf16 v[120:123], a[200:203], v[68:71], v[120:123]
    v_mfma_f32_16x16x32_bf16 v[120:123], a[204:207], v[72:75], v[120:123]
    v_mfma_f32_16x16x32_bf16 v[124:127], a[192:195], v[76:79], 0
    v_mfma_f32_16x16x32_bf16 v[124:127], a[196:199], v[80:83], v[124:127]
    v_mfma_f32_16x16x32_bf16 v[124:127], a[200:203], v[84:87], v[124:127]
    v_mfma_f32_16x16x32_bf16 v[124:127], a[204:207], v[88:91], v[124:127]
    v_mfma_f32_16x16x32_bf16 v[128:131], a[192:195], v[92:95], 0
    v_mfma_f32_16x16x32_bf16 v[128:131], a[196:199], v[96:99], v[128:131]
    v_mfma_f32_16x16x32_bf16 v[128:131], a[200:203], v[100:103], v[128:131]
    v_mfma_f32_16x16x32_bf16 v[128:131], a[204:207], v[104:107], v[128:131]
    s_nop 7
    v_max3_f32 v244, v244, v108, v109
    v_max3_f32 v244, v244, v110, v111
    v_max3_f32 v245, v245, v112, v113
    v_max3_f32 v245, v245, v114, v115
    v_max3_f32 v246, v246, v116, v117
    v_max3_f32 v246, v246, v118, v119
    v_max3_f32 v247, v247, v120, v121
    v_max3_f32 v247, v247, v122, v123
    v_max3_f32 v248, v248, v124, v125
    v_max3_f32 v248, v248, v126, v127
    v_max3_f32 v249, v249, v128, v129
    v_max3_f32 v249, v249, v130, v131
    s_nop 3
    v_mfma_f32_16x16x32_bf16 v[108:111], a[208:211], v[12:15], 0
    v_mfma_f32_16x16x32_bf16 v[108:111], a[212:215], v[16:19], v[108:111]
    v_mfma_f32_16x16x32_bf16 v[108:111], a[216:219], v[20:23], v[108:111]
    v_mfma_f32_16x16x32_bf16 v[108:111], a[220:223], v[24:27], v[108:111]
    v_mfma_f32_16x16x32_bf16 v[112:115], a[208:211], v[28:31], 0
    v_mfma_f32_16x16x32_bf16 v[112:115], a[212:215], v[32:35], v[112:115]
    v_mfma_f32_16x16x32_bf16 v[112:115], a[216:219], v[36:39], v[112:115]
    v_mfma_f32_16x16x32_bf16 v[112:115], a[220:223], v[40:43], v[112:115]
    v_mfma_f32_16x16x32_bf16 v[116:119], a[208:211], v[44:47], 0
    v_mfma_f32_16x16x32_bf16 v[116:119], a[212:215], v[48:51], v[116:119]
    v_mfma_f32_16x16x32_bf16 v[116:119], a[216:219], v[52:55], v[116:119]
    v_mfma_f32_16x16x32_bf16 v[116:119], a[220:223], v[56:59], v[116:119]
    v_mfma_f32_16x16x32_bf16 v[120:123], a[208:211], v[60:63], 0
    v_mfma_f32_16x16x32_bf16 v[120:123], a[212:215], v[64:67], v[120:123]
    v_mfma_f32_16x16x32_bf16 v[120:123], a[216:219], v[68:71], v[120:123]
    v_mfma_f32_16x16x32_bf16 v[120:123], a[220:223], v[72:75], v[120:123]
    v_mfma_f32_16x16x32_bf16 v[124:127], a[208:211], v[76:79], 0
    v_mfma_f32_16x16x32_bf16 v[124:127], a[212:215], v[80:83], v[124:127]
    v_mfma_f32_16x16x32_bf16 v[124:127], a[216:219], v[84:87], v[124:127]
    v_mfma_f32_16x16x32_bf16 v[124:127], a[220:223], v[88:91], v[124:127]
    v_mfma_f32_16x16x32_bf16 v[128:131], a[208:211], v[92:95], 0
    v_mfma_f32_16x16x32_bf16 v[128:131], a[212:215], v[96:99], v[128:131]
    v_mfma_f32_16x16x32_bf16 v[128:131], a[216:219], v[100:103], v[128:131]
    v_mfma_f32_16x16x32_bf16 v[128:131], a[220:223], v[104:107], v[128:131]
    s_nop 7
    v_max3_f32 v244, v244, v108, v109
    v_max3_f32 v244, v244, v110, v111
    v_max3_f32 v245, v245, v112, v113
    v_max3_f32 v245, v245, v114, v115
    v_max3_f32 v246, v246, v116, v117
    v_max3_f32 v246, v246, v118, v119
    v_max3_f32 v247, v247, v120, v121
    v_max3_f32 v247, v247, v122, v123
    v_max3_f32 v248, v248, v124, v125
    v_max3_f32 v248, v248, v126, v127
    v_max3_f32 v249, v249, v128, v129
    v_max3_f32 v249, v249, v130, v131
    s_nop 3
    ds_read_b128 a[192:195], v210 offset:0
    ds_read_b128 a[196:199], v211 offset:0
    ds_read_b128 a[200:203], v210 offset:1024
    ds_read_b128 a[204:207], v211 offset:1024
    ds_read_b128 a[208:211], v210 offset:4096
    ds_read_b128 a[212:215], v211 offset:4096
    ds_read_b128 a[216:219], v210 offset:5120
    ds_read_b128 a[220:223], v211 offset:5120
    s_waitcnt lgkmcnt(0)
    v_mfma_f32_16x16x32_bf16 v[108:111], a[192:195], v[12:15], 0
    v_mfma_f32_16x16x32_bf16 v[108:111], a[196:199], v[16:19], v[108:111]
    v_mfma_f32_16x16x32_bf16 v[108:111], a[200:203], v[20:23], v[108:111]
    v_mfma_f32_16x16x32_bf16 v[108:111], a[204:207], v[24:27], v[108:111]
    v_mfma_f32_16x16x32_bf16 v[112:115], a[192:195], v[28:31], 0
    v_mfma_f32_16x16x32_bf16 v[112:115], a[196:199], v[32:35], v[112:115]
    v_mfma_f32_16x16x32_bf16 v[112:115], a[200:203], v[36:39], v[112:115]
    v_mfma_f32_16x16x32_bf16 v[112:115], a[204:207], v[40:43], v[112:115]
    v_mfma_f32_16x16x32_bf16 v[116:119], a[192:195], v[44:47], 0
    v_mfma_f32_16x16x32_bf16 v[116:119], a[196:199], v[48:51], v[116:119]
    v_mfma_f32_16x16x32_bf16 v[116:119], a[200:203], v[52:55], v[116:119]
    v_mfma_f32_16x16x32_bf16 v[116:119], a[204:207], v[56:59], v[116:119]
    v_mfma_f32_16x16x32_bf16 v[120:123], a[192:195], v[60:63], 0
    v_mfma_f32_16x16x32_bf16 v[120:123], a[196:199], v[64:67], v[120:123]
    v_mfma_f32_16x16x32_bf16 v[120:123], a[200:203], v[68:71], v[120:123]
    v_mfma_f32_16x16x32_bf16 v[120:123], a[204:207], v[72:75], v[120:123]
    v_mfma_f32_16x16x32_bf16 v[124:127], a[192:195], v[76:79], 0
    v_mfma_f32_16x16x32_bf16 v[124:127], a[196:199], v[80:83], v[124:127]
    v_mfma_f32_16x16x32_bf16 v[124:127], a[200:203], v[84:87], v[124:127]
    v_mfma_f32_16x16x32_bf16 v[124:127], a[204:207], v[88:91], v[124:127]
    v_mfma_f32_16x16x32_bf16 v[128:131], a[192:195], v[92:95], 0
    v_mfma_f32_16x16x32_bf16 v[128:131], a[196:199], v[96:99], v[128:131]
    v_mfma_f32_16x16x32_bf16 v[128:131], a[200:203], v[100:103], v[128:131]
    v_mfma_f32_16x16x32_bf16 v[128:131], a[204:207], v[104:107], v[128:131]
    s_nop 7
    v_max3_f32 v244, v244, v108, v109
    v_max3_f32 v244, v244, v110, v111
    v_max3_f32 v245, v245, v112, v113
    v_max3_f32 v245, v245, v114, v115
    v_max3_f32 v246, v246, v116, v117
    v_max3_f32 v246, v246, v118, v119
    v_max3_f32 v247, v247, v120, v121
    v_max3_f32 v247, v247, v122, v123
    v_max3_f32 v248, v248, v124, v125
    v_max3_f32 v248, v248, v126, v127
    v_max3_f32 v249, v249, v128, v129
    v_max3_f32 v249, v249, v130, v131
    s_nop 3
    v_mfma_f32_16x16x32_bf16 v[108:111], a[208:211], v[12:15], 0
    v_mfma_f32_16x16x32_bf16 v[108:111], a[212:215], v[16:19], v[108:111]
    v_mfma_f32_16x16x32_bf16 v[108:111], a[216:219], v[20:23], v[108:111]
    v_mfma_f32_16x16x32_bf16 v[108:111], a[220:223], v[24:27], v[108:111]
    v_mfma_f32_16x16x32_bf16 v[112:115], a[208:211], v[28:31], 0
    v_mfma_f32_16x16x32_bf16 v[112:115], a[212:215], v[32:35], v[112:115]
    v_mfma_f32_16x16x32_bf16 v[112:115], a[216:219], v[36:39], v[112:115]
    v_mfma_f32_16x16x32_bf16 v[112:115], a[220:223], v[40:43], v[112:115]
    v_mfma_f32_16x16x32_bf16 v[116:119], a[208:211], v[44:47], 0
    v_mfma_f32_16x16x32_bf16 v[116:119], a[212:215], v[48:51], v[116:119]
    v_mfma_f32_16x16x32_bf16 v[116:119], a[216:219], v[52:55], v[116:119]
    v_mfma_f32_16x16x32_bf16 v[116:119], a[220:223], v[56:59], v[116:119]
    v_mfma_f32_16x16x32_bf16 v[120:123], a[208:211], v[60:63], 0
    v_mfma_f32_16x16x32_bf16 v[120:123], a[212:215], v[64:67], v[120:123]
    v_mfma_f32_16x16x32_bf16 v[120:123], a[216:219], v[68:71], v[120:123]
    v_mfma_f32_16x16x32_bf16 v[120:123], a[220:223], v[72:75], v[120:123]
    v_mfma_f32_16x16x32_bf16 v[124:127], a[208:211], v[76:79], 0
    v_mfma_f32_16x16x32_bf16 v[124:127], a[212:215], v[80:83], v[124:127]
    v_mfma_f32_16x16x32_bf16 v[124:127], a[216:219], v[84:87], v[124:127]
    v_mfma_f32_16x16x32_bf16 v[124:127], a[220:223], v[88:91], v[124:127]
    v_mfma_f32_16x16x32_bf16 v[128:131], a[208:211], v[92:95], 0
    v_mfma_f32_16x16x32_bf16 v[128:131], a[212:215], v[96:99], v[128:131]
    v_mfma_f32_16x16x32_bf16 v[128:131], a[216:219], v[100:103], v[128:131]
    v_mfma_f32_16x16x32_bf16 v[128:131], a[220:223], v[104:107], v[128:131]
    s_nop 7
    v_max3_f32 v244, v244, v108, v109
    v_max3_f32 v244, v244, v110, v111
    v_max3_f32 v245, v245, v112, v113
    v_max3_f32 v245, v245, v114, v115
    v_max3_f32 v246, v246, v116, v117
    v_max3_f32 v246, v246, v118, v119
    v_max3_f32 v247, v247, v120, v121
    v_max3_f32 v247, v247, v122, v123
    v_max3_f32 v248, v248, v124, v125
    v_max3_f32 v248, v248, v126, v127
    v_max3_f32 v249, v249, v128, v129
    v_max3_f32 v249, v249, v130, v131
    s_nop 3
    s_sub_u32 s58, s58, 1
    s_cmp_lg_u32 s58, 0
    s_cbranch_scc1 L_fb_loop
    s_barrier
    s_mov_b32 s48, s38
    s_add_u32 s49, s38, 4096
    s_mov_b32 m0, s68
    s_nop 0
    buffer_load_dwordx4 v1, s[8:11], s48 offen nt lds
    buffer_load_dwordx4 v2, s[8:11], s48 offen offset:1024 nt lds
    buffer_load_dwordx4 v3, s[8:11], s48 offen offset:2048 nt lds
    buffer_load_dwordx4 v4, s[8:11], s48 offen offset:3072 nt lds
    s_add_u32 m0, s68, 4096
    s_nop 0
    buffer_load_dwordx4 v1, s[8:11], s49 offen nt lds
    buffer_load_dwordx4 v2, s[8:11], s49 offen offset:1024 nt lds
    buffer_load_dwordx4 v3, s[8:11], s49 offen offset:2048 nt lds
    buffer_load_dwordx4 v4, s[8:11], s49 offen offset:3072 nt lds
    s_add_u32 s48, s48, s52
    s_add_u32 s49, s49, s52
    s_and_b32 s48, s48, s32
    s_and_b32 s49, s49, s32
    v_mov_b32 v156, v244
    v_mov_b32 v157, v245
    v_mov_b32 v158, v246
    v_mov_b32 v159, v247
    v_mov_b32 v160, v248
    v_mov_b32 v161, v249
    v_permlane32_swap_b32 v244, v156
    v_permlane32_swap_b32 v245, v157
    v_permlane32_swap_b32 v246, v158
    v_permlane32_swap_b32 v247, v159
    v_permlane32_swap_b32 v248, v160
    v_permlane32_swap_b32 v249, v161
    v_max_f32 v244, v244, v156
    v_max_f32 v245, v245, v157
    v_max_f32 v246, v246, v158
    v_max_f32 v247, v247, v159
    v_max_f32 v248, v248, v160
    v_max_f32 v249, v249, v161
    v_mov_b32 v156, v244
    v_mov_b32 v157, v245
    v_mov_b32 v158, v246
    v_mov_b32 v159, v247
    v_mov_b32 v160, v248
    v_mov_b32 v161, v249
    v_permlane16_swap_b32 v244, v156
    v_permlane16_swap_b32 v245, v157
    v_permlane16_swap_b32 v246, v158
    v_permlane16_swap_b32 v247, v159
    v_permlane16_swap_b32 v248, v160
    v_permlane16_swap_b32 v249, v161
    v_max_f32 v244, v244, v156
    v_max_f32 v245, v245, v157
    v_max_f32 v246, v246, v158
    v_max_f32 v247, v247, v159
    v_max_f32 v248, v248, v160
    v_max_f32 v249, v249, v161
    v_sub_f32 v108, 0, v244
    v_sub_f32 v109, 0, v244
    v_sub_f32 v110, 0, v244
    v_sub_f32 v111, 0, v244
    v_sub_f32 v112, 0, v245
    v_sub_f32 v113, 0, v245
    v_sub_f32 v114, 0, v245
    v_sub_f32 v115, 0, v245
    v_sub_f32 v116, 0, v246
    v_sub_f32 v117, 0, v246
    v_sub_f32 v118, 0, v246
    v_sub_f32 v119, 0, v246
    v_sub_f32 v120, 0, v247
    v_sub_f32 v121, 0, v247
    v_sub_f32 v122, 0, v247
    v_sub_f32 v123, 0, v247
    v_sub_f32 v124, 0, v248
    v_sub_f32 v125, 0, v248
    v_sub_f32 v126, 0, v248
    v_sub_f32 v127, 0, v248
    v_sub_f32 v128, 0, v249
    v_sub_f32 v129, 0, v249
    v_sub_f32 v130, 0, v249
    v_sub_f32 v131, 0, v249
    s_waitcnt vmcnt(0)
    s_barrier
    ds_read_b128 a[192:195], v204 offset:0
    ds_read_b128 a[196:199], v205 offset:0
    ds_read_b128 a[200:203], v204 offset:1024
    ds_read_b128 a[204:207], v205 offset:1024
    ds_read_b128 a[208:211], v204 offset:4096
    ds_read_b128 a[212:215], v205 offset:4096
    ds_read_b128 a[216:219], v204 offset:5120
    ds_read_b128 a[220:223], v205 offset:5120
    s_waitcnt lgkmcnt(0)
    s_mov_b32 s58, 3
    s_mov_b32 s66, 65536
    s_mov_b32 s65, 0xffff8000
    s_add_u32 s68, s91, 65536
    v_mfma_f32_16x16x32_bf16 v[156:159], a[192:195], v[12:15], v[108:111]
    v_mov_b32 v132, 0
    v_mov_b32 v133, 0
    s_add_u32 s50, s50, s53
    s_add_u32 s51, s51, s53
    s_and_b32 s50, s50, s33
    s_and_b32 s51, s51, s33
    s_mov_b32 m0, s56
    v_mfma_f32_16x16x32_bf16 v[156:159], a[196:199], v[16:19], v[156:159]
    v_mov_b32 v134, 0
    v_mov_b32 v135, 0
    buffer_load_dwordx4 v5, s[12:15], s50 offen nt lds
    v_mfma_f32_16x16x32_bf16 v[156:159], a[200:203], v[20:23], v[156:159]
    v_mov_b32 v136, 0
    v_mov_b32 v137, 0
    v_mfma_f32_16x16x32_bf16 v[156:159], a[204:207], v[24:27], v[156:159]
    v_mov_b32 v138, 0
    v_mov_b32 v139, 0
    v_mfma_f32_16x16x32_bf16 v[160:163], a[208:211], v[12:15], v[108:111]
    v_mov_b32 v140, 0
    v_mov_b32 v141, 0
    v_mfma_f32_16x16x32_bf16 v[160:163], a[212:215], v[16:19], v[160:163]
    v_mov_b32 v142, 0
    v_mov_b32 v143, 0
    v_mfma_f32_16x16x32_bf16 v[160:163], a[216:219], v[20:23], v[160:163]
    v_mov_b32 v144, 0
    v_mov_b32 v145, 0
    v_mfma_f32_16x16x32_bf16 v[160:163], a[220:223], v[24:27], v[160:163]
    v_mov_b32 v146, 0
    v_mov_b32 v147, 0
    v_mfma_f32_16x16x32_bf16 v[164:167], a[192:195], v[28:31], v[112:115]
    v_mov_b32 v148, 0
    v_mov_b32 v149, 0
    v_mfma_f32_16x16x32_bf16 v[164:167], a[196:199], v[32:35], v[164:167]
    v_mov_b32 v150, 0
    v_mov_b32 v151, 0
    v_exp_f32 v156, v156
    v_mfma_f32_16x16x32_bf16 v[164:167], a[200:203], v[36:39], v[164:167]
    v_mov_b32 v152, 0
    v_mov_b32 v153, 0
    v_mfma_f32_16x16x32_bf16 v[164:167], a[204:207], v[40:43], v[164:167]
    v_mov_b32 v154, 0
    v_mov_b32 v155, 0
    v_exp_f32 v157, v157
    v_mfma_f32_16x16x32_bf16 v[168:171], a[208:211], v[28:31], v[112:115]
    v_cvt_pk_bf16_f32 v188, v156, v157
    v_add_f32 v132, v132, v156
    v_mfma_f32_16x16x32_bf16 v[168:171], a[212:215], v[32:35], v[168:171]
    v_exp_f32 v158, v158
    v_mfma_f32_16x16x32_bf16 v[168:171], a[216:219], v[36:39], v[168:171]
    v_add_f32 v132, v132, v158
    v_mfma_f32_16x16x32_bf16 v[168:171], a[220:223], v[40:43], v[168:171]
    v_exp_f32 v159, v159
    s_nop 0
    v_cvt_pk_bf16_f32 v189, v158, v159
    v_add_f32 v133, v133, v157
    v_exp_f32 v160, v160
    buffer_load_dwordx4 v6, s[12:15], s50 offen offset:1024 nt lds
    v_exp_f32 v161, v161
    s_nop 0
    v_cvt_pk_bf16_f32 v190, v160, v161
    v_add_f32 v133, v133, v159
    v_exp_f32 v162, v162
    v_add_f32 v132, v132, v160
    v_add_f32 v133, v133, v161
    v_exp_f32 v163, v163
    s_waitcnt vmcnt(10)
    s_barrier
    ds_read_b64_tr_b16 a[224:225], v212 offset:0
    v_cvt_pk_bf16_f32 v191, v162, v163
    v_exp_f32 v164, v164
    ds_read_b64_tr_b16 a[228:229], v213 offset:0
    ds_read_b64_tr_b16 a[230:231], v213 offset:4096
    v_exp_f32 v165, v165
    ds_read_b64_tr_b16 a[226:227], v212 offset:4096
    v_cvt_pk_bf16_f32 v192, v164, v165
    v_exp_f32 v166, v166
    ds_read_b64_tr_b16 a[234:235], v214 offset:4096
    ds_read_b64_tr_b16 a[236:237], v215 offset:0
    v_exp_f32 v167, v167
    ds_read_b64_tr_b16 a[232:233], v214 offset:0
    v_cvt_pk_bf16_f32 v193, v166, v167
    s_nop 7
    s_branch L_loop
L_code_end:
.if (L_code_end - L_pc0) < 40960
.error "code prefetch range"
.endif
.if (L_code_end - L_pc1) < 24576
.error "code prefetch range"
.endif
.section .rodata,"a"
.p2align 6
.amdhsa_kernel standalone__gqa_block_cached__near_ridge_kernel
  .amdhsa_next_free_vgpr 512
  .amdhsa_next_free_sgpr 102
  .amdhsa_accum_offset 256
  .amdhsa_group_segment_fixed_size 0
  .amdhsa_kernarg_size 64
  .amdhsa_user_sgpr_count 2
  .amdhsa_user_sgpr_kernarg_segment_ptr 1
  .amdhsa_system_sgpr_workgroup_id_x 1
.end_amdhsa_kernel
```
